```python
import torch

def _softmax(x, axis=-1):
    return torch.softmax(x, dim=axis)
def _gelu(x):
    return torch.nn.functional.gelu(x, approximate="tanh")
def _silu(x):
    return torch.nn.functional.silu(x)
def _sigmoid(x):
    return torch.sigmoid(x)
def _layernorm(x, axis=-1, eps=1e-5):
    m = x.mean(dim=axis, keepdim=True)
    v = x.var(dim=axis, keepdim=True, unbiased=False)
    return (x - m) / torch.sqrt(v + eps)
def _scatter_add(tgt, idx, src, axis=0):
    return tgt.clone().index_add_(axis, idx, src)
def _segment_sum(src, seg, n):
    out = torch.zeros((n,) + src.shape[1:], dtype=src.dtype)
    return out.index_add_(0, seg, src)
def _pad(x, pw):
    flat = tuple(v for pair in reversed(pw) for v in pair)
    return torch.nn.functional.pad(x, flat)

kernel_name = 'recurrent_scan__compressed_kv_cla__geglu_ffn__prompt'

def setup_inputs():

    _w = (lambda a: (lambda t: t.to(torch.bfloat16) if t.is_floating_point() else t)(torch.as_tensor(a)))
    def _A_setup():
        B, H, Sq, Sk, D, M = 1, 32, 2048, 2048, 128, 512
        Dc = 4 * D
        return {
            "x": _w((lambda *s: torch.randn(*s, dtype=torch.bfloat16) * 0.05)(B, Sq, M)),
            "c_kv": _w((lambda *s: torch.randn(*s, dtype=torch.bfloat16) * 0.2)(B, Sk, Dc)),
            "w_q": _w((lambda *s: torch.randn(*s, dtype=torch.bfloat16) * 3.2)(M, H, D) * (M ** -0.5)),
            "w_uk": _w((lambda *s: torch.randn(*s, dtype=torch.bfloat16) * 3.2)(Dc, H, D) * (Dc ** -0.5)),
            "w_uv": _w((lambda *s: torch.randn(*s, dtype=torch.bfloat16) * 0.2)(Dc, H, D) * (Dc ** -0.5)),
            "w_o": _w((lambda *s: torch.randn(*s, dtype=torch.bfloat16) * 0.2)(H, D, M) * ((H * D) ** -0.5)),
        }
    _A_in = _A_setup()

    def _B_setup():
        B, S, D, F = 1, 2048, 512, 1376
        return {
            "x": _w((lambda *s: torch.randn(*s, dtype=torch.bfloat16) * 0.05)(B, S, D)),
            "w_gate": _w((lambda *s: torch.randn(*s, dtype=torch.bfloat16) * 0.1)(D, F)),
            "w_up": _w((lambda *s: torch.randn(*s, dtype=torch.bfloat16) * 0.1)(D, F)),
            "w_down": _w((lambda *s: torch.randn(*s, dtype=torch.bfloat16) * 0.1)(F, D)),
        }
    _B_in = _B_setup()

    return {
        "A_x": _A_in["x"],
        "A_c_kv": _A_in["c_kv"],
        "A_w_q": _A_in["w_q"],
        "A_w_uk": _A_in["w_uk"],
        "A_w_uv": _A_in["w_uv"],
        "A_w_o": _A_in["w_o"],
        "B_x": _B_in["x"],
        "B_w_gate": _B_in["w_gate"],
        "B_w_up": _B_in["w_up"],
        "B_w_down": _B_in["w_down"],
    }

def reference(A_x, A_c_kv, A_w_q, A_w_uk, A_w_uv, A_w_o, B_x, B_w_gate, B_w_up, B_w_down):
    def _A_ref(x, c_kv, w_q, w_uk, w_uv, w_o):
        B, Sq, M = x.shape[0], x.shape[1], x.shape[2]
        Sk = c_kv.shape[1]
        H, D = w_q.shape[1], w_q.shape[2]
        q = torch.einsum("bqm,mhd->bhqd", x, w_q)
        k = torch.einsum("bkc,chd->bhkd", c_kv, w_uk)
        v = torch.einsum("bkc,chd->bhkd", c_kv, w_uv)
        scores = torch.einsum("bhqd,bhkd->bhqk", q, k) * (D ** -0.5)
        off = Sk - Sq
        qi = torch.arange(Sq)[:, None]
        kj = torch.arange(Sk)[None, :]
        cmask = kj <= (qi + off)
        scores = torch.where(cmask[None, None], scores, -1e9)
        p = _softmax(scores, axis=-1)
        ctx = torch.einsum("bhqk,bhkd->bhqd", p, v)
        return torch.einsum("bhqd,hdm->bqm", ctx, w_o)

    def _B_ref(x, w_gate, w_up, w_down):
        return (_gelu(x @ w_gate) * (x @ w_up)) @ w_down

    x = A_x
    xn = _layernorm(x, axis=-1)
    s = _A_ref(xn, A_c_kv, A_w_q, A_w_uk, A_w_uv, A_w_o)
    g = _silu(_B_ref(xn, B_w_gate, B_w_up, B_w_down))
    return x + s * g
```

```asm
; @launch grid=(256,1,1) block=(512,1,1) lds=163840
.amdgcn_target "amdgcn-amd-amdhsa--gfx950"
.text
.globl recurrent_scan__compressed_kv_cla__geglu_ffn__prompt_kernel
.p2align 8
.type recurrent_scan__compressed_kv_cla__geglu_ffn__prompt_kernel,@function
recurrent_scan__compressed_kv_cla__geglu_ffn__prompt_kernel:
    s_cmp_ge_u32 s2, 256
    s_cbranch_scc1 LF_end
    s_load_dwordx4 s[28:31], s[0:1], 0
    s_load_dwordx4 s[32:35], s[0:1], 24
    s_load_dwordx4 s[36:39], s[0:1], 88
    s_load_dwordx4 s[64:67], s[0:1], 56
    s_load_dwordx2 s[68:69], s[0:1], 16
    s_load_dwordx2 s[56:57], s[0:1], 40
    s_load_dwordx2 s[58:59], s[0:1], 72
    v_lshrrev_b32 v9, 6, v0
    v_and_b32 v10, 63, v0
    v_readfirstlane_b32 s20, v9
    s_and_b32 s22, s2, 7
    s_lshr_b32 s23, s2, 3
    s_and_b32 s48, s23, 1
    s_bfe_u32 s49, s23, 0x10001
    s_lshr_b32 s50, s23, 2
    s_lshl_b32 s51, s22, 9
    s_lshl_b32 s3, s48, 8
    s_add_u32 s51, s51, s3
    v_lshlrev_b32 v1, 4, v10
    v_lshrrev_b32 v11, 3, v10
    v_and_b32 v12, 7, v10
    v_lshrrev_b32 v13, 4, v10
    v_xor_b32 v14, v12, v13
    v_lshlrev_b32 v14, 4, v14
    v_lshl_add_u32 v2, v11, 10, v14
    v_xor_b32 v3, 64, v2
    v_and_b32 v13, 1, v13
    v_lshlrev_b32 v13, 2, v13
    v_xor_b32 v14, v12, v13
    v_lshlrev_b32 v14, 4, v14
    v_lshl_add_u32 v4, v11, 13, v14
    v_and_b32 v11, 31, v10
    v_lshrrev_b32 v12, 5, v10
    v_bfe_u32 v13, v11, 1, 3
    v_xor_b32 v13, v12, v13
    v_lshlrev_b32 v13, 4, v13
    v_lshl_add_u32 v13, v11, 7, v13
    s_lshl_b32 s52, s20, 13
    s_add_u32 s52, s52, 65536
    v_add_u32 v16, s52, v13
    v_xor_b32 v17, 32, v16
    v_xor_b32 v18, 64, v16
    v_xor_b32 v19, 96, v16
    v_bfe_u32 v11, v10, 2, 2
    v_lshl_add_u32 v13, v12, 3, v11
    v_lshlrev_b32 v13, 7, v13
    v_lshrrev_b32 v11, 1, v11
    v_lshl_add_u32 v13, v11, 6, v13
    v_bfe_u32 v11, v10, 4, 1
    v_lshl_add_u32 v13, v11, 5, v13
    v_and_b32 v11, 3, v10
    v_lshl_add_u32 v20, v11, 3, v13
    v_xor_b32 v21, 64, v20
    v_add_u32 v22, 0x8000, v20
    v_add_u32 v23, 0x8000, v21
    v_add_u32 v24, 0x20000, v20
    v_add_u32 v25, 0x20000, v21
    v_add_u32 v26, 0x10000, v20
    v_add_u32 v27, 0x10000, v21
    v_lshlrev_b32 v14, 7, v10
    v_lshrrev_b32 v15, 2, v10
    v_lshlrev_b32 v15, 13, v15
    v_and_b32 v11, 3, v10
    v_lshl_add_u32 v15, v11, 7, v15
    v_lshrrev_b32 v5, 1, v10
    v_lshlrev_b32 v5, 10, v5
    v_and_b32 v11, 1, v10
    v_lshl_add_u32 v5, v11, 9, v5
    s_waitcnt lgkmcnt(0)
    s_mov_b32 s12, s30
    s_and_b32 s13, s31, 0xffff
    s_mov_b32 s14, 0x200000
    s_mov_b32 s15, 0x00020000
    s_mov_b32 s16, s28
    s_and_b32 s17, s29, 0xffff
    s_mov_b32 s18, 0x200000
    s_mov_b32 s19, 0x00020000
    s_mov_b32 s8, s38
    s_and_b32 s9, s39, 0xffff
    s_mov_b32 s10, 0x10000000
    s_mov_b32 s11, 0x00020000
    s_mov_b32 s96, s36
    s_and_b32 s97, s37, 0xffff
    s_mov_b32 s98, 0x100
    s_mov_b32 s99, 0x00020000
    s_cmp_eq_u32 s49, 0
    s_cselect_b32 s4, s32, s34
    s_cselect_b32 s5, s33, s35
    s_and_b32 s5, s5, 0xffff
    s_mov_b32 s6, 0x400000
    s_mov_b32 s7, 0x00020000
    s_lshl_b32 s40, s50, 8
    s_lshl_b32 s41, s20, 5
    s_add_u32 s40, s40, s41
    s_lshl_b32 s40, s40, 10
    s_lshl_b32 s42, s20, 18
    s_lshl_b32 s43, s51, 1
    s_add_u32 s42, s42, s43
    s_lshl_b32 s43, s20, 12
    s_add_u32 m0, s52, 0
    s_add_u32 s54, s40, 0
    buffer_load_dwordx4 v2, s[12:15], s54 offen lds
    s_add_u32 m0, s52, 1024
    s_add_u32 s54, s40, 8192
    buffer_load_dwordx4 v3, s[12:15], s54 offen lds
    s_add_u32 m0, s52, 2048
    s_add_u32 s54, s40, 16384
    buffer_load_dwordx4 v2, s[12:15], s54 offen lds
    s_add_u32 m0, s52, 3072
    s_add_u32 s54, s40, 24576
    buffer_load_dwordx4 v3, s[12:15], s54 offen lds
    s_add_u32 m0, s43, 0
    s_add_u32 s53, s42, 0
    buffer_load_dwordx4 v4, s[4:7], s53 offen lds
    s_add_u32 m0, s43, 1024
    s_add_u32 s53, s42, 65536
    buffer_load_dwordx4 v4, s[4:7], s53 offen lds
    s_add_u32 m0, s43, 2048
    s_add_u32 s53, s42, 131072
    buffer_load_dwordx4 v4, s[4:7], s53 offen lds
    s_add_u32 m0, s43, 3072
    s_add_u32 s53, s42, 196608
    buffer_load_dwordx4 v4, s[4:7], s53 offen lds
    s_add_u32 m0, s52, 4096
    s_add_u32 s54, s40, 128
    buffer_load_dwordx4 v2, s[12:15], s54 offen lds
    s_add_u32 m0, s52, 5120
    s_add_u32 s54, s40, 8320
    buffer_load_dwordx4 v3, s[12:15], s54 offen lds
    s_add_u32 m0, s52, 6144
    s_add_u32 s54, s40, 16512
    buffer_load_dwordx4 v2, s[12:15], s54 offen lds
    s_add_u32 m0, s52, 7168
    s_add_u32 s54, s40, 24704
    buffer_load_dwordx4 v3, s[12:15], s54 offen lds
    s_lshl_b32 s29, s2, 3
    s_add_u32 s29, s29, s20
    s_lshl_b32 s30, s29, 10
    buffer_load_dwordx4 v[96:99], v1, s[16:19], s30 offen
    s_add_u32 m0, s43, 32768
    s_add_u32 s53, s42, 2097152
    buffer_load_dwordx4 v4, s[4:7], s53 offen lds
    s_add_u32 m0, s43, 33792
    s_add_u32 s53, s42, 2162688
    buffer_load_dwordx4 v4, s[4:7], s53 offen lds
    s_add_u32 m0, s43, 34816
    s_add_u32 s53, s42, 2228224
    buffer_load_dwordx4 v4, s[4:7], s53 offen lds
    s_add_u32 m0, s43, 35840
    s_add_u32 s53, s42, 2293760
    buffer_load_dwordx4 v4, s[4:7], s53 offen lds
    s_add_u32 m0, s43, 131072
    s_add_u32 s53, s42, 128
    buffer_load_dwordx4 v4, s[4:7], s53 offen lds
    s_add_u32 m0, s43, 132096
    s_add_u32 s53, s42, 65664
    buffer_load_dwordx4 v4, s[4:7], s53 offen lds
    s_add_u32 m0, s43, 133120
    s_add_u32 s53, s42, 131200
    buffer_load_dwordx4 v4, s[4:7], s53 offen lds
    s_add_u32 m0, s43, 134144
    s_add_u32 s53, s42, 196736
    buffer_load_dwordx4 v4, s[4:7], s53 offen lds
    s_lshr_b32 s44, s51, 7
    s_lshl_b32 s44, s44, 19
    s_lshl_b32 s45, s50, 3
    s_add_u32 s45, s45, s20
    s_lshl_b32 s45, s45, 13
    s_add_u32 s44, s44, s45
    s_mov_b32 s45, 0x200000
    s_mov_b32 s46, 0x1200000
    s_cmp_eq_u32 s49, 0
    s_cselect_b32 s45, s45, s46
    s_add_u32 s41, s44, s45
    s_lshr_b32 s31, s29, 5
    s_lshl_b32 s31, s31, 15
    s_and_b32 s3, s29, 31
    s_lshl_b32 s3, s3, 4
    s_add_u32 s31, s31, s3
    s_lshr_b32 s32, s2, 4
    s_lshl_b32 s32, s32, 2
    s_lshr_b32 s33, s51, 8
    s_add_u32 s33, s33, 16
    s_lshl_b32 s33, s33, 2
    s_getreg_b32 s3, hwreg(HW_REG_XCC_ID, 0, 4)
    s_mul_i32 s53, s3, s3
    s_lshl_b32 s53, s53, 15
    s_lshl_b32 s3, s3, 6
    s_add_u32 s53, s53, s3
    s_add_u32 s53, s53, 1
    s_add_u32 s101, s22, 48
    s_lshl_b32 s101, s101, 2
    s_cmp_lg_u32 s20, 0
    s_cbranch_scc1 LF_noreg
    v_mov_b32 v8, s53
    v_mov_b32 v9, 0
    s_mov_b64 exec, 1
    buffer_atomic_add v8, v9, s[96:99], s101 offen sc1
    s_mov_b64 exec, -1
LF_noreg:
    s_and_b32 s3, s23, 3
    s_lshl_b32 s21, s22, 2
    s_add_u32 s21, s21, s3
    s_lshr_b32 s24, s23, 2
    s_lshr_b32 s25, s20, 2
    s_and_b32 s26, s20, 3
    s_sub_u32 s28, 15, s24
    s_lshl_b32 s28, s28, 2
    s_add_u32 s28, s28, s26
    s_lshl_b32 s27, s24, 2
    s_add_u32 s27, s27, s26
    s_cmp_eq_u32 s25, 0
    s_cselect_b32 s27, s28, s27
    s_cmp_eq_u32 s25, 0
    s_cbranch_scc1 LF_noprio1
    s_setprio 1
LF_noprio1:
    s_waitcnt vmcnt(17)
    ds_read_b128 v[128:131], v16 offset:0
    ds_read_b128 v[132:135], v17 offset:0
    ds_read_b128 v[136:139], v18 offset:0
    ds_read_b128 v[140:143], v19 offset:0
    s_waitcnt lgkmcnt(0)
    s_add_u32 m0, s52, 0
    s_add_u32 s54, s40, 256
    buffer_load_dwordx4 v2, s[12:15], s54 offen lds
    s_add_u32 m0, s52, 1024
    s_add_u32 s54, s40, 8448
    buffer_load_dwordx4 v3, s[12:15], s54 offen lds
    s_add_u32 m0, s52, 2048
    s_add_u32 s54, s40, 16640
    buffer_load_dwordx4 v2, s[12:15], s54 offen lds
    s_add_u32 m0, s52, 3072
    s_add_u32 s54, s40, 24832
    buffer_load_dwordx4 v3, s[12:15], s54 offen lds
    s_waitcnt vmcnt(17)
    s_barrier
    s_cmp_lg_u32 s49, 0
    s_cbranch_scc1 LF_v
    ds_read_b64_tr_b16 v[32:33], v20 offset:0
    ds_read_b64_tr_b16 v[34:35], v20 offset:512
    ds_read_b64_tr_b16 v[36:37], v21 offset:0
    ds_read_b64_tr_b16 v[38:39], v21 offset:512
    ds_read_b64_tr_b16 v[40:41], v20 offset:2048
    ds_read_b64_tr_b16 v[42:43], v20 offset:2560
    ds_read_b64_tr_b16 v[44:45], v21 offset:2048
    ds_read_b64_tr_b16 v[46:47], v21 offset:2560
    ds_read_b64_tr_b16 v[48:49], v20 offset:4096
    ds_read_b64_tr_b16 v[50:51], v20 offset:4608
    ds_read_b64_tr_b16 v[52:53], v21 offset:4096
    ds_read_b64_tr_b16 v[54:55], v21 offset:4608
    s_waitcnt lgkmcnt(10)
    v_mfma_f32_32x32x16_bf16 v[64:79], v[32:35], v[128:131], 0
    ds_read_b64_tr_b16 v[56:57], v20 offset:6144
    ds_read_b64_tr_b16 v[58:59], v20 offset:6656
    s_waitcnt lgkmcnt(10)
    v_mfma_f32_32x32x16_bf16 v[80:95], v[36:39], v[128:131], 0
    ds_read_b64_tr_b16 v[60:61], v21 offset:6144
    ds_read_b64_tr_b16 v[62:63], v21 offset:6656
    s_waitcnt vmcnt(13)
    ds_read_b128 v[144:147], v16 offset:4096
    ds_read_b128 v[148:151], v17 offset:4096
    s_waitcnt lgkmcnt(12)
    v_mfma_f32_32x32x16_bf16 v[64:79], v[40:43], v[132:135], v[64:79]
    ds_read_b64_tr_b16 v[32:33], v20 offset:8192
    ds_read_b64_tr_b16 v[34:35], v20 offset:8704
    ds_read_b128 v[152:155], v18 offset:4096
    ds_read_b128 v[156:159], v19 offset:4096
    s_waitcnt lgkmcnt(14)
    v_mfma_f32_32x32x16_bf16 v[80:95], v[44:47], v[132:135], v[80:95]
    ds_read_b64_tr_b16 v[36:37], v21 offset:8192
    ds_read_b64_tr_b16 v[38:39], v21 offset:8704
    s_waitcnt lgkmcnt(14)
    v_mfma_f32_32x32x16_bf16 v[64:79], v[48:51], v[136:139], v[64:79]
    ds_read_b64_tr_b16 v[40:41], v20 offset:10240
    ds_read_b64_tr_b16 v[42:43], v20 offset:10752
    s_lshl_b32 s3, s50, 6
    s_lshl_b32 s54, s20, 4
    s_add_u32 s3, s3, s54
    s_lshl_b32 s3, s3, 13
    s_lshl_b32 s54, s51, 1
    s_add_u32 s3, s3, s54
    s_cmp_ge_u32 s20, 4
    s_cselect_b32 s3, 0x7f000000, s3
    buffer_load_dword v127, v15, s[4:7], s3 offen
    s_waitcnt lgkmcnt(14)
    v_mfma_f32_32x32x16_bf16 v[80:95], v[52:55], v[136:139], v[80:95]
    ds_read_b64_tr_b16 v[44:45], v21 offset:10240
    ds_read_b64_tr_b16 v[46:47], v21 offset:10752
    s_waitcnt lgkmcnt(6)
    s_add_u32 m0, s52, 4096
    s_add_u32 s54, s40, 384
    buffer_load_dwordx4 v2, s[12:15], s54 offen lds
    s_add_u32 m0, s52, 5120
    s_add_u32 s54, s40, 8576
    buffer_load_dwordx4 v3, s[12:15], s54 offen lds
    v_mfma_f32_32x32x16_bf16 v[64:79], v[56:59], v[140:143], v[64:79]
    ds_read_b64_tr_b16 v[48:49], v20 offset:12288
    ds_read_b64_tr_b16 v[50:51], v20 offset:12800
    s_add_u32 m0, s52, 6144
    s_add_u32 s54, s40, 16768
    buffer_load_dwordx4 v2, s[12:15], s54 offen lds
    s_add_u32 m0, s52, 7168
    s_add_u32 s54, s40, 24960
    buffer_load_dwordx4 v3, s[12:15], s54 offen lds
    v_mfma_f32_32x32x16_bf16 v[80:95], v[60:63], v[140:143], v[80:95]
    ds_read_b64_tr_b16 v[52:53], v21 offset:12288
    ds_read_b64_tr_b16 v[54:55], v21 offset:12800
    v_mfma_f32_32x32x16_bf16 v[64:79], v[32:35], v[144:147], v[64:79]
    ds_read_b64_tr_b16 v[56:57], v20 offset:14336
    ds_read_b64_tr_b16 v[58:59], v20 offset:14848
    s_waitcnt lgkmcnt(10)
    v_mfma_f32_32x32x16_bf16 v[80:95], v[36:39], v[144:147], v[80:95]
    ds_read_b64_tr_b16 v[60:61], v21 offset:14336
    ds_read_b64_tr_b16 v[62:63], v21 offset:14848
    s_waitcnt vmcnt(5)
    ds_read_b128 v[160:163], v16 offset:0
    ds_read_b128 v[164:167], v17 offset:0
    s_waitcnt lgkmcnt(12)
    v_mfma_f32_32x32x16_bf16 v[64:79], v[40:43], v[148:151], v[64:79]
    ds_read_b64_tr_b16 v[32:33], v20 offset:16384
    ds_read_b64_tr_b16 v[34:35], v20 offset:16896
    ds_read_b128 v[168:171], v18 offset:0
    ds_read_b128 v[172:175], v19 offset:0
    s_waitcnt lgkmcnt(14)
    v_mfma_f32_32x32x16_bf16 v[80:95], v[44:47], v[148:151], v[80:95]
    ds_read_b64_tr_b16 v[36:37], v21 offset:16384
    ds_read_b64_tr_b16 v[38:39], v21 offset:16896
    s_waitcnt lgkmcnt(14)
    v_mfma_f32_32x32x16_bf16 v[64:79], v[48:51], v[152:155], v[64:79]
    ds_read_b64_tr_b16 v[40:41], v20 offset:18432
    ds_read_b64_tr_b16 v[42:43], v20 offset:18944
    s_waitcnt lgkmcnt(14)
    v_mfma_f32_32x32x16_bf16 v[80:95], v[52:55], v[152:155], v[80:95]
    ds_read_b64_tr_b16 v[44:45], v21 offset:18432
    ds_read_b64_tr_b16 v[46:47], v21 offset:18944
    s_waitcnt lgkmcnt(6)
    s_add_u32 m0, s52, 0
    s_add_u32 s54, s40, 512
    buffer_load_dwordx4 v2, s[12:15], s54 offen lds
    s_add_u32 m0, s52, 1024
    s_add_u32 s54, s40, 8704
    buffer_load_dwordx4 v3, s[12:15], s54 offen lds
    v_mfma_f32_32x32x16_bf16 v[64:79], v[56:59], v[156:159], v[64:79]
    ds_read_b64_tr_b16 v[48:49], v20 offset:20480
    ds_read_b64_tr_b16 v[50:51], v20 offset:20992
    s_add_u32 m0, s52, 2048
    s_add_u32 s54, s40, 16896
    buffer_load_dwordx4 v2, s[12:15], s54 offen lds
    s_add_u32 m0, s52, 3072
    s_add_u32 s54, s40, 25088
    buffer_load_dwordx4 v3, s[12:15], s54 offen lds
    v_mfma_f32_32x32x16_bf16 v[80:95], v[60:63], v[156:159], v[80:95]
    ds_read_b64_tr_b16 v[52:53], v21 offset:20480
    ds_read_b64_tr_b16 v[54:55], v21 offset:20992
    v_mfma_f32_32x32x16_bf16 v[64:79], v[32:35], v[160:163], v[64:79]
    ds_read_b64_tr_b16 v[56:57], v20 offset:22528
    ds_read_b64_tr_b16 v[58:59], v20 offset:23040
    s_waitcnt lgkmcnt(10)
    v_mfma_f32_32x32x16_bf16 v[80:95], v[36:39], v[160:163], v[80:95]
    ds_read_b64_tr_b16 v[60:61], v21 offset:22528
    ds_read_b64_tr_b16 v[62:63], v21 offset:23040
    s_waitcnt vmcnt(4)
    ds_read_b128 v[176:179], v16 offset:4096
    ds_read_b128 v[180:183], v17 offset:4096
    s_waitcnt lgkmcnt(12)
    v_mfma_f32_32x32x16_bf16 v[64:79], v[40:43], v[164:167], v[64:79]
    ds_read_b64_tr_b16 v[32:33], v20 offset:24576
    ds_read_b64_tr_b16 v[34:35], v20 offset:25088
    ds_read_b128 v[184:187], v18 offset:4096
    ds_read_b128 v[188:191], v19 offset:4096
    s_waitcnt lgkmcnt(14)
    v_mfma_f32_32x32x16_bf16 v[80:95], v[44:47], v[164:167], v[80:95]
    ds_read_b64_tr_b16 v[36:37], v21 offset:24576
    ds_read_b64_tr_b16 v[38:39], v21 offset:25088
    s_waitcnt lgkmcnt(14)
    v_mfma_f32_32x32x16_bf16 v[64:79], v[48:51], v[168:171], v[64:79]
    ds_read_b64_tr_b16 v[40:41], v20 offset:26624
    ds_read_b64_tr_b16 v[42:43], v20 offset:27136
    s_waitcnt lgkmcnt(14)
    v_mfma_f32_32x32x16_bf16 v[80:95], v[52:55], v[168:171], v[80:95]
    ds_read_b64_tr_b16 v[44:45], v21 offset:26624
    ds_read_b64_tr_b16 v[46:47], v21 offset:27136
    s_waitcnt lgkmcnt(6)
    s_add_u32 m0, s52, 4096
    s_add_u32 s54, s40, 640
    buffer_load_dwordx4 v2, s[12:15], s54 offen lds
    s_add_u32 m0, s52, 5120
    s_add_u32 s54, s40, 8832
    buffer_load_dwordx4 v3, s[12:15], s54 offen lds
    v_mfma_f32_32x32x16_bf16 v[64:79], v[56:59], v[172:175], v[64:79]
    ds_read_b64_tr_b16 v[48:49], v20 offset:28672
    ds_read_b64_tr_b16 v[50:51], v20 offset:29184
    s_add_u32 m0, s52, 6144
    s_add_u32 s54, s40, 17024
    buffer_load_dwordx4 v2, s[12:15], s54 offen lds
    s_add_u32 m0, s52, 7168
    s_add_u32 s54, s40, 25216
    buffer_load_dwordx4 v3, s[12:15], s54 offen lds
    v_mfma_f32_32x32x16_bf16 v[80:95], v[60:63], v[172:175], v[80:95]
    ds_read_b64_tr_b16 v[52:53], v21 offset:28672
    ds_read_b64_tr_b16 v[54:55], v21 offset:29184
    v_mfma_f32_32x32x16_bf16 v[64:79], v[32:35], v[176:179], v[64:79]
    ds_read_b64_tr_b16 v[56:57], v20 offset:30720
    ds_read_b64_tr_b16 v[58:59], v20 offset:31232
    s_waitcnt lgkmcnt(10)
    v_mfma_f32_32x32x16_bf16 v[80:95], v[36:39], v[176:179], v[80:95]
    ds_read_b64_tr_b16 v[60:61], v21 offset:30720
    ds_read_b64_tr_b16 v[62:63], v21 offset:31232
    s_waitcnt vmcnt(4)
    ds_read_b128 v[192:195], v16 offset:0
    ds_read_b128 v[196:199], v17 offset:0
    s_waitcnt lgkmcnt(12)
    v_mfma_f32_32x32x16_bf16 v[64:79], v[40:43], v[180:183], v[64:79]
    ds_read_b128 v[200:203], v18 offset:0
    ds_read_b128 v[204:207], v19 offset:0
    s_waitcnt lgkmcnt(12)
    v_mfma_f32_32x32x16_bf16 v[80:95], v[44:47], v[180:183], v[80:95]
    s_waitcnt lgkmcnt(0)
    s_barrier
    ds_read_b64_tr_b16 v[32:33], v22 offset:0
    ds_read_b64_tr_b16 v[34:35], v22 offset:512
    v_mfma_f32_32x32x16_bf16 v[64:79], v[48:51], v[184:187], v[64:79]
    ds_read_b64_tr_b16 v[36:37], v23 offset:0
    ds_read_b64_tr_b16 v[38:39], v23 offset:512
    v_mfma_f32_32x32x16_bf16 v[80:95], v[52:55], v[184:187], v[80:95]
    s_add_u32 m0, s52, 0
    s_add_u32 s54, s40, 768
    buffer_load_dwordx4 v2, s[12:15], s54 offen lds
    s_add_u32 m0, s52, 1024
    s_add_u32 s54, s40, 8960
    buffer_load_dwordx4 v3, s[12:15], s54 offen lds
    ds_read_b64_tr_b16 v[40:41], v22 offset:2048
    ds_read_b64_tr_b16 v[42:43], v22 offset:2560
    v_mfma_f32_32x32x16_bf16 v[64:79], v[56:59], v[188:191], v[64:79]
    s_add_u32 m0, s52, 2048
    s_add_u32 s54, s40, 17152
    buffer_load_dwordx4 v2, s[12:15], s54 offen lds
    s_add_u32 m0, s52, 3072
    s_add_u32 s54, s40, 25344
    buffer_load_dwordx4 v3, s[12:15], s54 offen lds
    ds_read_b64_tr_b16 v[44:45], v23 offset:2048
    ds_read_b64_tr_b16 v[46:47], v23 offset:2560
    v_mfma_f32_32x32x16_bf16 v[80:95], v[60:63], v[188:191], v[80:95]
    ds_read_b64_tr_b16 v[48:49], v22 offset:4096
    ds_read_b64_tr_b16 v[50:51], v22 offset:4608
    ds_read_b64_tr_b16 v[52:53], v23 offset:4096
    ds_read_b64_tr_b16 v[54:55], v23 offset:4608
    s_waitcnt lgkmcnt(10)
    v_mfma_f32_32x32x16_bf16 v[64:79], v[32:35], v[192:195], v[64:79]
    ds_read_b64_tr_b16 v[56:57], v22 offset:6144
    ds_read_b64_tr_b16 v[58:59], v22 offset:6656
    s_waitcnt lgkmcnt(10)
    v_mfma_f32_32x32x16_bf16 v[80:95], v[36:39], v[192:195], v[80:95]
    ds_read_b64_tr_b16 v[60:61], v23 offset:6144
    ds_read_b64_tr_b16 v[62:63], v23 offset:6656
    s_waitcnt vmcnt(4)
    ds_read_b128 v[208:211], v16 offset:4096
    ds_read_b128 v[212:215], v17 offset:4096
    v_lshlrev_b32 v100, 16, v96
    v_and_b32 v101, 0xffff0000, v96
    v_lshlrev_b32 v102, 16, v97
    v_and_b32 v103, 0xffff0000, v97
    v_lshlrev_b32 v104, 16, v98
    v_and_b32 v105, 0xffff0000, v98
    s_waitcnt lgkmcnt(12)
    v_mfma_f32_32x32x16_bf16 v[64:79], v[40:43], v[196:199], v[64:79]
    ds_read_b64_tr_b16 v[32:33], v22 offset:8192
    ds_read_b64_tr_b16 v[34:35], v22 offset:8704
    ds_read_b128 v[216:219], v18 offset:4096
    ds_read_b128 v[220:223], v19 offset:4096
    v_lshlrev_b32 v106, 16, v99
    v_and_b32 v107, 0xffff0000, v99
    v_add_f32 v116, v100, v101
    s_waitcnt lgkmcnt(14)
    v_mfma_f32_32x32x16_bf16 v[80:95], v[44:47], v[196:199], v[80:95]
    ds_read_b64_tr_b16 v[36:37], v23 offset:8192
    ds_read_b64_tr_b16 v[38:39], v23 offset:8704
    v_add_f32 v116, v116, v102
    v_add_f32 v116, v116, v103
    v_add_f32 v116, v116, v104
    s_waitcnt lgkmcnt(14)
    v_mfma_f32_32x32x16_bf16 v[64:79], v[48:51], v[200:203], v[64:79]
    ds_read_b64_tr_b16 v[40:41], v22 offset:10240
    ds_read_b64_tr_b16 v[42:43], v22 offset:10752
    v_add_f32 v116, v116, v105
    v_add_f32 v116, v116, v106
    v_add_f32 v116, v116, v107
    s_nop 1
    v_add_f32_dpp v116, v116, v116 quad_perm:[1,0,3,2] row_mask:0xf bank_mask:0xf
    s_nop 1
    v_add_f32_dpp v116, v116, v116 quad_perm:[2,3,0,1] row_mask:0xf bank_mask:0xf
    s_nop 1
    v_add_f32_dpp v116, v116, v116 row_half_mirror row_mask:0xf bank_mask:0xf
    s_waitcnt lgkmcnt(14)
    v_mfma_f32_32x32x16_bf16 v[80:95], v[52:55], v[200:203], v[80:95]
    ds_read_b64_tr_b16 v[44:45], v23 offset:10240
    ds_read_b64_tr_b16 v[46:47], v23 offset:10752
    s_waitcnt lgkmcnt(6)
    s_add_u32 m0, s52, 4096
    s_add_u32 s54, s40, 896
    buffer_load_dwordx4 v2, s[12:15], s54 offen lds
    s_add_u32 m0, s52, 5120
    s_add_u32 s54, s40, 9088
    buffer_load_dwordx4 v3, s[12:15], s54 offen lds
    v_add_f32_dpp v116, v116, v116 row_mirror row_mask:0xf bank_mask:0xf
    v_mov_b32 v117, v116
    s_nop 1
    v_permlane16_swap_b32 v116, v117
    v_mfma_f32_32x32x16_bf16 v[64:79], v[56:59], v[204:207], v[64:79]
    ds_read_b64_tr_b16 v[48:49], v22 offset:12288
    ds_read_b64_tr_b16 v[50:51], v22 offset:12800
    s_add_u32 m0, s52, 6144
    s_add_u32 s54, s40, 17280
    buffer_load_dwordx4 v2, s[12:15], s54 offen lds
    s_add_u32 m0, s52, 7168
    s_add_u32 s54, s40, 25472
    buffer_load_dwordx4 v3, s[12:15], s54 offen lds
    v_add_f32 v116, v116, v117
    v_mov_b32 v117, v116
    s_nop 1
    v_permlane32_swap_b32 v116, v117
    v_mfma_f32_32x32x16_bf16 v[80:95], v[60:63], v[204:207], v[80:95]
    ds_read_b64_tr_b16 v[52:53], v23 offset:12288
    ds_read_b64_tr_b16 v[54:55], v23 offset:12800
    v_add_f32 v116, v116, v117
    v_mul_f32 v116, 0x3b000000, v116
    v_sub_f32 v108, v100, v116
    v_sub_f32 v109, v101, v116
    v_sub_f32 v110, v102, v116
    v_sub_f32 v111, v103, v116
    v_mfma_f32_32x32x16_bf16 v[64:79], v[32:35], v[208:211], v[64:79]
    ds_read_b64_tr_b16 v[56:57], v22 offset:14336
    ds_read_b64_tr_b16 v[58:59], v22 offset:14848
    v_sub_f32 v112, v104, v116
    v_sub_f32 v113, v105, v116
    v_sub_f32 v114, v106, v116
    s_waitcnt lgkmcnt(10)
    v_mfma_f32_32x32x16_bf16 v[80:95], v[36:39], v[208:211], v[80:95]
    ds_read_b64_tr_b16 v[60:61], v23 offset:14336
    ds_read_b64_tr_b16 v[62:63], v23 offset:14848
    s_waitcnt vmcnt(4)
    ds_read_b128 v[224:227], v16 offset:0
    ds_read_b128 v[228:231], v17 offset:0
    v_sub_f32 v115, v107, v116
    v_mul_f32 v118, v108, v108
    v_fmac_f32 v118, v109, v109
    s_waitcnt lgkmcnt(12)
    v_mfma_f32_32x32x16_bf16 v[64:79], v[40:43], v[212:215], v[64:79]
    ds_read_b64_tr_b16 v[32:33], v22 offset:16384
    ds_read_b64_tr_b16 v[34:35], v22 offset:16896
    ds_read_b128 v[232:235], v18 offset:0
    ds_read_b128 v[236:239], v19 offset:0
    v_fmac_f32 v118, v110, v110
    v_fmac_f32 v118, v111, v111
    v_fmac_f32 v118, v112, v112
    v_fmac_f32 v118, v113, v113
    v_fmac_f32 v118, v114, v114
    v_fmac_f32 v118, v115, v115
    s_waitcnt lgkmcnt(14)
    v_mfma_f32_32x32x16_bf16 v[80:95], v[44:47], v[212:215], v[80:95]
    ds_read_b64_tr_b16 v[36:37], v23 offset:16384
    ds_read_b64_tr_b16 v[38:39], v23 offset:16896
    v_add_f32_dpp v118, v118, v118 quad_perm:[1,0,3,2] row_mask:0xf bank_mask:0xf
    s_nop 1
    v_add_f32_dpp v118, v118, v118 quad_perm:[2,3,0,1] row_mask:0xf bank_mask:0xf
    s_nop 1
    v_add_f32_dpp v118, v118, v118 row_half_mirror row_mask:0xf bank_mask:0xf
    s_waitcnt lgkmcnt(14)
    v_mfma_f32_32x32x16_bf16 v[64:79], v[48:51], v[216:219], v[64:79]
    ds_read_b64_tr_b16 v[40:41], v22 offset:18432
    ds_read_b64_tr_b16 v[42:43], v22 offset:18944
    v_add_f32_dpp v118, v118, v118 row_mirror row_mask:0xf bank_mask:0xf
    v_mov_b32 v117, v118
    s_nop 1
    v_permlane16_swap_b32 v118, v117
    s_waitcnt lgkmcnt(14)
    v_mfma_f32_32x32x16_bf16 v[80:95], v[52:55], v[216:219], v[80:95]
    ds_read_b64_tr_b16 v[44:45], v23 offset:18432
    ds_read_b64_tr_b16 v[46:47], v23 offset:18944
    v_add_f32 v118, v118, v117
    v_mov_b32 v117, v118
    s_nop 1
    v_permlane32_swap_b32 v118, v117
    v_add_f32 v118, v118, v117
    v_mul_f32 v118, 0x3b000000, v118
    v_cvt_pk_bf16_f32 v119, v116, v118
    s_waitcnt lgkmcnt(14)
    v_mfma_f32_32x32x16_bf16 v[64:79], v[56:59], v[220:223], v[64:79]
    ds_read_b64_tr_b16 v[48:49], v22 offset:20480
    ds_read_b64_tr_b16 v[50:51], v22 offset:20992
    v_lshlrev_b32 v116, 16, v119
    v_and_b32 v118, 0xffff0000, v119
    v_add_f32 v118, 0x3727c5ac, v118
    s_waitcnt lgkmcnt(14)
    v_mfma_f32_32x32x16_bf16 v[80:95], v[60:63], v[220:223], v[80:95]
    ds_read_b64_tr_b16 v[52:53], v23 offset:20480
    ds_read_b64_tr_b16 v[54:55], v23 offset:20992
    v_cvt_pk_bf16_f32 v119, v118, v118
    v_lshlrev_b32 v118, 16, v119
    v_sqrt_f32 v118, v118
    s_waitcnt lgkmcnt(12)
    v_mfma_f32_32x32x16_bf16 v[64:79], v[32:35], v[224:227], v[64:79]
    ds_read_b64_tr_b16 v[56:57], v22 offset:22528
    ds_read_b64_tr_b16 v[58:59], v22 offset:23040
    v_cvt_pk_bf16_f32 v119, v118, v118
    v_lshlrev_b32 v118, 16, v119
    v_rcp_f32 v120, v118
    s_nop 0
    v_fma_f32 v121, -v118, v120, 1.0
    v_fma_f32 v120, v121, v120, v120
    v_sub_f32 v108, v100, v116
    s_waitcnt lgkmcnt(10)
    v_mfma_f32_32x32x16_bf16 v[80:95], v[36:39], v[224:227], v[80:95]
    ds_read_b64_tr_b16 v[60:61], v23 offset:22528
    ds_read_b64_tr_b16 v[62:63], v23 offset:23040
    s_waitcnt vmcnt(0)
    ds_read_b128 v[240:243], v16 offset:4096
    ds_read_b128 v[244:247], v17 offset:4096
    v_sub_f32 v109, v101, v116
    v_sub_f32 v110, v102, v116
    v_sub_f32 v111, v103, v116
    s_waitcnt lgkmcnt(12)
    v_mfma_f32_32x32x16_bf16 v[64:79], v[40:43], v[228:231], v[64:79]
    ds_read_b64_tr_b16 v[32:33], v22 offset:24576
    ds_read_b64_tr_b16 v[34:35], v22 offset:25088
    ds_read_b128 v[248:251], v18 offset:4096
    ds_read_b128 v[252:255], v19 offset:4096
    v_sub_f32 v112, v104, v116
    v_sub_f32 v113, v105, v116
    v_sub_f32 v114, v106, v116
    s_waitcnt lgkmcnt(14)
    v_mfma_f32_32x32x16_bf16 v[80:95], v[44:47], v[228:231], v[80:95]
    ds_read_b64_tr_b16 v[36:37], v23 offset:24576
    ds_read_b64_tr_b16 v[38:39], v23 offset:25088
    v_sub_f32 v115, v107, v116
    v_cvt_pk_bf16_f32 v100, v108, v109
    v_cvt_pk_bf16_f32 v101, v110, v111
    v_cvt_pk_bf16_f32 v102, v112, v113
    v_cvt_pk_bf16_f32 v103, v114, v115
    v_lshlrev_b32 v108, 16, v100
    s_waitcnt lgkmcnt(14)
    v_mfma_f32_32x32x16_bf16 v[64:79], v[48:51], v[232:235], v[64:79]
    ds_read_b64_tr_b16 v[40:41], v22 offset:26624
    ds_read_b64_tr_b16 v[42:43], v22 offset:27136
    v_and_b32 v109, 0xffff0000, v100
    v_lshlrev_b32 v110, 16, v101
    v_and_b32 v111, 0xffff0000, v101
    s_waitcnt lgkmcnt(14)
    v_mfma_f32_32x32x16_bf16 v[80:95], v[52:55], v[232:235], v[80:95]
    ds_read_b64_tr_b16 v[44:45], v23 offset:26624
    ds_read_b64_tr_b16 v[46:47], v23 offset:27136
    v_lshlrev_b32 v112, 16, v102
    v_and_b32 v113, 0xffff0000, v102
    v_lshlrev_b32 v114, 16, v103
    s_waitcnt lgkmcnt(14)
    v_mfma_f32_32x32x16_bf16 v[64:79], v[56:59], v[236:239], v[64:79]
    ds_read_b64_tr_b16 v[48:49], v22 offset:28672
    ds_read_b64_tr_b16 v[50:51], v22 offset:29184
    v_and_b32 v115, 0xffff0000, v103
    v_mul_f32 v108, v108, v120
    v_mul_f32 v109, v109, v120
    v_mul_f32 v110, v110, v120
    v_mul_f32 v111, v111, v120
    v_mul_f32 v112, v112, v120
    s_waitcnt lgkmcnt(14)
    v_mfma_f32_32x32x16_bf16 v[80:95], v[60:63], v[236:239], v[80:95]
    ds_read_b64_tr_b16 v[52:53], v23 offset:28672
    ds_read_b64_tr_b16 v[54:55], v23 offset:29184
    v_mul_f32 v113, v113, v120
    v_mul_f32 v114, v114, v120
    v_mul_f32 v115, v115, v120
    s_waitcnt lgkmcnt(12)
    v_mfma_f32_32x32x16_bf16 v[64:79], v[32:35], v[240:243], v[64:79]
    ds_read_b64_tr_b16 v[56:57], v22 offset:30720
    ds_read_b64_tr_b16 v[58:59], v22 offset:31232
    v_cvt_pk_bf16_f32 v96, v108, v109
    v_cvt_pk_bf16_f32 v97, v110, v111
    v_cvt_pk_bf16_f32 v98, v112, v113
    s_waitcnt lgkmcnt(10)
    v_mfma_f32_32x32x16_bf16 v[80:95], v[36:39], v[240:243], v[80:95]
    ds_read_b64_tr_b16 v[60:61], v23 offset:30720
    ds_read_b64_tr_b16 v[62:63], v23 offset:31232
    v_cvt_pk_bf16_f32 v99, v114, v115
    buffer_store_dwordx4 v[96:99], v5, s[8:11], s31 offen sc1
    s_waitcnt lgkmcnt(10)
    v_mfma_f32_32x32x16_bf16 v[64:79], v[40:43], v[244:247], v[64:79]
    s_waitcnt lgkmcnt(8)
    v_mfma_f32_32x32x16_bf16 v[80:95], v[44:47], v[244:247], v[80:95]
    s_waitcnt lgkmcnt(0)
    s_barrier
    ds_read_b64_tr_b16 v[32:33], v24 offset:0
    ds_read_b64_tr_b16 v[34:35], v24 offset:512
    v_mfma_f32_32x32x16_bf16 v[64:79], v[48:51], v[248:251], v[64:79]
    ds_read_b64_tr_b16 v[36:37], v25 offset:0
    ds_read_b64_tr_b16 v[38:39], v25 offset:512
    v_mfma_f32_32x32x16_bf16 v[80:95], v[52:55], v[248:251], v[80:95]
    ds_read_b64_tr_b16 v[40:41], v24 offset:2048
    ds_read_b64_tr_b16 v[42:43], v24 offset:2560
    v_mfma_f32_32x32x16_bf16 v[64:79], v[56:59], v[252:255], v[64:79]
    ds_read_b64_tr_b16 v[44:45], v25 offset:2048
    ds_read_b64_tr_b16 v[46:47], v25 offset:2560
    v_mfma_f32_32x32x16_bf16 v[80:95], v[60:63], v[252:255], v[80:95]
    ds_read_b64_tr_b16 v[48:49], v24 offset:4096
    ds_read_b64_tr_b16 v[50:51], v24 offset:4608
    ds_read_b64_tr_b16 v[52:53], v25 offset:4096
    ds_read_b64_tr_b16 v[54:55], v25 offset:4608
    s_nop 4
    v_cvt_pk_bf16_f32 v96, v64, v65
    v_cvt_pk_bf16_f32 v97, v66, v67
    v_cvt_pk_bf16_f32 v98, v68, v69
    v_cvt_pk_bf16_f32 v99, v70, v71
    v_cvt_pk_bf16_f32 v100, v72, v73
    v_cvt_pk_bf16_f32 v101, v74, v75
    v_cvt_pk_bf16_f32 v102, v76, v77
    v_cvt_pk_bf16_f32 v103, v78, v79
    s_waitcnt lgkmcnt(10)
    v_mfma_f32_32x32x16_bf16 v[64:79], v[32:35], v[128:131], 0
    ds_read_b64_tr_b16 v[56:57], v24 offset:6144
    ds_read_b64_tr_b16 v[58:59], v24 offset:6656
    v_cvt_pk_bf16_f32 v104, v80, v81
    v_cvt_pk_bf16_f32 v105, v82, v83
    v_cvt_pk_bf16_f32 v106, v84, v85
    v_cvt_pk_bf16_f32 v107, v86, v87
    v_cvt_pk_bf16_f32 v108, v88, v89
    v_cvt_pk_bf16_f32 v109, v90, v91
    v_cvt_pk_bf16_f32 v110, v92, v93
    v_cvt_pk_bf16_f32 v111, v94, v95
    s_waitcnt lgkmcnt(10)
    v_mfma_f32_32x32x16_bf16 v[80:95], v[36:39], v[128:131], 0
    ds_read_b64_tr_b16 v[60:61], v25 offset:6144
    ds_read_b64_tr_b16 v[62:63], v25 offset:6656
    s_waitcnt lgkmcnt(10)
    v_mfma_f32_32x32x16_bf16 v[64:79], v[40:43], v[132:135], v[64:79]
    ds_read_b64_tr_b16 v[32:33], v24 offset:8192
    ds_read_b64_tr_b16 v[34:35], v24 offset:8704
    s_add_u32 m0, s43, 65536
    s_add_u32 s53, s42, 2097280
    buffer_load_dwordx4 v4, s[4:7], s53 offen lds
    s_waitcnt lgkmcnt(10)
    v_mfma_f32_32x32x16_bf16 v[80:95], v[44:47], v[132:135], v[80:95]
    ds_read_b64_tr_b16 v[36:37], v25 offset:8192
    ds_read_b64_tr_b16 v[38:39], v25 offset:8704
    s_waitcnt lgkmcnt(10)
    v_mfma_f32_32x32x16_bf16 v[64:79], v[48:51], v[136:139], v[64:79]
    ds_read_b64_tr_b16 v[40:41], v24 offset:10240
    ds_read_b64_tr_b16 v[42:43], v24 offset:10752
    s_waitcnt lgkmcnt(10)
    v_mfma_f32_32x32x16_bf16 v[80:95], v[52:55], v[136:139], v[80:95]
    ds_read_b64_tr_b16 v[44:45], v25 offset:10240
    ds_read_b64_tr_b16 v[46:47], v25 offset:10752
    s_add_u32 m0, s43, 66560
    s_add_u32 s53, s42, 2162816
    buffer_load_dwordx4 v4, s[4:7], s53 offen lds
    s_waitcnt lgkmcnt(10)
    v_mfma_f32_32x32x16_bf16 v[64:79], v[56:59], v[140:143], v[64:79]
    ds_read_b64_tr_b16 v[48:49], v24 offset:12288
    ds_read_b64_tr_b16 v[50:51], v24 offset:12800
    s_waitcnt lgkmcnt(10)
    v_mfma_f32_32x32x16_bf16 v[80:95], v[60:63], v[140:143], v[80:95]
    ds_read_b64_tr_b16 v[52:53], v25 offset:12288
    ds_read_b64_tr_b16 v[54:55], v25 offset:12800
    s_waitcnt lgkmcnt(10)
    v_mfma_f32_32x32x16_bf16 v[64:79], v[32:35], v[144:147], v[64:79]
    ds_read_b64_tr_b16 v[56:57], v24 offset:14336
    ds_read_b64_tr_b16 v[58:59], v24 offset:14848
    s_add_u32 m0, s43, 67584
    s_add_u32 s53, s42, 2228352
    buffer_load_dwordx4 v4, s[4:7], s53 offen lds
    s_waitcnt lgkmcnt(10)
    v_mfma_f32_32x32x16_bf16 v[80:95], v[36:39], v[144:147], v[80:95]
    ds_read_b64_tr_b16 v[60:61], v25 offset:14336
    ds_read_b64_tr_b16 v[62:63], v25 offset:14848
    s_waitcnt lgkmcnt(10)
    v_mfma_f32_32x32x16_bf16 v[64:79], v[40:43], v[148:151], v[64:79]
    ds_read_b64_tr_b16 v[32:33], v24 offset:16384
    ds_read_b64_tr_b16 v[34:35], v24 offset:16896
    v_and_b32 v10, 63, v0
    v_lshrrev_b32 v11, 4, v10
    v_bfe_u32 v12, v10, 2, 2
    v_and_b32 v13, 3, v11
    v_xor_b32 v12, v12, v13
    v_lshlrev_b32 v12, 6, v12
    v_and_b32 v13, 3, v10
    v_lshl_add_u32 v12, v13, 4, v12
    s_waitcnt lgkmcnt(10)
    v_mfma_f32_32x32x16_bf16 v[80:95], v[44:47], v[148:151], v[80:95]
    ds_read_b64_tr_b16 v[36:37], v25 offset:16384
    ds_read_b64_tr_b16 v[38:39], v25 offset:16896
    s_add_u32 m0, s43, 68608
    s_add_u32 s53, s42, 2293888
    buffer_load_dwordx4 v4, s[4:7], s53 offen lds
    v_lshl_add_u32 v12, v11, 13, v12
    s_lshl_b32 s29, s26, 17
    v_add_u32 v28, s29, v12
    v_add_u32 v29, 0x8000, v28
    v_add_u32 v30, 0x10000, v28
    v_add_u32 v31, 0x18000, v28
    s_and_b32 s29, s20, 1
    s_mul_i32 s29, s29, 192
    s_waitcnt lgkmcnt(10)
    v_mfma_f32_32x32x16_bf16 v[64:79], v[48:51], v[152:155], v[64:79]
    ds_read_b64_tr_b16 v[40:41], v24 offset:18432
    ds_read_b64_tr_b16 v[42:43], v24 offset:18944
    s_mov_b32 s30, 43691
    s_movk_i32 s34, 2752
    s_cmp_eq_u32 s25, 0
    s_cselect_b64 s[36:37], -1, 0
    s_add_u32 s55, s41, 0
    buffer_store_dwordx4 v[96:99], v1, s[8:11], s55 offen
    s_waitcnt lgkmcnt(10)
    v_mfma_f32_32x32x16_bf16 v[80:95], v[52:55], v[152:155], v[80:95]
    ds_read_b64_tr_b16 v[44:45], v25 offset:18432
    ds_read_b64_tr_b16 v[46:47], v25 offset:18944
    v_add_u32 v11, s29, v10
    v_add_u32 v11, 0, v11
    v_mul_lo_u32 v12, v11, s30
    v_lshrrev_b32 v12, 18, v12
    v_mul_u32_u24 v13, 6, v12
    v_sub_u32 v13, v11, v13
    v_mul_lo_u32 v12, v12, s34
    v_lshl_add_u32 v9, v13, 4, v12
    s_waitcnt lgkmcnt(10)
    v_mfma_f32_32x32x16_bf16 v[64:79], v[56:59], v[156:159], v[64:79]
    ds_read_b64_tr_b16 v[48:49], v24 offset:20480
    ds_read_b64_tr_b16 v[50:51], v24 offset:20992
    s_add_u32 m0, s43, 0
    s_add_u32 s53, s42, 256
    buffer_load_dwordx4 v4, s[4:7], s53 offen lds
    v_cndmask_b32 v28, v9, v28, s[36:37]
    v_add_u32 v11, s29, v10
    v_add_u32 v11, 64, v11
    v_mul_lo_u32 v12, v11, s30
    v_lshrrev_b32 v12, 18, v12
    v_mul_u32_u24 v13, 6, v12
    v_sub_u32 v13, v11, v13
    v_mul_lo_u32 v12, v12, s34
    s_waitcnt lgkmcnt(10)
    v_mfma_f32_32x32x16_bf16 v[80:95], v[60:63], v[156:159], v[80:95]
    ds_read_b64_tr_b16 v[52:53], v25 offset:20480
    ds_read_b64_tr_b16 v[54:55], v25 offset:20992
    v_lshl_add_u32 v9, v13, 4, v12
    v_cndmask_b32 v29, v9, v29, s[36:37]
    v_add_u32 v11, s29, v10
    v_add_u32 v11, 128, v11
    s_waitcnt lgkmcnt(10)
    v_mfma_f32_32x32x16_bf16 v[64:79], v[32:35], v[160:163], v[64:79]
    ds_read_b64_tr_b16 v[56:57], v24 offset:22528
    ds_read_b64_tr_b16 v[58:59], v24 offset:23040
    v_mul_lo_u32 v12, v11, s30
    v_lshrrev_b32 v12, 18, v12
    v_mul_u32_u24 v13, 6, v12
    v_sub_u32 v13, v11, v13
    v_mul_lo_u32 v12, v12, s34
    v_lshl_add_u32 v9, v13, 4, v12
    v_cndmask_b32 v30, v9, v30, s[36:37]
    v_cndmask_b32 v31, v9, v31, s[36:37]
    s_waitcnt lgkmcnt(10)
    v_mfma_f32_32x32x16_bf16 v[80:95], v[36:39], v[160:163], v[80:95]
    ds_read_b64_tr_b16 v[60:61], v25 offset:22528
    ds_read_b64_tr_b16 v[62:63], v25 offset:23040
    s_add_u32 m0, s43, 1024
    s_add_u32 s53, s42, 65792
    buffer_load_dwordx4 v4, s[4:7], s53 offen lds
    v_lshrrev_b32 v11, 5, v10
    v_bfe_u32 v12, v10, 2, 2
    v_lshl_add_u32 v13, v11, 3, v12
    v_lshlrev_b32 v6, 8, v13
    v_lshl_add_u32 v6, v12, 6, v6
    v_bfe_u32 v7, v10, 4, 1
    v_lshl_add_u32 v6, v7, 5, v6
    v_and_b32 v9, 3, v10
    s_waitcnt lgkmcnt(10)
    v_mfma_f32_32x32x16_bf16 v[64:79], v[40:43], v[164:167], v[64:79]
    ds_read_b64_tr_b16 v[32:33], v24 offset:24576
    ds_read_b64_tr_b16 v[34:35], v24 offset:25088
    v_lshl_add_u32 v6, v9, 3, v6
    v_mul_u32_u24 v13, 96, v13
    v_mul_u32_u24 v7, 6272, v7
    v_add_u32 v13, v13, v7
    s_waitcnt lgkmcnt(10)
    v_mfma_f32_32x32x16_bf16 v[80:95], v[44:47], v[164:167], v[80:95]
    ds_read_b64_tr_b16 v[36:37], v25 offset:24576
    ds_read_b64_tr_b16 v[38:39], v25 offset:25088
    v_lshl_add_u32 v13, v9, 3, v13
    v_add_u32 v7, 0x4000, v13
    s_mov_b32 s60, s68
    s_mov_b32 s61, s69
    s_cmp_eq_u32 s20, 2
    s_cselect_b32 s60, s64, s60
    s_cselect_b32 s61, s65, s61
    s_cmp_eq_u32 s20, 3
    s_cselect_b32 s60, s66, s60
    s_cselect_b32 s61, s67, s61
    s_waitcnt lgkmcnt(10)
    v_mfma_f32_32x32x16_bf16 v[64:79], v[48:51], v[168:171], v[64:79]
    ds_read_b64_tr_b16 v[40:41], v24 offset:26624
    ds_read_b64_tr_b16 v[42:43], v24 offset:27136
    s_add_u32 m0, s43, 2048
    s_add_u32 s53, s42, 131328
    buffer_load_dwordx4 v4, s[4:7], s53 offen lds
    s_cmp_ge_u32 s20, 4
    s_cselect_b32 s60, s56, s60
    s_cselect_b32 s61, s57, s61
    s_cmp_ge_u32 s20, 6
    s_cselect_b32 s60, s58, s60
    s_cselect_b32 s61, s59, s61
    s_and_b32 s61, s61, 0xffff
    s_mov_b32 s63, 0x00020000
    s_mov_b32 s62, 0x158000
    s_movk_i32 s35, 5504
    s_waitcnt lgkmcnt(10)
    v_mfma_f32_32x32x16_bf16 v[80:95], v[52:55], v[168:171], v[80:95]
    ds_read_b64_tr_b16 v[44:45], v25 offset:26624
    ds_read_b64_tr_b16 v[46:47], v25 offset:27136
    s_and_b32 s38, s20, 2
    s_cmp_eq_u32 s38, 0
    s_cselect_b32 s62, 0x400000, s62
    s_cselect_b32 s35, 0x4000, s35
    s_waitcnt lgkmcnt(10)
    v_mfma_f32_32x32x16_bf16 v[64:79], v[56:59], v[172:175], v[64:79]
    ds_read_b64_tr_b16 v[48:49], v24 offset:28672
    ds_read_b64_tr_b16 v[50:51], v24 offset:29184
    s_mul_i32 s35, s35, s2
    s_and_b32 s39, s20, 1
    s_lshl_b32 s39, s39, 13
    s_cmp_eq_u32 s38, 0
    s_cselect_b32 s39, s39, 0
    s_add_u32 s35, s35, s39
    s_cmp_ge_u32 s20, 4
    s_cselect_b32 s35, 0x7f000000, s35
    v_lshlrev_b32 v12, 3, v1
    s_waitcnt lgkmcnt(10)
    v_mfma_f32_32x32x16_bf16 v[80:95], v[60:63], v[172:175], v[80:95]
    ds_read_b64_tr_b16 v[52:53], v25 offset:28672
    ds_read_b64_tr_b16 v[54:55], v25 offset:29184
    s_add_u32 m0, s43, 3072
    s_add_u32 s53, s42, 196864
    buffer_load_dwordx4 v4, s[4:7], s53 offen lds
    buffer_load_dword v11, v12, s[60:63], s35 offen
    s_bfe_u32 s29, s20, 0x10001
    s_cmp_eq_u32 s29, 0
    s_cselect_b32 s16, s64, s66
    s_cselect_b32 s17, s65, s67
    s_mov_b32 s18, 0x158000
    s_cmp_eq_u32 s25, 0
    s_cselect_b32 s16, s68, s16
    s_cselect_b32 s17, s69, s17
    s_cselect_b32 s18, 0x400000, s18
    s_waitcnt lgkmcnt(10)
    v_mfma_f32_32x32x16_bf16 v[64:79], v[32:35], v[176:179], v[64:79]
    ds_read_b64_tr_b16 v[56:57], v24 offset:30720
    ds_read_b64_tr_b16 v[58:59], v24 offset:31232
    s_and_b32 s17, s17, 0xffff
    s_mov_b32 s19, 0x00020000
    s_lshl_b32 s56, s21, 8
    s_mul_i32 s38, s21, 96
    s_add_u32 s55, s41, 1024
    buffer_store_dwordx4 v[100:103], v1, s[8:11], s55 offen
    s_waitcnt lgkmcnt(10)
    v_mfma_f32_32x32x16_bf16 v[80:95], v[36:39], v[176:179], v[80:95]
    ds_read_b64_tr_b16 v[60:61], v25 offset:30720
    ds_read_b64_tr_b16 v[62:63], v25 offset:31232
    s_lshl_b32 s58, s26, 12
    s_mul_i32 s39, s29, 6272
    s_and_b32 s30, s20, 1
    s_mul_i32 s30, s30, 3072
    s_add_u32 s39, s39, s30
    s_add_u32 s39, s39, 16384
    s_cmp_eq_u32 s25, 0
    s_cselect_b32 s56, s56, s38
    s_mov_b32 s57, 0x2b000
    s_cselect_b32 s57, 0x80000, s57
    s_cselect_b32 s58, s58, s39
    s_movk_i32 s59, 2048
    s_cselect_b32 s59, 3072, s59
    s_waitcnt lgkmcnt(10)
    v_mfma_f32_32x32x16_bf16 v[64:79], v[40:43], v[180:183], v[64:79]
    s_add_u32 s59, s59, s58
    s_lshl_b32 s60, s27, 15
    s_waitcnt lgkmcnt(8)
    v_mfma_f32_32x32x16_bf16 v[80:95], v[44:47], v[180:183], v[80:95]
    s_waitcnt vmcnt(7)
    s_waitcnt lgkmcnt(0)
    s_barrier
    s_cmp_lg_u32 s20, 0
    s_cbranch_scc1 LF_pub1
    v_mov_b32 v14, 1
    v_mov_b32 v15, 0
    s_mov_b64 exec, 1
    buffer_atomic_add v14, v15, s[96:99], s32 offen sc1
    s_mov_b64 exec, -1
LF_pub1:
    ds_read_b64_tr_b16 v[32:33], v26 offset:0
    ds_read_b64_tr_b16 v[34:35], v26 offset:512
    v_mfma_f32_32x32x16_bf16 v[64:79], v[48:51], v[184:187], v[64:79]
    ds_read_b64_tr_b16 v[36:37], v27 offset:0
    ds_read_b64_tr_b16 v[38:39], v27 offset:512
    v_mfma_f32_32x32x16_bf16 v[80:95], v[52:55], v[184:187], v[80:95]
    ds_read_b64_tr_b16 v[40:41], v26 offset:2048
    ds_read_b64_tr_b16 v[42:43], v26 offset:2560
    v_mfma_f32_32x32x16_bf16 v[64:79], v[56:59], v[188:191], v[64:79]
    ds_read_b64_tr_b16 v[44:45], v27 offset:2048
    ds_read_b64_tr_b16 v[46:47], v27 offset:2560
    v_mfma_f32_32x32x16_bf16 v[80:95], v[60:63], v[188:191], v[80:95]
    ds_read_b64_tr_b16 v[48:49], v26 offset:4096
    ds_read_b64_tr_b16 v[50:51], v26 offset:4608
    ds_read_b64_tr_b16 v[52:53], v27 offset:4096
    ds_read_b64_tr_b16 v[54:55], v27 offset:4608
    s_waitcnt lgkmcnt(10)
    v_mfma_f32_32x32x16_bf16 v[64:79], v[32:35], v[192:195], v[64:79]
    ds_read_b64_tr_b16 v[56:57], v26 offset:6144
    ds_read_b64_tr_b16 v[58:59], v26 offset:6656
    s_waitcnt lgkmcnt(10)
    v_mfma_f32_32x32x16_bf16 v[80:95], v[36:39], v[192:195], v[80:95]
    ds_read_b64_tr_b16 v[60:61], v27 offset:6144
    ds_read_b64_tr_b16 v[62:63], v27 offset:6656
    s_waitcnt lgkmcnt(10)
    v_mfma_f32_32x32x16_bf16 v[64:79], v[40:43], v[196:199], v[64:79]
    ds_read_b64_tr_b16 v[32:33], v26 offset:8192
    ds_read_b64_tr_b16 v[34:35], v26 offset:8704
    s_add_u32 m0, s43, 32768
    s_add_u32 s53, s42, 2097408
    buffer_load_dwordx4 v4, s[4:7], s53 offen lds
    s_waitcnt lgkmcnt(10)
    v_mfma_f32_32x32x16_bf16 v[80:95], v[44:47], v[196:199], v[80:95]
    ds_read_b64_tr_b16 v[36:37], v27 offset:8192
    ds_read_b64_tr_b16 v[38:39], v27 offset:8704
    s_waitcnt lgkmcnt(10)
    v_mfma_f32_32x32x16_bf16 v[64:79], v[48:51], v[200:203], v[64:79]
    ds_read_b64_tr_b16 v[40:41], v26 offset:10240
    ds_read_b64_tr_b16 v[42:43], v26 offset:10752
    s_waitcnt lgkmcnt(10)
    v_mfma_f32_32x32x16_bf16 v[80:95], v[52:55], v[200:203], v[80:95]
    ds_read_b64_tr_b16 v[44:45], v27 offset:10240
    ds_read_b64_tr_b16 v[46:47], v27 offset:10752
    s_waitcnt lgkmcnt(10)
    v_mfma_f32_32x32x16_bf16 v[64:79], v[56:59], v[204:207], v[64:79]
    ds_read_b64_tr_b16 v[48:49], v26 offset:12288
    ds_read_b64_tr_b16 v[50:51], v26 offset:12800
    s_waitcnt lgkmcnt(10)
    v_mfma_f32_32x32x16_bf16 v[80:95], v[60:63], v[204:207], v[80:95]
    ds_read_b64_tr_b16 v[52:53], v27 offset:12288
    ds_read_b64_tr_b16 v[54:55], v27 offset:12800
    s_waitcnt lgkmcnt(10)
    v_mfma_f32_32x32x16_bf16 v[64:79], v[32:35], v[208:211], v[64:79]
    ds_read_b64_tr_b16 v[56:57], v26 offset:14336
    ds_read_b64_tr_b16 v[58:59], v26 offset:14848
    s_add_u32 m0, s43, 33792
    s_add_u32 s53, s42, 2162944
    buffer_load_dwordx4 v4, s[4:7], s53 offen lds
    s_waitcnt lgkmcnt(10)
    v_mfma_f32_32x32x16_bf16 v[80:95], v[36:39], v[208:211], v[80:95]
    ds_read_b64_tr_b16 v[60:61], v27 offset:14336
    ds_read_b64_tr_b16 v[62:63], v27 offset:14848
    s_waitcnt lgkmcnt(10)
    v_mfma_f32_32x32x16_bf16 v[64:79], v[40:43], v[212:215], v[64:79]
    ds_read_b64_tr_b16 v[32:33], v26 offset:16384
    ds_read_b64_tr_b16 v[34:35], v26 offset:16896
    s_waitcnt lgkmcnt(10)
    v_mfma_f32_32x32x16_bf16 v[80:95], v[44:47], v[212:215], v[80:95]
    ds_read_b64_tr_b16 v[36:37], v27 offset:16384
    ds_read_b64_tr_b16 v[38:39], v27 offset:16896
    s_waitcnt lgkmcnt(10)
    v_mfma_f32_32x32x16_bf16 v[64:79], v[48:51], v[216:219], v[64:79]
    ds_read_b64_tr_b16 v[40:41], v26 offset:18432
    ds_read_b64_tr_b16 v[42:43], v26 offset:18944
    s_add_u32 s55, s41, 2048
    buffer_store_dwordx4 v[104:107], v1, s[8:11], s55 offen
    s_waitcnt lgkmcnt(10)
    v_mfma_f32_32x32x16_bf16 v[80:95], v[52:55], v[216:219], v[80:95]
    ds_read_b64_tr_b16 v[44:45], v27 offset:18432
    ds_read_b64_tr_b16 v[46:47], v27 offset:18944
    s_waitcnt lgkmcnt(10)
    v_mfma_f32_32x32x16_bf16 v[64:79], v[56:59], v[220:223], v[64:79]
    ds_read_b64_tr_b16 v[48:49], v26 offset:20480
    ds_read_b64_tr_b16 v[50:51], v26 offset:20992
    s_add_u32 m0, s43, 34816
    s_add_u32 s53, s42, 2228480
    buffer_load_dwordx4 v4, s[4:7], s53 offen lds
    s_waitcnt lgkmcnt(10)
    v_mfma_f32_32x32x16_bf16 v[80:95], v[60:63], v[220:223], v[80:95]
    ds_read_b64_tr_b16 v[52:53], v27 offset:20480
    ds_read_b64_tr_b16 v[54:55], v27 offset:20992
    s_waitcnt lgkmcnt(10)
    v_mfma_f32_32x32x16_bf16 v[64:79], v[32:35], v[224:227], v[64:79]
    ds_read_b64_tr_b16 v[56:57], v26 offset:22528
    ds_read_b64_tr_b16 v[58:59], v26 offset:23040
    s_waitcnt lgkmcnt(10)
    v_mfma_f32_32x32x16_bf16 v[80:95], v[36:39], v[224:227], v[80:95]
    ds_read_b64_tr_b16 v[60:61], v27 offset:22528
    ds_read_b64_tr_b16 v[62:63], v27 offset:23040
    s_waitcnt lgkmcnt(10)
    v_mfma_f32_32x32x16_bf16 v[64:79], v[40:43], v[228:231], v[64:79]
    ds_read_b64_tr_b16 v[32:33], v26 offset:24576
    ds_read_b64_tr_b16 v[34:35], v26 offset:25088
    s_waitcnt lgkmcnt(10)
    v_mfma_f32_32x32x16_bf16 v[80:95], v[44:47], v[228:231], v[80:95]
    ds_read_b64_tr_b16 v[36:37], v27 offset:24576
    ds_read_b64_tr_b16 v[38:39], v27 offset:25088
    s_waitcnt lgkmcnt(10)
    v_mfma_f32_32x32x16_bf16 v[64:79], v[48:51], v[232:235], v[64:79]
    ds_read_b64_tr_b16 v[40:41], v26 offset:26624
    ds_read_b64_tr_b16 v[42:43], v26 offset:27136
    s_add_u32 m0, s43, 35840
    s_add_u32 s53, s42, 2294016
    buffer_load_dwordx4 v4, s[4:7], s53 offen lds
    s_waitcnt lgkmcnt(10)
    v_mfma_f32_32x32x16_bf16 v[80:95], v[52:55], v[232:235], v[80:95]
    ds_read_b64_tr_b16 v[44:45], v27 offset:26624
    ds_read_b64_tr_b16 v[46:47], v27 offset:27136
    s_waitcnt lgkmcnt(10)
    v_mfma_f32_32x32x16_bf16 v[64:79], v[56:59], v[236:239], v[64:79]
    ds_read_b64_tr_b16 v[48:49], v26 offset:28672
    ds_read_b64_tr_b16 v[50:51], v26 offset:29184
    s_waitcnt lgkmcnt(10)
    v_mfma_f32_32x32x16_bf16 v[80:95], v[60:63], v[236:239], v[80:95]
    ds_read_b64_tr_b16 v[52:53], v27 offset:28672
    ds_read_b64_tr_b16 v[54:55], v27 offset:29184
    s_waitcnt lgkmcnt(10)
    v_mfma_f32_32x32x16_bf16 v[64:79], v[32:35], v[240:243], v[64:79]
    ds_read_b64_tr_b16 v[56:57], v26 offset:30720
    ds_read_b64_tr_b16 v[58:59], v26 offset:31232
    s_add_u32 s55, s41, 3072
    buffer_store_dwordx4 v[108:111], v1, s[8:11], s55 offen
    s_waitcnt lgkmcnt(10)
    v_mfma_f32_32x32x16_bf16 v[80:95], v[36:39], v[240:243], v[80:95]
    ds_read_b64_tr_b16 v[60:61], v27 offset:30720
    ds_read_b64_tr_b16 v[62:63], v27 offset:31232
    s_waitcnt lgkmcnt(10)
    v_mfma_f32_32x32x16_bf16 v[64:79], v[40:43], v[244:247], v[64:79]
    s_waitcnt lgkmcnt(8)
    v_mfma_f32_32x32x16_bf16 v[80:95], v[44:47], v[244:247], v[80:95]
    s_waitcnt vmcnt(8)
    s_waitcnt lgkmcnt(0)
    s_barrier
    ds_read_b64_tr_b16 v[32:33], v20 offset:0
    ds_read_b64_tr_b16 v[34:35], v20 offset:512
    v_mfma_f32_32x32x16_bf16 v[64:79], v[48:51], v[248:251], v[64:79]
    ds_read_b64_tr_b16 v[36:37], v21 offset:0
    ds_read_b64_tr_b16 v[38:39], v21 offset:512
    v_mfma_f32_32x32x16_bf16 v[80:95], v[52:55], v[248:251], v[80:95]
    ds_read_b64_tr_b16 v[40:41], v20 offset:2048
    ds_read_b64_tr_b16 v[42:43], v20 offset:2560
    v_mfma_f32_32x32x16_bf16 v[64:79], v[56:59], v[252:255], v[64:79]
    ds_read_b64_tr_b16 v[44:45], v21 offset:2048
    ds_read_b64_tr_b16 v[46:47], v21 offset:2560
    v_mfma_f32_32x32x16_bf16 v[80:95], v[60:63], v[252:255], v[80:95]
    ds_read_b64_tr_b16 v[48:49], v20 offset:4096
    ds_read_b64_tr_b16 v[50:51], v20 offset:4608
    ds_read_b64_tr_b16 v[52:53], v21 offset:4096
    ds_read_b64_tr_b16 v[54:55], v21 offset:4608
    s_nop 4
    v_cvt_pk_bf16_f32 v96, v64, v65
    v_cvt_pk_bf16_f32 v97, v66, v67
    v_cvt_pk_bf16_f32 v98, v68, v69
    v_cvt_pk_bf16_f32 v99, v70, v71
    v_cvt_pk_bf16_f32 v100, v72, v73
    v_cvt_pk_bf16_f32 v101, v74, v75
    v_cvt_pk_bf16_f32 v102, v76, v77
    v_cvt_pk_bf16_f32 v103, v78, v79
    s_waitcnt lgkmcnt(10)
    v_mfma_f32_32x32x16_bf16 v[64:79], v[32:35], v[128:131], 0
    ds_read_b64_tr_b16 v[56:57], v20 offset:6144
    ds_read_b64_tr_b16 v[58:59], v20 offset:6656
    v_cvt_pk_bf16_f32 v104, v80, v81
    v_cvt_pk_bf16_f32 v105, v82, v83
    v_cvt_pk_bf16_f32 v106, v84, v85
    v_cvt_pk_bf16_f32 v107, v86, v87
    v_cvt_pk_bf16_f32 v108, v88, v89
    v_cvt_pk_bf16_f32 v109, v90, v91
    v_cvt_pk_bf16_f32 v110, v92, v93
    v_cvt_pk_bf16_f32 v111, v94, v95
    s_waitcnt lgkmcnt(10)
    v_mfma_f32_32x32x16_bf16 v[80:95], v[36:39], v[128:131], 0
    ds_read_b64_tr_b16 v[60:61], v21 offset:6144
    ds_read_b64_tr_b16 v[62:63], v21 offset:6656
    s_waitcnt lgkmcnt(10)
    v_mfma_f32_32x32x16_bf16 v[64:79], v[40:43], v[132:135], v[64:79]
    ds_read_b64_tr_b16 v[32:33], v20 offset:8192
    ds_read_b64_tr_b16 v[34:35], v20 offset:8704
    s_add_u32 m0, s43, 131072
    s_add_u32 s53, s42, 384
    buffer_load_dwordx4 v4, s[4:7], s53 offen lds
    s_waitcnt lgkmcnt(10)
    v_mfma_f32_32x32x16_bf16 v[80:95], v[44:47], v[132:135], v[80:95]
    ds_read_b64_tr_b16 v[36:37], v21 offset:8192
    ds_read_b64_tr_b16 v[38:39], v21 offset:8704
    s_waitcnt lgkmcnt(10)
    v_mfma_f32_32x32x16_bf16 v[64:79], v[48:51], v[136:139], v[64:79]
    ds_read_b64_tr_b16 v[40:41], v20 offset:10240
    ds_read_b64_tr_b16 v[42:43], v20 offset:10752
    s_waitcnt lgkmcnt(10)
    v_mfma_f32_32x32x16_bf16 v[80:95], v[52:55], v[136:139], v[80:95]
    ds_read_b64_tr_b16 v[44:45], v21 offset:10240
    ds_read_b64_tr_b16 v[46:47], v21 offset:10752
    s_waitcnt lgkmcnt(10)
    v_mfma_f32_32x32x16_bf16 v[64:79], v[56:59], v[140:143], v[64:79]
    ds_read_b64_tr_b16 v[48:49], v20 offset:12288
    ds_read_b64_tr_b16 v[50:51], v20 offset:12800
    s_waitcnt lgkmcnt(10)
    v_mfma_f32_32x32x16_bf16 v[80:95], v[60:63], v[140:143], v[80:95]
    ds_read_b64_tr_b16 v[52:53], v21 offset:12288
    ds_read_b64_tr_b16 v[54:55], v21 offset:12800
    s_waitcnt lgkmcnt(10)
    v_mfma_f32_32x32x16_bf16 v[64:79], v[32:35], v[144:147], v[64:79]
    ds_read_b64_tr_b16 v[56:57], v20 offset:14336
    ds_read_b64_tr_b16 v[58:59], v20 offset:14848
    s_add_u32 m0, s43, 132096
    s_add_u32 s53, s42, 65920
    buffer_load_dwordx4 v4, s[4:7], s53 offen lds
    s_waitcnt lgkmcnt(10)
    v_mfma_f32_32x32x16_bf16 v[80:95], v[36:39], v[144:147], v[80:95]
    ds_read_b64_tr_b16 v[60:61], v21 offset:14336
    ds_read_b64_tr_b16 v[62:63], v21 offset:14848
    s_waitcnt lgkmcnt(10)
    v_mfma_f32_32x32x16_bf16 v[64:79], v[40:43], v[148:151], v[64:79]
    ds_read_b64_tr_b16 v[32:33], v20 offset:16384
    ds_read_b64_tr_b16 v[34:35], v20 offset:16896
    s_waitcnt lgkmcnt(10)
    v_mfma_f32_32x32x16_bf16 v[80:95], v[44:47], v[148:151], v[80:95]
    ds_read_b64_tr_b16 v[36:37], v21 offset:16384
    ds_read_b64_tr_b16 v[38:39], v21 offset:16896
    s_waitcnt lgkmcnt(10)
    v_mfma_f32_32x32x16_bf16 v[64:79], v[48:51], v[152:155], v[64:79]
    ds_read_b64_tr_b16 v[40:41], v20 offset:18432
    ds_read_b64_tr_b16 v[42:43], v20 offset:18944
    s_add_u32 s55, s41, 4096
    buffer_store_dwordx4 v[96:99], v1, s[8:11], s55 offen
    s_waitcnt lgkmcnt(10)
    v_mfma_f32_32x32x16_bf16 v[80:95], v[52:55], v[152:155], v[80:95]
    ds_read_b64_tr_b16 v[44:45], v21 offset:18432
    ds_read_b64_tr_b16 v[46:47], v21 offset:18944
    s_waitcnt lgkmcnt(10)
    v_mfma_f32_32x32x16_bf16 v[64:79], v[56:59], v[156:159], v[64:79]
    ds_read_b64_tr_b16 v[48:49], v20 offset:20480
    ds_read_b64_tr_b16 v[50:51], v20 offset:20992
    s_add_u32 m0, s43, 133120
    s_add_u32 s53, s42, 131456
    buffer_load_dwordx4 v4, s[4:7], s53 offen lds
    s_waitcnt lgkmcnt(10)
    v_mfma_f32_32x32x16_bf16 v[80:95], v[60:63], v[156:159], v[80:95]
    ds_read_b64_tr_b16 v[52:53], v21 offset:20480
    ds_read_b64_tr_b16 v[54:55], v21 offset:20992
    s_waitcnt lgkmcnt(10)
    v_mfma_f32_32x32x16_bf16 v[64:79], v[32:35], v[160:163], v[64:79]
    ds_read_b64_tr_b16 v[56:57], v20 offset:22528
    ds_read_b64_tr_b16 v[58:59], v20 offset:23040
    s_waitcnt lgkmcnt(10)
    v_mfma_f32_32x32x16_bf16 v[80:95], v[36:39], v[160:163], v[80:95]
    ds_read_b64_tr_b16 v[60:61], v21 offset:22528
    ds_read_b64_tr_b16 v[62:63], v21 offset:23040
    s_waitcnt lgkmcnt(10)
    v_mfma_f32_32x32x16_bf16 v[64:79], v[40:43], v[164:167], v[64:79]
    ds_read_b64_tr_b16 v[32:33], v20 offset:24576
    ds_read_b64_tr_b16 v[34:35], v20 offset:25088
    s_waitcnt lgkmcnt(10)
    v_mfma_f32_32x32x16_bf16 v[80:95], v[44:47], v[164:167], v[80:95]
    ds_read_b64_tr_b16 v[36:37], v21 offset:24576
    ds_read_b64_tr_b16 v[38:39], v21 offset:25088
    s_waitcnt lgkmcnt(10)
    v_mfma_f32_32x32x16_bf16 v[64:79], v[48:51], v[168:171], v[64:79]
    ds_read_b64_tr_b16 v[40:41], v20 offset:26624
    ds_read_b64_tr_b16 v[42:43], v20 offset:27136
    s_add_u32 m0, s43, 134144
    s_add_u32 s53, s42, 196992
    buffer_load_dwordx4 v4, s[4:7], s53 offen lds
    s_waitcnt lgkmcnt(10)
    v_mfma_f32_32x32x16_bf16 v[80:95], v[52:55], v[168:171], v[80:95]
    ds_read_b64_tr_b16 v[44:45], v21 offset:26624
    ds_read_b64_tr_b16 v[46:47], v21 offset:27136
    s_waitcnt lgkmcnt(10)
    v_mfma_f32_32x32x16_bf16 v[64:79], v[56:59], v[172:175], v[64:79]
    ds_read_b64_tr_b16 v[48:49], v20 offset:28672
    ds_read_b64_tr_b16 v[50:51], v20 offset:29184
    s_waitcnt lgkmcnt(10)
    v_mfma_f32_32x32x16_bf16 v[80:95], v[60:63], v[172:175], v[80:95]
    ds_read_b64_tr_b16 v[52:53], v21 offset:28672
    ds_read_b64_tr_b16 v[54:55], v21 offset:29184
    s_waitcnt lgkmcnt(10)
    v_mfma_f32_32x32x16_bf16 v[64:79], v[32:35], v[176:179], v[64:79]
    ds_read_b64_tr_b16 v[56:57], v20 offset:30720
    ds_read_b64_tr_b16 v[58:59], v20 offset:31232
    s_add_u32 s55, s41, 5120
    buffer_store_dwordx4 v[100:103], v1, s[8:11], s55 offen
    s_waitcnt lgkmcnt(10)
    v_mfma_f32_32x32x16_bf16 v[80:95], v[36:39], v[176:179], v[80:95]
    ds_read_b64_tr_b16 v[60:61], v21 offset:30720
    ds_read_b64_tr_b16 v[62:63], v21 offset:31232
    s_waitcnt lgkmcnt(10)
    v_mfma_f32_32x32x16_bf16 v[64:79], v[40:43], v[180:183], v[64:79]
    s_waitcnt lgkmcnt(8)
    v_mfma_f32_32x32x16_bf16 v[80:95], v[44:47], v[180:183], v[80:95]
    s_waitcnt vmcnt(7)
    s_waitcnt lgkmcnt(0)
    s_barrier
    ds_read_b64_tr_b16 v[32:33], v22 offset:0
    ds_read_b64_tr_b16 v[34:35], v22 offset:512
    v_mfma_f32_32x32x16_bf16 v[64:79], v[48:51], v[184:187], v[64:79]
    ds_read_b64_tr_b16 v[36:37], v23 offset:0
    ds_read_b64_tr_b16 v[38:39], v23 offset:512
    v_mfma_f32_32x32x16_bf16 v[80:95], v[52:55], v[184:187], v[80:95]
    ds_read_b64_tr_b16 v[40:41], v22 offset:2048
    ds_read_b64_tr_b16 v[42:43], v22 offset:2560
    v_mfma_f32_32x32x16_bf16 v[64:79], v[56:59], v[188:191], v[64:79]
    ds_read_b64_tr_b16 v[44:45], v23 offset:2048
    ds_read_b64_tr_b16 v[46:47], v23 offset:2560
    v_mfma_f32_32x32x16_bf16 v[80:95], v[60:63], v[188:191], v[80:95]
    ds_read_b64_tr_b16 v[48:49], v22 offset:4096
    ds_read_b64_tr_b16 v[50:51], v22 offset:4608
    ds_read_b64_tr_b16 v[52:53], v23 offset:4096
    ds_read_b64_tr_b16 v[54:55], v23 offset:4608
    s_waitcnt lgkmcnt(10)
    v_mfma_f32_32x32x16_bf16 v[64:79], v[32:35], v[192:195], v[64:79]
    ds_read_b64_tr_b16 v[56:57], v22 offset:6144
    ds_read_b64_tr_b16 v[58:59], v22 offset:6656
    s_waitcnt lgkmcnt(10)
    v_mfma_f32_32x32x16_bf16 v[80:95], v[36:39], v[192:195], v[80:95]
    ds_read_b64_tr_b16 v[60:61], v23 offset:6144
    ds_read_b64_tr_b16 v[62:63], v23 offset:6656
    s_waitcnt lgkmcnt(10)
    v_mfma_f32_32x32x16_bf16 v[64:79], v[40:43], v[196:199], v[64:79]
    ds_read_b64_tr_b16 v[32:33], v22 offset:8192
    ds_read_b64_tr_b16 v[34:35], v22 offset:8704
    s_add_u32 m0, s43, 65536
    s_add_u32 s53, s42, 2097536
    buffer_load_dwordx4 v4, s[4:7], s53 offen lds
    s_waitcnt lgkmcnt(10)
    v_mfma_f32_32x32x16_bf16 v[80:95], v[44:47], v[196:199], v[80:95]
    ds_read_b64_tr_b16 v[36:37], v23 offset:8192
    ds_read_b64_tr_b16 v[38:39], v23 offset:8704
    s_waitcnt lgkmcnt(10)
    v_mfma_f32_32x32x16_bf16 v[64:79], v[48:51], v[200:203], v[64:79]
    ds_read_b64_tr_b16 v[40:41], v22 offset:10240
    ds_read_b64_tr_b16 v[42:43], v22 offset:10752
    s_waitcnt lgkmcnt(10)
    v_mfma_f32_32x32x16_bf16 v[80:95], v[52:55], v[200:203], v[80:95]
    ds_read_b64_tr_b16 v[44:45], v23 offset:10240
    ds_read_b64_tr_b16 v[46:47], v23 offset:10752
    s_waitcnt lgkmcnt(10)
    v_mfma_f32_32x32x16_bf16 v[64:79], v[56:59], v[204:207], v[64:79]
    ds_read_b64_tr_b16 v[48:49], v22 offset:12288
    ds_read_b64_tr_b16 v[50:51], v22 offset:12800
    s_waitcnt lgkmcnt(10)
    v_mfma_f32_32x32x16_bf16 v[80:95], v[60:63], v[204:207], v[80:95]
    ds_read_b64_tr_b16 v[52:53], v23 offset:12288
    ds_read_b64_tr_b16 v[54:55], v23 offset:12800
    s_waitcnt lgkmcnt(10)
    v_mfma_f32_32x32x16_bf16 v[64:79], v[32:35], v[208:211], v[64:79]
    ds_read_b64_tr_b16 v[56:57], v22 offset:14336
    ds_read_b64_tr_b16 v[58:59], v22 offset:14848
    s_add_u32 m0, s43, 66560
    s_add_u32 s53, s42, 2163072
    buffer_load_dwordx4 v4, s[4:7], s53 offen lds
    s_waitcnt lgkmcnt(10)
    v_mfma_f32_32x32x16_bf16 v[80:95], v[36:39], v[208:211], v[80:95]
    ds_read_b64_tr_b16 v[60:61], v23 offset:14336
    ds_read_b64_tr_b16 v[62:63], v23 offset:14848
    s_waitcnt lgkmcnt(10)
    v_mfma_f32_32x32x16_bf16 v[64:79], v[40:43], v[212:215], v[64:79]
    ds_read_b64_tr_b16 v[32:33], v22 offset:16384
    ds_read_b64_tr_b16 v[34:35], v22 offset:16896
    s_waitcnt lgkmcnt(10)
    v_mfma_f32_32x32x16_bf16 v[80:95], v[44:47], v[212:215], v[80:95]
    ds_read_b64_tr_b16 v[36:37], v23 offset:16384
    ds_read_b64_tr_b16 v[38:39], v23 offset:16896
    s_waitcnt lgkmcnt(10)
    v_mfma_f32_32x32x16_bf16 v[64:79], v[48:51], v[216:219], v[64:79]
    ds_read_b64_tr_b16 v[40:41], v22 offset:18432
    ds_read_b64_tr_b16 v[42:43], v22 offset:18944
    s_add_u32 s55, s41, 6144
    buffer_store_dwordx4 v[104:107], v1, s[8:11], s55 offen
    s_waitcnt lgkmcnt(10)
    v_mfma_f32_32x32x16_bf16 v[80:95], v[52:55], v[216:219], v[80:95]
    ds_read_b64_tr_b16 v[44:45], v23 offset:18432
    ds_read_b64_tr_b16 v[46:47], v23 offset:18944
    s_waitcnt lgkmcnt(10)
    v_mfma_f32_32x32x16_bf16 v[64:79], v[56:59], v[220:223], v[64:79]
    ds_read_b64_tr_b16 v[48:49], v22 offset:20480
    ds_read_b64_tr_b16 v[50:51], v22 offset:20992
    s_add_u32 m0, s43, 67584
    s_add_u32 s53, s42, 2228608
    buffer_load_dwordx4 v4, s[4:7], s53 offen lds
    s_waitcnt lgkmcnt(10)
    v_mfma_f32_32x32x16_bf16 v[80:95], v[60:63], v[220:223], v[80:95]
    ds_read_b64_tr_b16 v[52:53], v23 offset:20480
    ds_read_b64_tr_b16 v[54:55], v23 offset:20992
    s_waitcnt lgkmcnt(10)
    v_mfma_f32_32x32x16_bf16 v[64:79], v[32:35], v[224:227], v[64:79]
    ds_read_b64_tr_b16 v[56:57], v22 offset:22528
    ds_read_b64_tr_b16 v[58:59], v22 offset:23040
    s_waitcnt lgkmcnt(10)
    v_mfma_f32_32x32x16_bf16 v[80:95], v[36:39], v[224:227], v[80:95]
    ds_read_b64_tr_b16 v[60:61], v23 offset:22528
    ds_read_b64_tr_b16 v[62:63], v23 offset:23040
    s_waitcnt lgkmcnt(10)
    v_mfma_f32_32x32x16_bf16 v[64:79], v[40:43], v[228:231], v[64:79]
    ds_read_b64_tr_b16 v[32:33], v22 offset:24576
    ds_read_b64_tr_b16 v[34:35], v22 offset:25088
    s_sub_u32 s29, 15, s24
    s_lshl_b32 s29, s29, 2
    s_lshl_b32 s30, s24, 2
    s_cmp_lg_u32 s20, 0
    s_cbranch_scc1 LF_pi2
    v_mov_b32 v8, 0
    buffer_load_dword v14, v8, s[96:99], s29 offen sc1
    buffer_load_dword v15, v8, s[96:99], s30 offen sc1
LF_pi2:
    s_waitcnt lgkmcnt(10)
    v_mfma_f32_32x32x16_bf16 v[80:95], v[44:47], v[228:231], v[80:95]
    ds_read_b64_tr_b16 v[36:37], v23 offset:24576
    ds_read_b64_tr_b16 v[38:39], v23 offset:25088
    s_waitcnt lgkmcnt(10)
    v_mfma_f32_32x32x16_bf16 v[64:79], v[48:51], v[232:235], v[64:79]
    ds_read_b64_tr_b16 v[40:41], v22 offset:26624
    ds_read_b64_tr_b16 v[42:43], v22 offset:27136
    s_add_u32 m0, s43, 68608
    s_add_u32 s53, s42, 2294144
    buffer_load_dwordx4 v4, s[4:7], s53 offen lds
    s_waitcnt lgkmcnt(10)
    v_mfma_f32_32x32x16_bf16 v[80:95], v[52:55], v[232:235], v[80:95]
    ds_read_b64_tr_b16 v[44:45], v23 offset:26624
    ds_read_b64_tr_b16 v[46:47], v23 offset:27136
    s_waitcnt lgkmcnt(10)
    v_mfma_f32_32x32x16_bf16 v[64:79], v[56:59], v[236:239], v[64:79]
    ds_read_b64_tr_b16 v[48:49], v22 offset:28672
    ds_read_b64_tr_b16 v[50:51], v22 offset:29184
    s_waitcnt lgkmcnt(10)
    v_mfma_f32_32x32x16_bf16 v[80:95], v[60:63], v[236:239], v[80:95]
    ds_read_b64_tr_b16 v[52:53], v23 offset:28672
    ds_read_b64_tr_b16 v[54:55], v23 offset:29184
    s_waitcnt lgkmcnt(10)
    v_mfma_f32_32x32x16_bf16 v[64:79], v[32:35], v[240:243], v[64:79]
    ds_read_b64_tr_b16 v[56:57], v22 offset:30720
    ds_read_b64_tr_b16 v[58:59], v22 offset:31232
    s_add_u32 s55, s41, 7168
    buffer_store_dwordx4 v[108:111], v1, s[8:11], s55 offen
    s_waitcnt lgkmcnt(10)
    v_mfma_f32_32x32x16_bf16 v[80:95], v[36:39], v[240:243], v[80:95]
    ds_read_b64_tr_b16 v[60:61], v23 offset:30720
    ds_read_b64_tr_b16 v[62:63], v23 offset:31232
    s_waitcnt lgkmcnt(10)
    v_mfma_f32_32x32x16_bf16 v[64:79], v[40:43], v[244:247], v[64:79]
    s_waitcnt lgkmcnt(8)
    v_mfma_f32_32x32x16_bf16 v[80:95], v[44:47], v[244:247], v[80:95]
    s_waitcnt vmcnt(7)
    s_waitcnt lgkmcnt(0)
    s_barrier
    s_cmp_lg_u32 s20, 0
    s_cbranch_scc1 LF_pc3
    s_waitcnt vmcnt(2)
    v_readfirstlane_b32 s100, v14
    s_nop 1
    s_cmp_lt_u32 s100, 16
    s_cbranch_scc1 LF_pc3_slow
    s_waitcnt vmcnt(2)
    v_readfirstlane_b32 s100, v15
    s_nop 1
    s_cmp_lt_u32 s100, 16
    s_cbranch_scc1 LF_pc3_slow
LF_pc3_ok:
LF_pc3:
    ds_read_b64_tr_b16 v[32:33], v24 offset:0
    ds_read_b64_tr_b16 v[34:35], v24 offset:512
    v_mfma_f32_32x32x16_bf16 v[64:79], v[48:51], v[248:251], v[64:79]
    ds_read_b64_tr_b16 v[36:37], v25 offset:0
    ds_read_b64_tr_b16 v[38:39], v25 offset:512
    v_mfma_f32_32x32x16_bf16 v[80:95], v[52:55], v[248:251], v[80:95]
    ds_read_b64_tr_b16 v[40:41], v24 offset:2048
    ds_read_b64_tr_b16 v[42:43], v24 offset:2560
    v_mfma_f32_32x32x16_bf16 v[64:79], v[56:59], v[252:255], v[64:79]
    ds_read_b64_tr_b16 v[44:45], v25 offset:2048
    ds_read_b64_tr_b16 v[46:47], v25 offset:2560
    v_mfma_f32_32x32x16_bf16 v[80:95], v[60:63], v[252:255], v[80:95]
    ds_read_b64_tr_b16 v[48:49], v24 offset:4096
    ds_read_b64_tr_b16 v[50:51], v24 offset:4608
    ds_read_b64_tr_b16 v[52:53], v25 offset:4096
    ds_read_b64_tr_b16 v[54:55], v25 offset:4608
    s_nop 4
    v_cvt_pk_bf16_f32 v96, v64, v65
    v_cvt_pk_bf16_f32 v97, v66, v67
    v_cvt_pk_bf16_f32 v98, v68, v69
    v_cvt_pk_bf16_f32 v99, v70, v71
    v_cvt_pk_bf16_f32 v100, v72, v73
    v_cvt_pk_bf16_f32 v101, v74, v75
    v_cvt_pk_bf16_f32 v102, v76, v77
    v_cvt_pk_bf16_f32 v103, v78, v79
    s_waitcnt lgkmcnt(10)
    v_mfma_f32_32x32x16_bf16 v[64:79], v[32:35], v[128:131], 0
    ds_read_b64_tr_b16 v[56:57], v24 offset:6144
    ds_read_b64_tr_b16 v[58:59], v24 offset:6656
    v_cvt_pk_bf16_f32 v104, v80, v81
    v_cvt_pk_bf16_f32 v105, v82, v83
    v_cvt_pk_bf16_f32 v106, v84, v85
    v_cvt_pk_bf16_f32 v107, v86, v87
    v_cvt_pk_bf16_f32 v108, v88, v89
    v_cvt_pk_bf16_f32 v109, v90, v91
    v_cvt_pk_bf16_f32 v110, v92, v93
    v_cvt_pk_bf16_f32 v111, v94, v95
    s_waitcnt lgkmcnt(10)
    v_mfma_f32_32x32x16_bf16 v[80:95], v[36:39], v[128:131], 0
    ds_read_b64_tr_b16 v[60:61], v25 offset:6144
    ds_read_b64_tr_b16 v[62:63], v25 offset:6656
    s_add_u32 m0, s58, 0
    s_nop 0
    buffer_load_dwordx4 v28, s[16:19], s56 offen lds
    s_waitcnt lgkmcnt(10)
    v_mfma_f32_32x32x16_bf16 v[64:79], v[40:43], v[132:135], v[64:79]
    ds_read_b64_tr_b16 v[32:33], v24 offset:8192
    ds_read_b64_tr_b16 v[34:35], v24 offset:8704
    s_waitcnt lgkmcnt(10)
    v_mfma_f32_32x32x16_bf16 v[80:95], v[44:47], v[132:135], v[80:95]
    ds_read_b64_tr_b16 v[36:37], v25 offset:8192
    ds_read_b64_tr_b16 v[38:39], v25 offset:8704
    s_waitcnt lgkmcnt(10)
    v_mfma_f32_32x32x16_bf16 v[64:79], v[48:51], v[136:139], v[64:79]
    ds_read_b64_tr_b16 v[40:41], v24 offset:10240
    ds_read_b64_tr_b16 v[42:43], v24 offset:10752
    s_add_u32 m0, s58, 1024
    s_nop 0
    buffer_load_dwordx4 v29, s[16:19], s56 offen lds
    s_waitcnt lgkmcnt(10)
    v_mfma_f32_32x32x16_bf16 v[80:95], v[52:55], v[136:139], v[80:95]
    ds_read_b64_tr_b16 v[44:45], v25 offset:10240
    ds_read_b64_tr_b16 v[46:47], v25 offset:10752
    s_waitcnt lgkmcnt(10)
    v_mfma_f32_32x32x16_bf16 v[64:79], v[56:59], v[140:143], v[64:79]
    ds_read_b64_tr_b16 v[48:49], v24 offset:12288
    ds_read_b64_tr_b16 v[50:51], v24 offset:12800
    s_waitcnt lgkmcnt(10)
    v_mfma_f32_32x32x16_bf16 v[80:95], v[60:63], v[140:143], v[80:95]
    ds_read_b64_tr_b16 v[52:53], v25 offset:12288
    ds_read_b64_tr_b16 v[54:55], v25 offset:12800
    s_add_u32 m0, s58, 2048
    s_nop 0
    buffer_load_dwordx4 v30, s[16:19], s56 offen lds
    s_waitcnt lgkmcnt(10)
    v_mfma_f32_32x32x16_bf16 v[64:79], v[32:35], v[144:147], v[64:79]
    ds_read_b64_tr_b16 v[56:57], v24 offset:14336
    ds_read_b64_tr_b16 v[58:59], v24 offset:14848
    s_waitcnt lgkmcnt(10)
    v_mfma_f32_32x32x16_bf16 v[80:95], v[36:39], v[144:147], v[80:95]
    ds_read_b64_tr_b16 v[60:61], v25 offset:14336
    ds_read_b64_tr_b16 v[62:63], v25 offset:14848
    s_waitcnt lgkmcnt(10)
    v_mfma_f32_32x32x16_bf16 v[64:79], v[40:43], v[148:151], v[64:79]
    ds_read_b64_tr_b16 v[32:33], v24 offset:16384
    ds_read_b64_tr_b16 v[34:35], v24 offset:16896
    s_add_u32 m0, s59, 0
    s_nop 0
    buffer_load_dwordx4 v31, s[16:19], s56 offen lds
    s_add_u32 s56, s56, s57
    s_waitcnt lgkmcnt(10)
    v_mfma_f32_32x32x16_bf16 v[80:95], v[44:47], v[148:151], v[80:95]
    ds_read_b64_tr_b16 v[36:37], v25 offset:16384
    ds_read_b64_tr_b16 v[38:39], v25 offset:16896
    s_waitcnt lgkmcnt(10)
    v_mfma_f32_32x32x16_bf16 v[64:79], v[48:51], v[152:155], v[64:79]
    ds_read_b64_tr_b16 v[40:41], v24 offset:18432
    ds_read_b64_tr_b16 v[42:43], v24 offset:18944
    s_add_u32 s55, s41, 524288
    buffer_store_dwordx4 v[96:99], v1, s[8:11], s55 offen
    s_waitcnt lgkmcnt(10)
    v_mfma_f32_32x32x16_bf16 v[80:95], v[52:55], v[152:155], v[80:95]
    ds_read_b64_tr_b16 v[44:45], v25 offset:18432
    ds_read_b64_tr_b16 v[46:47], v25 offset:18944
    s_add_u32 m0, s58, 29184
    s_nop 0
    buffer_load_dwordx4 v28, s[16:19], s56 offen lds
    s_waitcnt lgkmcnt(10)
    v_mfma_f32_32x32x16_bf16 v[64:79], v[56:59], v[156:159], v[64:79]
    ds_read_b64_tr_b16 v[48:49], v24 offset:20480
    ds_read_b64_tr_b16 v[50:51], v24 offset:20992
    s_waitcnt lgkmcnt(10)
    v_mfma_f32_32x32x16_bf16 v[80:95], v[60:63], v[156:159], v[80:95]
    ds_read_b64_tr_b16 v[52:53], v25 offset:20480
    ds_read_b64_tr_b16 v[54:55], v25 offset:20992
    s_waitcnt lgkmcnt(10)
    v_mfma_f32_32x32x16_bf16 v[64:79], v[32:35], v[160:163], v[64:79]
    ds_read_b64_tr_b16 v[56:57], v24 offset:22528
    ds_read_b64_tr_b16 v[58:59], v24 offset:23040
    s_add_u32 m0, s58, 30208
    s_nop 0
    buffer_load_dwordx4 v29, s[16:19], s56 offen lds
    s_waitcnt lgkmcnt(10)
    v_mfma_f32_32x32x16_bf16 v[80:95], v[36:39], v[160:163], v[80:95]
    ds_read_b64_tr_b16 v[60:61], v25 offset:22528
    ds_read_b64_tr_b16 v[62:63], v25 offset:23040
    s_waitcnt lgkmcnt(10)
    v_mfma_f32_32x32x16_bf16 v[64:79], v[40:43], v[164:167], v[64:79]
    ds_read_b64_tr_b16 v[32:33], v24 offset:24576
    ds_read_b64_tr_b16 v[34:35], v24 offset:25088
    s_waitcnt lgkmcnt(10)
    v_mfma_f32_32x32x16_bf16 v[80:95], v[44:47], v[164:167], v[80:95]
    ds_read_b64_tr_b16 v[36:37], v25 offset:24576
    ds_read_b64_tr_b16 v[38:39], v25 offset:25088
    s_add_u32 m0, s58, 31232
    s_nop 0
    buffer_load_dwordx4 v30, s[16:19], s56 offen lds
    s_waitcnt lgkmcnt(10)
    v_mfma_f32_32x32x16_bf16 v[64:79], v[48:51], v[168:171], v[64:79]
    ds_read_b64_tr_b16 v[40:41], v24 offset:26624
    ds_read_b64_tr_b16 v[42:43], v24 offset:27136
    s_waitcnt lgkmcnt(10)
    v_mfma_f32_32x32x16_bf16 v[80:95], v[52:55], v[168:171], v[80:95]
    ds_read_b64_tr_b16 v[44:45], v25 offset:26624
    ds_read_b64_tr_b16 v[46:47], v25 offset:27136
    s_waitcnt lgkmcnt(10)
    v_mfma_f32_32x32x16_bf16 v[64:79], v[56:59], v[172:175], v[64:79]
    ds_read_b64_tr_b16 v[48:49], v24 offset:28672
    ds_read_b64_tr_b16 v[50:51], v24 offset:29184
    s_add_u32 m0, s59, 29184
    s_nop 0
    buffer_load_dwordx4 v31, s[16:19], s56 offen lds
    s_add_u32 s56, s56, s57
    s_waitcnt lgkmcnt(10)
    v_mfma_f32_32x32x16_bf16 v[80:95], v[60:63], v[172:175], v[80:95]
    ds_read_b64_tr_b16 v[52:53], v25 offset:28672
    ds_read_b64_tr_b16 v[54:55], v25 offset:29184
    s_waitcnt lgkmcnt(10)
    v_mfma_f32_32x32x16_bf16 v[64:79], v[32:35], v[176:179], v[64:79]
    ds_read_b64_tr_b16 v[56:57], v24 offset:30720
    ds_read_b64_tr_b16 v[58:59], v24 offset:31232
    s_add_u32 s55, s41, 525312
    buffer_store_dwordx4 v[100:103], v1, s[8:11], s55 offen
    s_waitcnt lgkmcnt(10)
    v_mfma_f32_32x32x16_bf16 v[80:95], v[36:39], v[176:179], v[80:95]
    ds_read_b64_tr_b16 v[60:61], v25 offset:30720
    ds_read_b64_tr_b16 v[62:63], v25 offset:31232
    s_waitcnt lgkmcnt(10)
    v_mfma_f32_32x32x16_bf16 v[64:79], v[40:43], v[180:183], v[64:79]
    s_waitcnt lgkmcnt(8)
    v_mfma_f32_32x32x16_bf16 v[80:95], v[44:47], v[180:183], v[80:95]
    s_waitcnt vmcnt(11)
    s_waitcnt lgkmcnt(0)
    s_barrier
    ds_read_b64_tr_b16 v[32:33], v26 offset:0
    ds_read_b64_tr_b16 v[34:35], v26 offset:512
    v_mfma_f32_32x32x16_bf16 v[64:79], v[48:51], v[184:187], v[64:79]
    ds_read_b64_tr_b16 v[36:37], v27 offset:0
    ds_read_b64_tr_b16 v[38:39], v27 offset:512
    v_mfma_f32_32x32x16_bf16 v[80:95], v[52:55], v[184:187], v[80:95]
    ds_read_b64_tr_b16 v[40:41], v26 offset:2048
    ds_read_b64_tr_b16 v[42:43], v26 offset:2560
    v_mfma_f32_32x32x16_bf16 v[64:79], v[56:59], v[188:191], v[64:79]
    ds_read_b64_tr_b16 v[44:45], v27 offset:2048
    ds_read_b64_tr_b16 v[46:47], v27 offset:2560
    v_mfma_f32_32x32x16_bf16 v[80:95], v[60:63], v[188:191], v[80:95]
    ds_read_b64_tr_b16 v[48:49], v26 offset:4096
    ds_read_b64_tr_b16 v[50:51], v26 offset:4608
    ds_read_b64_tr_b16 v[52:53], v27 offset:4096
    ds_read_b64_tr_b16 v[54:55], v27 offset:4608
    s_waitcnt lgkmcnt(10)
    v_mfma_f32_32x32x16_bf16 v[64:79], v[32:35], v[192:195], v[64:79]
    ds_read_b64_tr_b16 v[56:57], v26 offset:6144
    ds_read_b64_tr_b16 v[58:59], v26 offset:6656
    s_waitcnt lgkmcnt(10)
    v_mfma_f32_32x32x16_bf16 v[80:95], v[36:39], v[192:195], v[80:95]
    ds_read_b64_tr_b16 v[60:61], v27 offset:6144
    ds_read_b64_tr_b16 v[62:63], v27 offset:6656
    s_add_u32 s61, s60, 0
    buffer_load_dwordx4 v[128:131], v1, s[8:11], s61 offen offset:0 sc1
    s_waitcnt lgkmcnt(10)
    v_mfma_f32_32x32x16_bf16 v[64:79], v[40:43], v[196:199], v[64:79]
    ds_read_b64_tr_b16 v[32:33], v26 offset:8192
    ds_read_b64_tr_b16 v[34:35], v26 offset:8704
    s_waitcnt lgkmcnt(10)
    v_mfma_f32_32x32x16_bf16 v[80:95], v[44:47], v[196:199], v[80:95]
    ds_read_b64_tr_b16 v[36:37], v27 offset:8192
    ds_read_b64_tr_b16 v[38:39], v27 offset:8704
    s_waitcnt lgkmcnt(10)
    v_mfma_f32_32x32x16_bf16 v[64:79], v[48:51], v[200:203], v[64:79]
    ds_read_b64_tr_b16 v[40:41], v26 offset:10240
    ds_read_b64_tr_b16 v[42:43], v26 offset:10752
    buffer_load_dwordx4 v[132:135], v1, s[8:11], s61 offen offset:1024 sc1
    s_waitcnt lgkmcnt(10)
    v_mfma_f32_32x32x16_bf16 v[80:95], v[52:55], v[200:203], v[80:95]
    ds_read_b64_tr_b16 v[44:45], v27 offset:10240
    ds_read_b64_tr_b16 v[46:47], v27 offset:10752
    s_waitcnt lgkmcnt(10)
    v_mfma_f32_32x32x16_bf16 v[64:79], v[56:59], v[204:207], v[64:79]
    ds_read_b64_tr_b16 v[48:49], v26 offset:12288
    ds_read_b64_tr_b16 v[50:51], v26 offset:12800
    s_waitcnt lgkmcnt(10)
    v_mfma_f32_32x32x16_bf16 v[80:95], v[60:63], v[204:207], v[80:95]
    ds_read_b64_tr_b16 v[52:53], v27 offset:12288
    ds_read_b64_tr_b16 v[54:55], v27 offset:12800
    s_waitcnt lgkmcnt(10)
    v_mfma_f32_32x32x16_bf16 v[64:79], v[32:35], v[208:211], v[64:79]
    ds_read_b64_tr_b16 v[56:57], v26 offset:14336
    ds_read_b64_tr_b16 v[58:59], v26 offset:14848
    buffer_load_dwordx4 v[136:139], v1, s[8:11], s61 offen offset:2048 sc1
    s_waitcnt lgkmcnt(10)
    v_mfma_f32_32x32x16_bf16 v[80:95], v[36:39], v[208:211], v[80:95]
    ds_read_b64_tr_b16 v[60:61], v27 offset:14336
    ds_read_b64_tr_b16 v[62:63], v27 offset:14848
    s_waitcnt lgkmcnt(10)
    v_mfma_f32_32x32x16_bf16 v[64:79], v[40:43], v[212:215], v[64:79]
    ds_read_b64_tr_b16 v[32:33], v26 offset:16384
    ds_read_b64_tr_b16 v[34:35], v26 offset:16896
    s_waitcnt lgkmcnt(10)
    v_mfma_f32_32x32x16_bf16 v[80:95], v[44:47], v[212:215], v[80:95]
    ds_read_b64_tr_b16 v[36:37], v27 offset:16384
    ds_read_b64_tr_b16 v[38:39], v27 offset:16896
    buffer_load_dwordx4 v[140:143], v1, s[8:11], s61 offen offset:3072 sc1
    s_waitcnt lgkmcnt(10)
    v_mfma_f32_32x32x16_bf16 v[64:79], v[48:51], v[216:219], v[64:79]
    ds_read_b64_tr_b16 v[40:41], v26 offset:18432
    ds_read_b64_tr_b16 v[42:43], v26 offset:18944
    s_add_u32 s55, s41, 526336
    buffer_store_dwordx4 v[104:107], v1, s[8:11], s55 offen
    s_waitcnt lgkmcnt(10)
    v_mfma_f32_32x32x16_bf16 v[80:95], v[52:55], v[216:219], v[80:95]
    ds_read_b64_tr_b16 v[44:45], v27 offset:18432
    ds_read_b64_tr_b16 v[46:47], v27 offset:18944
    s_waitcnt lgkmcnt(10)
    v_mfma_f32_32x32x16_bf16 v[64:79], v[56:59], v[220:223], v[64:79]
    ds_read_b64_tr_b16 v[48:49], v26 offset:20480
    ds_read_b64_tr_b16 v[50:51], v26 offset:20992
    s_waitcnt lgkmcnt(10)
    v_mfma_f32_32x32x16_bf16 v[80:95], v[60:63], v[220:223], v[80:95]
    ds_read_b64_tr_b16 v[52:53], v27 offset:20480
    ds_read_b64_tr_b16 v[54:55], v27 offset:20992
    s_add_u32 m0, s58, 131072
    s_nop 0
    buffer_load_dwordx4 v28, s[16:19], s56 offen lds
    s_waitcnt lgkmcnt(10)
    v_mfma_f32_32x32x16_bf16 v[64:79], v[32:35], v[224:227], v[64:79]
    ds_read_b64_tr_b16 v[56:57], v26 offset:22528
    ds_read_b64_tr_b16 v[58:59], v26 offset:23040
    s_waitcnt lgkmcnt(10)
    v_mfma_f32_32x32x16_bf16 v[80:95], v[36:39], v[224:227], v[80:95]
    ds_read_b64_tr_b16 v[60:61], v27 offset:22528
    ds_read_b64_tr_b16 v[62:63], v27 offset:23040
    s_waitcnt lgkmcnt(10)
    v_mfma_f32_32x32x16_bf16 v[64:79], v[40:43], v[228:231], v[64:79]
    ds_read_b64_tr_b16 v[32:33], v26 offset:24576
    ds_read_b64_tr_b16 v[34:35], v26 offset:25088
    s_add_u32 m0, s58, 132096
    s_nop 0
    buffer_load_dwordx4 v29, s[16:19], s56 offen lds
    s_waitcnt lgkmcnt(10)
    v_mfma_f32_32x32x16_bf16 v[80:95], v[44:47], v[228:231], v[80:95]
    ds_read_b64_tr_b16 v[36:37], v27 offset:24576
    ds_read_b64_tr_b16 v[38:39], v27 offset:25088
    s_waitcnt lgkmcnt(10)
    v_mfma_f32_32x32x16_bf16 v[64:79], v[48:51], v[232:235], v[64:79]
    ds_read_b64_tr_b16 v[40:41], v26 offset:26624
    ds_read_b64_tr_b16 v[42:43], v26 offset:27136
    s_waitcnt lgkmcnt(10)
    v_mfma_f32_32x32x16_bf16 v[80:95], v[52:55], v[232:235], v[80:95]
    ds_read_b64_tr_b16 v[44:45], v27 offset:26624
    ds_read_b64_tr_b16 v[46:47], v27 offset:27136
    s_waitcnt lgkmcnt(10)
    v_mfma_f32_32x32x16_bf16 v[64:79], v[56:59], v[236:239], v[64:79]
    ds_read_b64_tr_b16 v[48:49], v26 offset:28672
    ds_read_b64_tr_b16 v[50:51], v26 offset:29184
    s_add_u32 m0, s58, 133120
    s_nop 0
    buffer_load_dwordx4 v30, s[16:19], s56 offen lds
    s_waitcnt lgkmcnt(10)
    v_mfma_f32_32x32x16_bf16 v[80:95], v[60:63], v[236:239], v[80:95]
    ds_read_b64_tr_b16 v[52:53], v27 offset:28672
    ds_read_b64_tr_b16 v[54:55], v27 offset:29184
    s_waitcnt lgkmcnt(10)
    v_mfma_f32_32x32x16_bf16 v[64:79], v[32:35], v[240:243], v[64:79]
    ds_read_b64_tr_b16 v[56:57], v26 offset:30720
    ds_read_b64_tr_b16 v[58:59], v26 offset:31232
    s_add_u32 s55, s41, 527360
    buffer_store_dwordx4 v[108:111], v1, s[8:11], s55 offen
    s_waitcnt lgkmcnt(10)
    v_mfma_f32_32x32x16_bf16 v[80:95], v[36:39], v[240:243], v[80:95]
    ds_read_b64_tr_b16 v[60:61], v27 offset:30720
    ds_read_b64_tr_b16 v[62:63], v27 offset:31232
    s_add_u32 m0, s59, 131072
    s_nop 0
    buffer_load_dwordx4 v31, s[16:19], s56 offen lds
    s_add_u32 s56, s56, s57
    s_waitcnt lgkmcnt(10)
    v_mfma_f32_32x32x16_bf16 v[64:79], v[40:43], v[244:247], v[64:79]
    s_waitcnt lgkmcnt(8)
    v_mfma_f32_32x32x16_bf16 v[80:95], v[44:47], v[244:247], v[80:95]
    s_waitcnt lgkmcnt(6)
    v_mfma_f32_32x32x16_bf16 v[64:79], v[48:51], v[248:251], v[64:79]
    s_waitcnt lgkmcnt(4)
    v_mfma_f32_32x32x16_bf16 v[80:95], v[52:55], v[248:251], v[80:95]
    s_waitcnt lgkmcnt(2)
    v_mfma_f32_32x32x16_bf16 v[64:79], v[56:59], v[252:255], v[64:79]
    s_waitcnt lgkmcnt(0)
    v_mfma_f32_32x32x16_bf16 v[80:95], v[60:63], v[252:255], v[80:95]
    s_nop 9
    v_cvt_pk_bf16_f32 v32, v64, v65
    v_cvt_pk_bf16_f32 v33, v66, v67
    v_cvt_pk_bf16_f32 v34, v68, v69
    v_cvt_pk_bf16_f32 v35, v70, v71
    v_cvt_pk_bf16_f32 v36, v72, v73
    v_cvt_pk_bf16_f32 v37, v74, v75
    v_cvt_pk_bf16_f32 v38, v76, v77
    v_cvt_pk_bf16_f32 v39, v78, v79
    v_cvt_pk_bf16_f32 v40, v80, v81
    v_cvt_pk_bf16_f32 v41, v82, v83
    v_cvt_pk_bf16_f32 v42, v84, v85
    v_cvt_pk_bf16_f32 v43, v86, v87
    v_cvt_pk_bf16_f32 v44, v88, v89
    v_cvt_pk_bf16_f32 v45, v90, v91
    v_cvt_pk_bf16_f32 v46, v92, v93
    v_cvt_pk_bf16_f32 v47, v94, v95
    s_branch LF_p2
LF_v:
    ds_read_b64_tr_b16 v[32:33], v20 offset:0
    ds_read_b64_tr_b16 v[34:35], v20 offset:512
    ds_read_b64_tr_b16 v[36:37], v21 offset:0
    ds_read_b64_tr_b16 v[38:39], v21 offset:512
    ds_read_b64_tr_b16 v[40:41], v20 offset:2048
    ds_read_b64_tr_b16 v[42:43], v20 offset:2560
    ds_read_b64_tr_b16 v[44:45], v21 offset:2048
    ds_read_b64_tr_b16 v[46:47], v21 offset:2560
    ds_read_b64_tr_b16 v[48:49], v20 offset:4096
    ds_read_b64_tr_b16 v[50:51], v20 offset:4608
    ds_read_b64_tr_b16 v[52:53], v21 offset:4096
    ds_read_b64_tr_b16 v[54:55], v21 offset:4608
    s_waitcnt lgkmcnt(10)
    v_mfma_f32_32x32x16_bf16 v[64:79], v[128:131], v[32:35], 0
    ds_read_b64_tr_b16 v[56:57], v20 offset:6144
    ds_read_b64_tr_b16 v[58:59], v20 offset:6656
    s_waitcnt lgkmcnt(10)
    v_mfma_f32_32x32x16_bf16 v[80:95], v[128:131], v[36:39], 0
    ds_read_b64_tr_b16 v[60:61], v21 offset:6144
    ds_read_b64_tr_b16 v[62:63], v21 offset:6656
    s_waitcnt vmcnt(13)
    ds_read_b128 v[144:147], v16 offset:4096
    ds_read_b128 v[148:151], v17 offset:4096
    s_waitcnt lgkmcnt(12)
    v_mfma_f32_32x32x16_bf16 v[64:79], v[132:135], v[40:43], v[64:79]
    ds_read_b64_tr_b16 v[32:33], v20 offset:8192
    ds_read_b64_tr_b16 v[34:35], v20 offset:8704
    ds_read_b128 v[152:155], v18 offset:4096
    ds_read_b128 v[156:159], v19 offset:4096
    s_waitcnt lgkmcnt(14)
    v_mfma_f32_32x32x16_bf16 v[80:95], v[132:135], v[44:47], v[80:95]
    ds_read_b64_tr_b16 v[36:37], v21 offset:8192
    ds_read_b64_tr_b16 v[38:39], v21 offset:8704
    s_waitcnt lgkmcnt(14)
    v_mfma_f32_32x32x16_bf16 v[64:79], v[136:139], v[48:51], v[64:79]
    ds_read_b64_tr_b16 v[40:41], v20 offset:10240
    ds_read_b64_tr_b16 v[42:43], v20 offset:10752
    s_lshl_b32 s3, s50, 6
    s_lshl_b32 s54, s20, 4
    s_add_u32 s3, s3, s54
    s_lshl_b32 s3, s3, 13
    s_lshl_b32 s54, s51, 1
    s_add_u32 s3, s3, s54
    s_cmp_ge_u32 s20, 4
    s_cselect_b32 s3, 0x7f000000, s3
    buffer_load_dword v127, v15, s[4:7], s3 offen
    s_waitcnt lgkmcnt(14)
    v_mfma_f32_32x32x16_bf16 v[80:95], v[136:139], v[52:55], v[80:95]
    ds_read_b64_tr_b16 v[44:45], v21 offset:10240
    ds_read_b64_tr_b16 v[46:47], v21 offset:10752
    s_waitcnt lgkmcnt(6)
    s_add_u32 m0, s52, 4096
    s_add_u32 s54, s40, 384
    buffer_load_dwordx4 v2, s[12:15], s54 offen lds
    s_add_u32 m0, s52, 5120
    s_add_u32 s54, s40, 8576
    buffer_load_dwordx4 v3, s[12:15], s54 offen lds
    v_mfma_f32_32x32x16_bf16 v[64:79], v[140:143], v[56:59], v[64:79]
    ds_read_b64_tr_b16 v[48:49], v20 offset:12288
    ds_read_b64_tr_b16 v[50:51], v20 offset:12800
    s_add_u32 m0, s52, 6144
    s_add_u32 s54, s40, 16768
    buffer_load_dwordx4 v2, s[12:15], s54 offen lds
    s_add_u32 m0, s52, 7168
    s_add_u32 s54, s40, 24960
    buffer_load_dwordx4 v3, s[12:15], s54 offen lds
    v_mfma_f32_32x32x16_bf16 v[80:95], v[140:143], v[60:63], v[80:95]
    ds_read_b64_tr_b16 v[52:53], v21 offset:12288
    ds_read_b64_tr_b16 v[54:55], v21 offset:12800
    v_mfma_f32_32x32x16_bf16 v[64:79], v[144:147], v[32:35], v[64:79]
    ds_read_b64_tr_b16 v[56:57], v20 offset:14336
    ds_read_b64_tr_b16 v[58:59], v20 offset:14848
    s_waitcnt lgkmcnt(10)
    v_mfma_f32_32x32x16_bf16 v[80:95], v[144:147], v[36:39], v[80:95]
    ds_read_b64_tr_b16 v[60:61], v21 offset:14336
    ds_read_b64_tr_b16 v[62:63], v21 offset:14848
    s_waitcnt vmcnt(5)
    ds_read_b128 v[160:163], v16 offset:0
    ds_read_b128 v[164:167], v17 offset:0
    s_waitcnt lgkmcnt(12)
    v_mfma_f32_32x32x16_bf16 v[64:79], v[148:151], v[40:43], v[64:79]
    ds_read_b64_tr_b16 v[32:33], v20 offset:16384
    ds_read_b64_tr_b16 v[34:35], v20 offset:16896
    ds_read_b128 v[168:171], v18 offset:0
    ds_read_b128 v[172:175], v19 offset:0
    s_waitcnt lgkmcnt(14)
    v_mfma_f32_32x32x16_bf16 v[80:95], v[148:151], v[44:47], v[80:95]
    ds_read_b64_tr_b16 v[36:37], v21 offset:16384
    ds_read_b64_tr_b16 v[38:39], v21 offset:16896
    s_waitcnt lgkmcnt(14)
    v_mfma_f32_32x32x16_bf16 v[64:79], v[152:155], v[48:51], v[64:79]
    ds_read_b64_tr_b16 v[40:41], v20 offset:18432
    ds_read_b64_tr_b16 v[42:43], v20 offset:18944
    s_waitcnt lgkmcnt(14)
    v_mfma_f32_32x32x16_bf16 v[80:95], v[152:155], v[52:55], v[80:95]
    ds_read_b64_tr_b16 v[44:45], v21 offset:18432
    ds_read_b64_tr_b16 v[46:47], v21 offset:18944
    s_waitcnt lgkmcnt(6)
    s_add_u32 m0, s52, 0
    s_add_u32 s54, s40, 512
    buffer_load_dwordx4 v2, s[12:15], s54 offen lds
    s_add_u32 m0, s52, 1024
    s_add_u32 s54, s40, 8704
    buffer_load_dwordx4 v3, s[12:15], s54 offen lds
    v_mfma_f32_32x32x16_bf16 v[64:79], v[156:159], v[56:59], v[64:79]
    ds_read_b64_tr_b16 v[48:49], v20 offset:20480
    ds_read_b64_tr_b16 v[50:51], v20 offset:20992
    s_add_u32 m0, s52, 2048
    s_add_u32 s54, s40, 16896
    buffer_load_dwordx4 v2, s[12:15], s54 offen lds
    s_add_u32 m0, s52, 3072
    s_add_u32 s54, s40, 25088
    buffer_load_dwordx4 v3, s[12:15], s54 offen lds
    v_mfma_f32_32x32x16_bf16 v[80:95], v[156:159], v[60:63], v[80:95]
    ds_read_b64_tr_b16 v[52:53], v21 offset:20480
    ds_read_b64_tr_b16 v[54:55], v21 offset:20992
    v_mfma_f32_32x32x16_bf16 v[64:79], v[160:163], v[32:35], v[64:79]
    ds_read_b64_tr_b16 v[56:57], v20 offset:22528
    ds_read_b64_tr_b16 v[58:59], v20 offset:23040
    s_waitcnt lgkmcnt(10)
    v_mfma_f32_32x32x16_bf16 v[80:95], v[160:163], v[36:39], v[80:95]
    ds_read_b64_tr_b16 v[60:61], v21 offset:22528
    ds_read_b64_tr_b16 v[62:63], v21 offset:23040
    s_waitcnt vmcnt(4)
    ds_read_b128 v[176:179], v16 offset:4096
    ds_read_b128 v[180:183], v17 offset:4096
    s_waitcnt lgkmcnt(12)
    v_mfma_f32_32x32x16_bf16 v[64:79], v[164:167], v[40:43], v[64:79]
    ds_read_b64_tr_b16 v[32:33], v20 offset:24576
    ds_read_b64_tr_b16 v[34:35], v20 offset:25088
    ds_read_b128 v[184:187], v18 offset:4096
    ds_read_b128 v[188:191], v19 offset:4096
    s_waitcnt lgkmcnt(14)
    v_mfma_f32_32x32x16_bf16 v[80:95], v[164:167], v[44:47], v[80:95]
    ds_read_b64_tr_b16 v[36:37], v21 offset:24576
    ds_read_b64_tr_b16 v[38:39], v21 offset:25088
    s_waitcnt lgkmcnt(14)
    v_mfma_f32_32x32x16_bf16 v[64:79], v[168:171], v[48:51], v[64:79]
    ds_read_b64_tr_b16 v[40:41], v20 offset:26624
    ds_read_b64_tr_b16 v[42:43], v20 offset:27136
    s_waitcnt lgkmcnt(14)
    v_mfma_f32_32x32x16_bf16 v[80:95], v[168:171], v[52:55], v[80:95]
    ds_read_b64_tr_b16 v[44:45], v21 offset:26624
    ds_read_b64_tr_b16 v[46:47], v21 offset:27136
    s_waitcnt lgkmcnt(6)
    s_add_u32 m0, s52, 4096
    s_add_u32 s54, s40, 640
    buffer_load_dwordx4 v2, s[12:15], s54 offen lds
    s_add_u32 m0, s52, 5120
    s_add_u32 s54, s40, 8832
    buffer_load_dwordx4 v3, s[12:15], s54 offen lds
    v_mfma_f32_32x32x16_bf16 v[64:79], v[172:175], v[56:59], v[64:79]
    ds_read_b64_tr_b16 v[48:49], v20 offset:28672
    ds_read_b64_tr_b16 v[50:51], v20 offset:29184
    s_add_u32 m0, s52, 6144
    s_add_u32 s54, s40, 17024
    buffer_load_dwordx4 v2, s[12:15], s54 offen lds
    s_add_u32 m0, s52, 7168
    s_add_u32 s54, s40, 25216
    buffer_load_dwordx4 v3, s[12:15], s54 offen lds
    v_mfma_f32_32x32x16_bf16 v[80:95], v[172:175], v[60:63], v[80:95]
    ds_read_b64_tr_b16 v[52:53], v21 offset:28672
    ds_read_b64_tr_b16 v[54:55], v21 offset:29184
    v_mfma_f32_32x32x16_bf16 v[64:79], v[176:179], v[32:35], v[64:79]
    ds_read_b64_tr_b16 v[56:57], v20 offset:30720
    ds_read_b64_tr_b16 v[58:59], v20 offset:31232
    s_waitcnt lgkmcnt(10)
    v_mfma_f32_32x32x16_bf16 v[80:95], v[176:179], v[36:39], v[80:95]
    ds_read_b64_tr_b16 v[60:61], v21 offset:30720
    ds_read_b64_tr_b16 v[62:63], v21 offset:31232
    s_waitcnt vmcnt(4)
    ds_read_b128 v[192:195], v16 offset:0
    ds_read_b128 v[196:199], v17 offset:0
    s_waitcnt lgkmcnt(12)
    v_mfma_f32_32x32x16_bf16 v[64:79], v[180:183], v[40:43], v[64:79]
    ds_read_b128 v[200:203], v18 offset:0
    ds_read_b128 v[204:207], v19 offset:0
    s_waitcnt lgkmcnt(12)
    v_mfma_f32_32x32x16_bf16 v[80:95], v[180:183], v[44:47], v[80:95]
    s_waitcnt lgkmcnt(0)
    s_barrier
    ds_read_b64_tr_b16 v[32:33], v22 offset:0
    ds_read_b64_tr_b16 v[34:35], v22 offset:512
    v_mfma_f32_32x32x16_bf16 v[64:79], v[184:187], v[48:51], v[64:79]
    ds_read_b64_tr_b16 v[36:37], v23 offset:0
    ds_read_b64_tr_b16 v[38:39], v23 offset:512
    v_mfma_f32_32x32x16_bf16 v[80:95], v[184:187], v[52:55], v[80:95]
    s_add_u32 m0, s52, 0
    s_add_u32 s54, s40, 768
    buffer_load_dwordx4 v2, s[12:15], s54 offen lds
    s_add_u32 m0, s52, 1024
    s_add_u32 s54, s40, 8960
    buffer_load_dwordx4 v3, s[12:15], s54 offen lds
    ds_read_b64_tr_b16 v[40:41], v22 offset:2048
    ds_read_b64_tr_b16 v[42:43], v22 offset:2560
    v_mfma_f32_32x32x16_bf16 v[64:79], v[188:191], v[56:59], v[64:79]
    s_add_u32 m0, s52, 2048
    s_add_u32 s54, s40, 17152
    buffer_load_dwordx4 v2, s[12:15], s54 offen lds
    s_add_u32 m0, s52, 3072
    s_add_u32 s54, s40, 25344
    buffer_load_dwordx4 v3, s[12:15], s54 offen lds
    ds_read_b64_tr_b16 v[44:45], v23 offset:2048
    ds_read_b64_tr_b16 v[46:47], v23 offset:2560
    v_mfma_f32_32x32x16_bf16 v[80:95], v[188:191], v[60:63], v[80:95]
    ds_read_b64_tr_b16 v[48:49], v22 offset:4096
    ds_read_b64_tr_b16 v[50:51], v22 offset:4608
    ds_read_b64_tr_b16 v[52:53], v23 offset:4096
    ds_read_b64_tr_b16 v[54:55], v23 offset:4608
    s_waitcnt lgkmcnt(10)
    v_mfma_f32_32x32x16_bf16 v[64:79], v[192:195], v[32:35], v[64:79]
    ds_read_b64_tr_b16 v[56:57], v22 offset:6144
    ds_read_b64_tr_b16 v[58:59], v22 offset:6656
    s_waitcnt lgkmcnt(10)
    v_mfma_f32_32x32x16_bf16 v[80:95], v[192:195], v[36:39], v[80:95]
    ds_read_b64_tr_b16 v[60:61], v23 offset:6144
    ds_read_b64_tr_b16 v[62:63], v23 offset:6656
    s_waitcnt vmcnt(4)
    ds_read_b128 v[208:211], v16 offset:4096
    ds_read_b128 v[212:215], v17 offset:4096
    v_lshlrev_b32 v100, 16, v96
    v_and_b32 v101, 0xffff0000, v96
    v_lshlrev_b32 v102, 16, v97
    v_and_b32 v103, 0xffff0000, v97
    v_lshlrev_b32 v104, 16, v98
    v_and_b32 v105, 0xffff0000, v98
    s_waitcnt lgkmcnt(12)
    v_mfma_f32_32x32x16_bf16 v[64:79], v[196:199], v[40:43], v[64:79]
    ds_read_b64_tr_b16 v[32:33], v22 offset:8192
    ds_read_b64_tr_b16 v[34:35], v22 offset:8704
    ds_read_b128 v[216:219], v18 offset:4096
    ds_read_b128 v[220:223], v19 offset:4096
    v_lshlrev_b32 v106, 16, v99
    v_and_b32 v107, 0xffff0000, v99
    v_add_f32 v116, v100, v101
    s_waitcnt lgkmcnt(14)
    v_mfma_f32_32x32x16_bf16 v[80:95], v[196:199], v[44:47], v[80:95]
    ds_read_b64_tr_b16 v[36:37], v23 offset:8192
    ds_read_b64_tr_b16 v[38:39], v23 offset:8704
    v_add_f32 v116, v116, v102
    v_add_f32 v116, v116, v103
    v_add_f32 v116, v116, v104
    s_waitcnt lgkmcnt(14)
    v_mfma_f32_32x32x16_bf16 v[64:79], v[200:203], v[48:51], v[64:79]
    ds_read_b64_tr_b16 v[40:41], v22 offset:10240
    ds_read_b64_tr_b16 v[42:43], v22 offset:10752
    v_add_f32 v116, v116, v105
    v_add_f32 v116, v116, v106
    v_add_f32 v116, v116, v107
    s_nop 1
    v_add_f32_dpp v116, v116, v116 quad_perm:[1,0,3,2] row_mask:0xf bank_mask:0xf
    s_nop 1
    v_add_f32_dpp v116, v116, v116 quad_perm:[2,3,0,1] row_mask:0xf bank_mask:0xf
    s_nop 1
    v_add_f32_dpp v116, v116, v116 row_half_mirror row_mask:0xf bank_mask:0xf
    s_waitcnt lgkmcnt(14)
    v_mfma_f32_32x32x16_bf16 v[80:95], v[200:203], v[52:55], v[80:95]
    ds_read_b64_tr_b16 v[44:45], v23 offset:10240
    ds_read_b64_tr_b16 v[46:47], v23 offset:10752
    s_waitcnt lgkmcnt(6)
    s_add_u32 m0, s52, 4096
    s_add_u32 s54, s40, 896
    buffer_load_dwordx4 v2, s[12:15], s54 offen lds
    s_add_u32 m0, s52, 5120
    s_add_u32 s54, s40, 9088
    buffer_load_dwordx4 v3, s[12:15], s54 offen lds
    v_add_f32_dpp v116, v116, v116 row_mirror row_mask:0xf bank_mask:0xf
    v_mov_b32 v117, v116
    s_nop 1
    v_permlane16_swap_b32 v116, v117
    v_mfma_f32_32x32x16_bf16 v[64:79], v[204:207], v[56:59], v[64:79]
    ds_read_b64_tr_b16 v[48:49], v22 offset:12288
    ds_read_b64_tr_b16 v[50:51], v22 offset:12800
    s_add_u32 m0, s52, 6144
    s_add_u32 s54, s40, 17280
    buffer_load_dwordx4 v2, s[12:15], s54 offen lds
    s_add_u32 m0, s52, 7168
    s_add_u32 s54, s40, 25472
    buffer_load_dwordx4 v3, s[12:15], s54 offen lds
    v_add_f32 v116, v116, v117
    v_mov_b32 v117, v116
    s_nop 1
    v_permlane32_swap_b32 v116, v117
    v_mfma_f32_32x32x16_bf16 v[80:95], v[204:207], v[60:63], v[80:95]
    ds_read_b64_tr_b16 v[52:53], v23 offset:12288
    ds_read_b64_tr_b16 v[54:55], v23 offset:12800
    v_add_f32 v116, v116, v117
    v_mul_f32 v116, 0x3b000000, v116
    v_sub_f32 v108, v100, v116
    v_sub_f32 v109, v101, v116
    v_sub_f32 v110, v102, v116
    v_sub_f32 v111, v103, v116
    v_mfma_f32_32x32x16_bf16 v[64:79], v[208:211], v[32:35], v[64:79]
    ds_read_b64_tr_b16 v[56:57], v22 offset:14336
    ds_read_b64_tr_b16 v[58:59], v22 offset:14848
    v_sub_f32 v112, v104, v116
    v_sub_f32 v113, v105, v116
    v_sub_f32 v114, v106, v116
    s_waitcnt lgkmcnt(10)
    v_mfma_f32_32x32x16_bf16 v[80:95], v[208:211], v[36:39], v[80:95]
    ds_read_b64_tr_b16 v[60:61], v23 offset:14336
    ds_read_b64_tr_b16 v[62:63], v23 offset:14848
    s_waitcnt vmcnt(4)
    ds_read_b128 v[224:227], v16 offset:0
    ds_read_b128 v[228:231], v17 offset:0
    v_sub_f32 v115, v107, v116
    v_mul_f32 v118, v108, v108
    v_fmac_f32 v118, v109, v109
    s_waitcnt lgkmcnt(12)
    v_mfma_f32_32x32x16_bf16 v[64:79], v[212:215], v[40:43], v[64:79]
    ds_read_b64_tr_b16 v[32:33], v22 offset:16384
    ds_read_b64_tr_b16 v[34:35], v22 offset:16896
    ds_read_b128 v[232:235], v18 offset:0
    ds_read_b128 v[236:239], v19 offset:0
    v_fmac_f32 v118, v110, v110
    v_fmac_f32 v118, v111, v111
    v_fmac_f32 v118, v112, v112
    v_fmac_f32 v118, v113, v113
    v_fmac_f32 v118, v114, v114
    v_fmac_f32 v118, v115, v115
    s_waitcnt lgkmcnt(14)
    v_mfma_f32_32x32x16_bf16 v[80:95], v[212:215], v[44:47], v[80:95]
    ds_read_b64_tr_b16 v[36:37], v23 offset:16384
    ds_read_b64_tr_b16 v[38:39], v23 offset:16896
    v_add_f32_dpp v118, v118, v118 quad_perm:[1,0,3,2] row_mask:0xf bank_mask:0xf
    s_nop 1
    v_add_f32_dpp v118, v118, v118 quad_perm:[2,3,0,1] row_mask:0xf bank_mask:0xf
    s_nop 1
    v_add_f32_dpp v118, v118, v118 row_half_mirror row_mask:0xf bank_mask:0xf
    s_waitcnt lgkmcnt(14)
    v_mfma_f32_32x32x16_bf16 v[64:79], v[216:219], v[48:51], v[64:79]
    ds_read_b64_tr_b16 v[40:41], v22 offset:18432
    ds_read_b64_tr_b16 v[42:43], v22 offset:18944
    v_add_f32_dpp v118, v118, v118 row_mirror row_mask:0xf bank_mask:0xf
    v_mov_b32 v117, v118
    s_nop 1
    v_permlane16_swap_b32 v118, v117
    s_waitcnt lgkmcnt(14)
    v_mfma_f32_32x32x16_bf16 v[80:95], v[216:219], v[52:55], v[80:95]
    ds_read_b64_tr_b16 v[44:45], v23 offset:18432
    ds_read_b64_tr_b16 v[46:47], v23 offset:18944
    v_add_f32 v118, v118, v117
    v_mov_b32 v117, v118
    s_nop 1
    v_permlane32_swap_b32 v118, v117
    v_add_f32 v118, v118, v117
    v_mul_f32 v118, 0x3b000000, v118
    v_cvt_pk_bf16_f32 v119, v116, v118
    s_waitcnt lgkmcnt(14)
    v_mfma_f32_32x32x16_bf16 v[64:79], v[220:223], v[56:59], v[64:79]
    ds_read_b64_tr_b16 v[48:49], v22 offset:20480
    ds_read_b64_tr_b16 v[50:51], v22 offset:20992
    v_lshlrev_b32 v116, 16, v119
    v_and_b32 v118, 0xffff0000, v119
    v_add_f32 v118, 0x3727c5ac, v118
    s_waitcnt lgkmcnt(14)
    v_mfma_f32_32x32x16_bf16 v[80:95], v[220:223], v[60:63], v[80:95]
    ds_read_b64_tr_b16 v[52:53], v23 offset:20480
    ds_read_b64_tr_b16 v[54:55], v23 offset:20992
    v_cvt_pk_bf16_f32 v119, v118, v118
    v_lshlrev_b32 v118, 16, v119
    v_sqrt_f32 v118, v118
    s_waitcnt lgkmcnt(12)
    v_mfma_f32_32x32x16_bf16 v[64:79], v[224:227], v[32:35], v[64:79]
    ds_read_b64_tr_b16 v[56:57], v22 offset:22528
    ds_read_b64_tr_b16 v[58:59], v22 offset:23040
    v_cvt_pk_bf16_f32 v119, v118, v118
    v_lshlrev_b32 v118, 16, v119
    v_rcp_f32 v120, v118
    s_nop 0
    v_fma_f32 v121, -v118, v120, 1.0
    v_fma_f32 v120, v121, v120, v120
    v_sub_f32 v108, v100, v116
    s_waitcnt lgkmcnt(10)
    v_mfma_f32_32x32x16_bf16 v[80:95], v[224:227], v[36:39], v[80:95]
    ds_read_b64_tr_b16 v[60:61], v23 offset:22528
    ds_read_b64_tr_b16 v[62:63], v23 offset:23040
    s_waitcnt vmcnt(0)
    ds_read_b128 v[240:243], v16 offset:4096
    ds_read_b128 v[244:247], v17 offset:4096
    v_sub_f32 v109, v101, v116
    v_sub_f32 v110, v102, v116
    v_sub_f32 v111, v103, v116
    s_waitcnt lgkmcnt(12)
    v_mfma_f32_32x32x16_bf16 v[64:79], v[228:231], v[40:43], v[64:79]
    ds_read_b64_tr_b16 v[32:33], v22 offset:24576
    ds_read_b64_tr_b16 v[34:35], v22 offset:25088
    ds_read_b128 v[248:251], v18 offset:4096
    ds_read_b128 v[252:255], v19 offset:4096
    v_sub_f32 v112, v104, v116
    v_sub_f32 v113, v105, v116
    v_sub_f32 v114, v106, v116
    s_waitcnt lgkmcnt(14)
    v_mfma_f32_32x32x16_bf16 v[80:95], v[228:231], v[44:47], v[80:95]
    ds_read_b64_tr_b16 v[36:37], v23 offset:24576
    ds_read_b64_tr_b16 v[38:39], v23 offset:25088
    v_sub_f32 v115, v107, v116
    v_cvt_pk_bf16_f32 v100, v108, v109
    v_cvt_pk_bf16_f32 v101, v110, v111
    v_cvt_pk_bf16_f32 v102, v112, v113
    v_cvt_pk_bf16_f32 v103, v114, v115
    v_lshlrev_b32 v108, 16, v100
    s_waitcnt lgkmcnt(14)
    v_mfma_f32_32x32x16_bf16 v[64:79], v[232:235], v[48:51], v[64:79]
    ds_read_b64_tr_b16 v[40:41], v22 offset:26624
    ds_read_b64_tr_b16 v[42:43], v22 offset:27136
    v_and_b32 v109, 0xffff0000, v100
    v_lshlrev_b32 v110, 16, v101
    v_and_b32 v111, 0xffff0000, v101
    s_waitcnt lgkmcnt(14)
    v_mfma_f32_32x32x16_bf16 v[80:95], v[232:235], v[52:55], v[80:95]
    ds_read_b64_tr_b16 v[44:45], v23 offset:26624
    ds_read_b64_tr_b16 v[46:47], v23 offset:27136
    v_lshlrev_b32 v112, 16, v102
    v_and_b32 v113, 0xffff0000, v102
    v_lshlrev_b32 v114, 16, v103
    s_waitcnt lgkmcnt(14)
    v_mfma_f32_32x32x16_bf16 v[64:79], v[236:239], v[56:59], v[64:79]
    ds_read_b64_tr_b16 v[48:49], v22 offset:28672
    ds_read_b64_tr_b16 v[50:51], v22 offset:29184
    v_and_b32 v115, 0xffff0000, v103
    v_mul_f32 v108, v108, v120
    v_mul_f32 v109, v109, v120
    v_mul_f32 v110, v110, v120
    v_mul_f32 v111, v111, v120
    v_mul_f32 v112, v112, v120
    s_waitcnt lgkmcnt(14)
    v_mfma_f32_32x32x16_bf16 v[80:95], v[236:239], v[60:63], v[80:95]
    ds_read_b64_tr_b16 v[52:53], v23 offset:28672
    ds_read_b64_tr_b16 v[54:55], v23 offset:29184
    v_mul_f32 v113, v113, v120
    v_mul_f32 v114, v114, v120
    v_mul_f32 v115, v115, v120
    s_waitcnt lgkmcnt(12)
    v_mfma_f32_32x32x16_bf16 v[64:79], v[240:243], v[32:35], v[64:79]
    ds_read_b64_tr_b16 v[56:57], v22 offset:30720
    ds_read_b64_tr_b16 v[58:59], v22 offset:31232
    v_cvt_pk_bf16_f32 v96, v108, v109
    v_cvt_pk_bf16_f32 v97, v110, v111
    v_cvt_pk_bf16_f32 v98, v112, v113
    s_waitcnt lgkmcnt(10)
    v_mfma_f32_32x32x16_bf16 v[80:95], v[240:243], v[36:39], v[80:95]
    ds_read_b64_tr_b16 v[60:61], v23 offset:30720
    ds_read_b64_tr_b16 v[62:63], v23 offset:31232
    v_cvt_pk_bf16_f32 v99, v114, v115
    buffer_store_dwordx4 v[96:99], v5, s[8:11], s31 offen sc1
    s_waitcnt lgkmcnt(10)
    v_mfma_f32_32x32x16_bf16 v[64:79], v[244:247], v[40:43], v[64:79]
    s_waitcnt lgkmcnt(8)
    v_mfma_f32_32x32x16_bf16 v[80:95], v[244:247], v[44:47], v[80:95]
    s_waitcnt lgkmcnt(0)
    s_barrier
    ds_read_b64_tr_b16 v[32:33], v24 offset:0
    ds_read_b64_tr_b16 v[34:35], v24 offset:512
    v_mfma_f32_32x32x16_bf16 v[64:79], v[248:251], v[48:51], v[64:79]
    ds_read_b64_tr_b16 v[36:37], v25 offset:0
    ds_read_b64_tr_b16 v[38:39], v25 offset:512
    v_mfma_f32_32x32x16_bf16 v[80:95], v[248:251], v[52:55], v[80:95]
    ds_read_b64_tr_b16 v[40:41], v24 offset:2048
    ds_read_b64_tr_b16 v[42:43], v24 offset:2560
    v_mfma_f32_32x32x16_bf16 v[64:79], v[252:255], v[56:59], v[64:79]
    ds_read_b64_tr_b16 v[44:45], v25 offset:2048
    ds_read_b64_tr_b16 v[46:47], v25 offset:2560
    v_mfma_f32_32x32x16_bf16 v[80:95], v[252:255], v[60:63], v[80:95]
    ds_read_b64_tr_b16 v[48:49], v24 offset:4096
    ds_read_b64_tr_b16 v[50:51], v24 offset:4608
    ds_read_b64_tr_b16 v[52:53], v25 offset:4096
    ds_read_b64_tr_b16 v[54:55], v25 offset:4608
    s_nop 4
    v_cvt_pk_bf16_f32 v96, v64, v65
    v_cvt_pk_bf16_f32 v97, v66, v67
    v_cvt_pk_bf16_f32 v98, v68, v69
    v_cvt_pk_bf16_f32 v99, v70, v71
    v_cvt_pk_bf16_f32 v100, v72, v73
    v_cvt_pk_bf16_f32 v101, v74, v75
    v_cvt_pk_bf16_f32 v102, v76, v77
    v_cvt_pk_bf16_f32 v103, v78, v79
    s_waitcnt lgkmcnt(10)
    v_mfma_f32_32x32x16_bf16 v[64:79], v[128:131], v[32:35], 0
    ds_read_b64_tr_b16 v[56:57], v24 offset:6144
    ds_read_b64_tr_b16 v[58:59], v24 offset:6656
    v_cvt_pk_bf16_f32 v104, v80, v81
    v_cvt_pk_bf16_f32 v105, v82, v83
    v_cvt_pk_bf16_f32 v106, v84, v85
    v_cvt_pk_bf16_f32 v107, v86, v87
    v_cvt_pk_bf16_f32 v108, v88, v89
    v_cvt_pk_bf16_f32 v109, v90, v91
    v_cvt_pk_bf16_f32 v110, v92, v93
    v_cvt_pk_bf16_f32 v111, v94, v95
    s_waitcnt lgkmcnt(10)
    v_mfma_f32_32x32x16_bf16 v[80:95], v[128:131], v[36:39], 0
    ds_read_b64_tr_b16 v[60:61], v25 offset:6144
    ds_read_b64_tr_b16 v[62:63], v25 offset:6656
    s_waitcnt lgkmcnt(10)
    v_mfma_f32_32x32x16_bf16 v[64:79], v[132:135], v[40:43], v[64:79]
    ds_read_b64_tr_b16 v[32:33], v24 offset:8192
    ds_read_b64_tr_b16 v[34:35], v24 offset:8704
    s_add_u32 m0, s43, 65536
    s_add_u32 s53, s42, 2097280
    buffer_load_dwordx4 v4, s[4:7], s53 offen lds
    s_waitcnt lgkmcnt(10)
    v_mfma_f32_32x32x16_bf16 v[80:95], v[132:135], v[44:47], v[80:95]
    ds_read_b64_tr_b16 v[36:37], v25 offset:8192
    ds_read_b64_tr_b16 v[38:39], v25 offset:8704
    s_waitcnt lgkmcnt(10)
    v_mfma_f32_32x32x16_bf16 v[64:79], v[136:139], v[48:51], v[64:79]
    ds_read_b64_tr_b16 v[40:41], v24 offset:10240
    ds_read_b64_tr_b16 v[42:43], v24 offset:10752
    s_waitcnt lgkmcnt(10)
    v_mfma_f32_32x32x16_bf16 v[80:95], v[136:139], v[52:55], v[80:95]
    ds_read_b64_tr_b16 v[44:45], v25 offset:10240
    ds_read_b64_tr_b16 v[46:47], v25 offset:10752
    s_add_u32 m0, s43, 66560
    s_add_u32 s53, s42, 2162816
    buffer_load_dwordx4 v4, s[4:7], s53 offen lds
    s_waitcnt lgkmcnt(10)
    v_mfma_f32_32x32x16_bf16 v[64:79], v[140:143], v[56:59], v[64:79]
    ds_read_b64_tr_b16 v[48:49], v24 offset:12288
    ds_read_b64_tr_b16 v[50:51], v24 offset:12800
    s_waitcnt lgkmcnt(10)
    v_mfma_f32_32x32x16_bf16 v[80:95], v[140:143], v[60:63], v[80:95]
    ds_read_b64_tr_b16 v[52:53], v25 offset:12288
    ds_read_b64_tr_b16 v[54:55], v25 offset:12800
    s_waitcnt lgkmcnt(10)
    v_mfma_f32_32x32x16_bf16 v[64:79], v[144:147], v[32:35], v[64:79]
    ds_read_b64_tr_b16 v[56:57], v24 offset:14336
    ds_read_b64_tr_b16 v[58:59], v24 offset:14848
    s_add_u32 m0, s43, 67584
    s_add_u32 s53, s42, 2228352
    buffer_load_dwordx4 v4, s[4:7], s53 offen lds
    s_waitcnt lgkmcnt(10)
    v_mfma_f32_32x32x16_bf16 v[80:95], v[144:147], v[36:39], v[80:95]
    ds_read_b64_tr_b16 v[60:61], v25 offset:14336
    ds_read_b64_tr_b16 v[62:63], v25 offset:14848
    s_waitcnt lgkmcnt(10)
    v_mfma_f32_32x32x16_bf16 v[64:79], v[148:151], v[40:43], v[64:79]
    ds_read_b64_tr_b16 v[32:33], v24 offset:16384
    ds_read_b64_tr_b16 v[34:35], v24 offset:16896
    v_and_b32 v10, 63, v0
    v_lshrrev_b32 v11, 4, v10
    v_bfe_u32 v12, v10, 2, 2
    v_and_b32 v13, 3, v11
    v_xor_b32 v12, v12, v13
    v_lshlrev_b32 v12, 6, v12
    v_and_b32 v13, 3, v10
    v_lshl_add_u32 v12, v13, 4, v12
    s_waitcnt lgkmcnt(10)
    v_mfma_f32_32x32x16_bf16 v[80:95], v[148:151], v[44:47], v[80:95]
    ds_read_b64_tr_b16 v[36:37], v25 offset:16384
    ds_read_b64_tr_b16 v[38:39], v25 offset:16896
    s_add_u32 m0, s43, 68608
    s_add_u32 s53, s42, 2293888
    buffer_load_dwordx4 v4, s[4:7], s53 offen lds
    v_lshl_add_u32 v12, v11, 13, v12
    s_lshl_b32 s29, s26, 17
    v_add_u32 v28, s29, v12
    v_add_u32 v29, 0x8000, v28
    v_add_u32 v30, 0x10000, v28
    v_add_u32 v31, 0x18000, v28
    s_and_b32 s29, s20, 1
    s_mul_i32 s29, s29, 192
    s_waitcnt lgkmcnt(10)
    v_mfma_f32_32x32x16_bf16 v[64:79], v[152:155], v[48:51], v[64:79]
    ds_read_b64_tr_b16 v[40:41], v24 offset:18432
    ds_read_b64_tr_b16 v[42:43], v24 offset:18944
    s_mov_b32 s30, 43691
    s_movk_i32 s34, 2752
    s_cmp_eq_u32 s25, 0
    s_cselect_b64 s[36:37], -1, 0
    s_add_u32 s55, s41, 0
    buffer_store_dwordx4 v[96:99], v1, s[8:11], s55 offen
    s_waitcnt lgkmcnt(10)
    v_mfma_f32_32x32x16_bf16 v[80:95], v[152:155], v[52:55], v[80:95]
    ds_read_b64_tr_b16 v[44:45], v25 offset:18432
    ds_read_b64_tr_b16 v[46:47], v25 offset:18944
    v_add_u32 v11, s29, v10
    v_add_u32 v11, 0, v11
    v_mul_lo_u32 v12, v11, s30
    v_lshrrev_b32 v12, 18, v12
    v_mul_u32_u24 v13, 6, v12
    v_sub_u32 v13, v11, v13
    v_mul_lo_u32 v12, v12, s34
    v_lshl_add_u32 v9, v13, 4, v12
    s_waitcnt lgkmcnt(10)
    v_mfma_f32_32x32x16_bf16 v[64:79], v[156:159], v[56:59], v[64:79]
    ds_read_b64_tr_b16 v[48:49], v24 offset:20480
    ds_read_b64_tr_b16 v[50:51], v24 offset:20992
    s_add_u32 m0, s43, 0
    s_add_u32 s53, s42, 256
    buffer_load_dwordx4 v4, s[4:7], s53 offen lds
    v_cndmask_b32 v28, v9, v28, s[36:37]
    v_add_u32 v11, s29, v10
    v_add_u32 v11, 64, v11
    v_mul_lo_u32 v12, v11, s30
    v_lshrrev_b32 v12, 18, v12
    v_mul_u32_u24 v13, 6, v12
    v_sub_u32 v13, v11, v13
    v_mul_lo_u32 v12, v12, s34
    s_waitcnt lgkmcnt(10)
    v_mfma_f32_32x32x16_bf16 v[80:95], v[156:159], v[60:63], v[80:95]
    ds_read_b64_tr_b16 v[52:53], v25 offset:20480
    ds_read_b64_tr_b16 v[54:55], v25 offset:20992
    v_lshl_add_u32 v9, v13, 4, v12
    v_cndmask_b32 v29, v9, v29, s[36:37]
    v_add_u32 v11, s29, v10
    v_add_u32 v11, 128, v11
    s_waitcnt lgkmcnt(10)
    v_mfma_f32_32x32x16_bf16 v[64:79], v[160:163], v[32:35], v[64:79]
    ds_read_b64_tr_b16 v[56:57], v24 offset:22528
    ds_read_b64_tr_b16 v[58:59], v24 offset:23040
    v_mul_lo_u32 v12, v11, s30
    v_lshrrev_b32 v12, 18, v12
    v_mul_u32_u24 v13, 6, v12
    v_sub_u32 v13, v11, v13
    v_mul_lo_u32 v12, v12, s34
    v_lshl_add_u32 v9, v13, 4, v12
    v_cndmask_b32 v30, v9, v30, s[36:37]
    v_cndmask_b32 v31, v9, v31, s[36:37]
    s_waitcnt lgkmcnt(10)
    v_mfma_f32_32x32x16_bf16 v[80:95], v[160:163], v[36:39], v[80:95]
    ds_read_b64_tr_b16 v[60:61], v25 offset:22528
    ds_read_b64_tr_b16 v[62:63], v25 offset:23040
    s_add_u32 m0, s43, 1024
    s_add_u32 s53, s42, 65792
    buffer_load_dwordx4 v4, s[4:7], s53 offen lds
    v_lshrrev_b32 v11, 5, v10
    v_bfe_u32 v12, v10, 2, 2
    v_lshl_add_u32 v13, v11, 3, v12
    v_lshlrev_b32 v6, 8, v13
    v_lshl_add_u32 v6, v12, 6, v6
    v_bfe_u32 v7, v10, 4, 1
    v_lshl_add_u32 v6, v7, 5, v6
    v_and_b32 v9, 3, v10
    s_waitcnt lgkmcnt(10)
    v_mfma_f32_32x32x16_bf16 v[64:79], v[164:167], v[40:43], v[64:79]
    ds_read_b64_tr_b16 v[32:33], v24 offset:24576
    ds_read_b64_tr_b16 v[34:35], v24 offset:25088
    v_lshl_add_u32 v6, v9, 3, v6
    v_mul_u32_u24 v13, 96, v13
    v_mul_u32_u24 v7, 6272, v7
    v_add_u32 v13, v13, v7
    s_waitcnt lgkmcnt(10)
    v_mfma_f32_32x32x16_bf16 v[80:95], v[164:167], v[44:47], v[80:95]
    ds_read_b64_tr_b16 v[36:37], v25 offset:24576
    ds_read_b64_tr_b16 v[38:39], v25 offset:25088
    v_lshl_add_u32 v13, v9, 3, v13
    v_add_u32 v7, 0x4000, v13
    s_mov_b32 s60, s68
    s_mov_b32 s61, s69
    s_cmp_eq_u32 s20, 2
    s_cselect_b32 s60, s64, s60
    s_cselect_b32 s61, s65, s61
    s_cmp_eq_u32 s20, 3
    s_cselect_b32 s60, s66, s60
    s_cselect_b32 s61, s67, s61
    s_waitcnt lgkmcnt(10)
    v_mfma_f32_32x32x16_bf16 v[64:79], v[168:171], v[48:51], v[64:79]
    ds_read_b64_tr_b16 v[40:41], v24 offset:26624
    ds_read_b64_tr_b16 v[42:43], v24 offset:27136
    s_add_u32 m0, s43, 2048
    s_add_u32 s53, s42, 131328
    buffer_load_dwordx4 v4, s[4:7], s53 offen lds
    s_cmp_ge_u32 s20, 4
    s_cselect_b32 s60, s56, s60
    s_cselect_b32 s61, s57, s61
    s_cmp_ge_u32 s20, 6
    s_cselect_b32 s60, s58, s60
    s_cselect_b32 s61, s59, s61
    s_and_b32 s61, s61, 0xffff
    s_mov_b32 s63, 0x00020000
    s_mov_b32 s62, 0x158000
    s_movk_i32 s35, 5504
    s_waitcnt lgkmcnt(10)
    v_mfma_f32_32x32x16_bf16 v[80:95], v[168:171], v[52:55], v[80:95]
    ds_read_b64_tr_b16 v[44:45], v25 offset:26624
    ds_read_b64_tr_b16 v[46:47], v25 offset:27136
    s_and_b32 s38, s20, 2
    s_cmp_eq_u32 s38, 0
    s_cselect_b32 s62, 0x400000, s62
    s_cselect_b32 s35, 0x4000, s35
    s_waitcnt lgkmcnt(10)
    v_mfma_f32_32x32x16_bf16 v[64:79], v[172:175], v[56:59], v[64:79]
    ds_read_b64_tr_b16 v[48:49], v24 offset:28672
    ds_read_b64_tr_b16 v[50:51], v24 offset:29184
    s_mul_i32 s35, s35, s2
    s_and_b32 s39, s20, 1
    s_lshl_b32 s39, s39, 13
    s_cmp_eq_u32 s38, 0
    s_cselect_b32 s39, s39, 0
    s_add_u32 s35, s35, s39
    s_cmp_ge_u32 s20, 4
    s_cselect_b32 s35, 0x7f000000, s35
    v_lshlrev_b32 v12, 3, v1
    s_waitcnt lgkmcnt(10)
    v_mfma_f32_32x32x16_bf16 v[80:95], v[172:175], v[60:63], v[80:95]
    ds_read_b64_tr_b16 v[52:53], v25 offset:28672
    ds_read_b64_tr_b16 v[54:55], v25 offset:29184
    s_add_u32 m0, s43, 3072
    s_add_u32 s53, s42, 196864
    buffer_load_dwordx4 v4, s[4:7], s53 offen lds
    buffer_load_dword v11, v12, s[60:63], s35 offen
    s_bfe_u32 s29, s20, 0x10001
    s_cmp_eq_u32 s29, 0
    s_cselect_b32 s16, s64, s66
    s_cselect_b32 s17, s65, s67
    s_mov_b32 s18, 0x158000
    s_cmp_eq_u32 s25, 0
    s_cselect_b32 s16, s68, s16
    s_cselect_b32 s17, s69, s17
    s_cselect_b32 s18, 0x400000, s18
    s_waitcnt lgkmcnt(10)
    v_mfma_f32_32x32x16_bf16 v[64:79], v[176:179], v[32:35], v[64:79]
    ds_read_b64_tr_b16 v[56:57], v24 offset:30720
    ds_read_b64_tr_b16 v[58:59], v24 offset:31232
    s_and_b32 s17, s17, 0xffff
    s_mov_b32 s19, 0x00020000
    s_lshl_b32 s56, s21, 8
    s_mul_i32 s38, s21, 96
    s_add_u32 s55, s41, 1024
    buffer_store_dwordx4 v[100:103], v1, s[8:11], s55 offen
    s_waitcnt lgkmcnt(10)
    v_mfma_f32_32x32x16_bf16 v[80:95], v[176:179], v[36:39], v[80:95]
    ds_read_b64_tr_b16 v[60:61], v25 offset:30720
    ds_read_b64_tr_b16 v[62:63], v25 offset:31232
    s_lshl_b32 s58, s26, 12
    s_mul_i32 s39, s29, 6272
    s_and_b32 s30, s20, 1
    s_mul_i32 s30, s30, 3072
    s_add_u32 s39, s39, s30
    s_add_u32 s39, s39, 16384
    s_cmp_eq_u32 s25, 0
    s_cselect_b32 s56, s56, s38
    s_mov_b32 s57, 0x2b000
    s_cselect_b32 s57, 0x80000, s57
    s_cselect_b32 s58, s58, s39
    s_movk_i32 s59, 2048
    s_cselect_b32 s59, 3072, s59
    s_waitcnt lgkmcnt(10)
    v_mfma_f32_32x32x16_bf16 v[64:79], v[180:183], v[40:43], v[64:79]
    s_add_u32 s59, s59, s58
    s_lshl_b32 s60, s27, 15
    s_waitcnt lgkmcnt(8)
    v_mfma_f32_32x32x16_bf16 v[80:95], v[180:183], v[44:47], v[80:95]
    s_waitcnt vmcnt(7)
    s_waitcnt lgkmcnt(0)
    s_barrier
    s_cmp_lg_u32 s20, 0
    s_cbranch_scc1 LF_pub4
    v_mov_b32 v14, 1
    v_mov_b32 v15, 0
    s_mov_b64 exec, 1
    buffer_atomic_add v14, v15, s[96:99], s32 offen sc1
    s_mov_b64 exec, -1
LF_pub4:
    ds_read_b64_tr_b16 v[32:33], v26 offset:0
    ds_read_b64_tr_b16 v[34:35], v26 offset:512
    v_mfma_f32_32x32x16_bf16 v[64:79], v[184:187], v[48:51], v[64:79]
    ds_read_b64_tr_b16 v[36:37], v27 offset:0
    ds_read_b64_tr_b16 v[38:39], v27 offset:512
    v_mfma_f32_32x32x16_bf16 v[80:95], v[184:187], v[52:55], v[80:95]
    ds_read_b64_tr_b16 v[40:41], v26 offset:2048
    ds_read_b64_tr_b16 v[42:43], v26 offset:2560
    v_mfma_f32_32x32x16_bf16 v[64:79], v[188:191], v[56:59], v[64:79]
    ds_read_b64_tr_b16 v[44:45], v27 offset:2048
    ds_read_b64_tr_b16 v[46:47], v27 offset:2560
    v_mfma_f32_32x32x16_bf16 v[80:95], v[188:191], v[60:63], v[80:95]
    ds_read_b64_tr_b16 v[48:49], v26 offset:4096
    ds_read_b64_tr_b16 v[50:51], v26 offset:4608
    ds_read_b64_tr_b16 v[52:53], v27 offset:4096
    ds_read_b64_tr_b16 v[54:55], v27 offset:4608
    s_waitcnt lgkmcnt(10)
    v_mfma_f32_32x32x16_bf16 v[64:79], v[192:195], v[32:35], v[64:79]
    ds_read_b64_tr_b16 v[56:57], v26 offset:6144
    ds_read_b64_tr_b16 v[58:59], v26 offset:6656
    s_waitcnt lgkmcnt(10)
    v_mfma_f32_32x32x16_bf16 v[80:95], v[192:195], v[36:39], v[80:95]
    ds_read_b64_tr_b16 v[60:61], v27 offset:6144
    ds_read_b64_tr_b16 v[62:63], v27 offset:6656
    s_waitcnt lgkmcnt(10)
    v_mfma_f32_32x32x16_bf16 v[64:79], v[196:199], v[40:43], v[64:79]
    ds_read_b64_tr_b16 v[32:33], v26 offset:8192
    ds_read_b64_tr_b16 v[34:35], v26 offset:8704
    s_add_u32 m0, s43, 32768
    s_add_u32 s53, s42, 2097408
    buffer_load_dwordx4 v4, s[4:7], s53 offen lds
    s_waitcnt lgkmcnt(10)
    v_mfma_f32_32x32x16_bf16 v[80:95], v[196:199], v[44:47], v[80:95]
    ds_read_b64_tr_b16 v[36:37], v27 offset:8192
    ds_read_b64_tr_b16 v[38:39], v27 offset:8704
    s_waitcnt lgkmcnt(10)
    v_mfma_f32_32x32x16_bf16 v[64:79], v[200:203], v[48:51], v[64:79]
    ds_read_b64_tr_b16 v[40:41], v26 offset:10240
    ds_read_b64_tr_b16 v[42:43], v26 offset:10752
    s_waitcnt lgkmcnt(10)
    v_mfma_f32_32x32x16_bf16 v[80:95], v[200:203], v[52:55], v[80:95]
    ds_read_b64_tr_b16 v[44:45], v27 offset:10240
    ds_read_b64_tr_b16 v[46:47], v27 offset:10752
    s_waitcnt lgkmcnt(10)
    v_mfma_f32_32x32x16_bf16 v[64:79], v[204:207], v[56:59], v[64:79]
    ds_read_b64_tr_b16 v[48:49], v26 offset:12288
    ds_read_b64_tr_b16 v[50:51], v26 offset:12800
    s_waitcnt lgkmcnt(10)
    v_mfma_f32_32x32x16_bf16 v[80:95], v[204:207], v[60:63], v[80:95]
    ds_read_b64_tr_b16 v[52:53], v27 offset:12288
    ds_read_b64_tr_b16 v[54:55], v27 offset:12800
    s_waitcnt lgkmcnt(10)
    v_mfma_f32_32x32x16_bf16 v[64:79], v[208:211], v[32:35], v[64:79]
    ds_read_b64_tr_b16 v[56:57], v26 offset:14336
    ds_read_b64_tr_b16 v[58:59], v26 offset:14848
    s_add_u32 m0, s43, 33792
    s_add_u32 s53, s42, 2162944
    buffer_load_dwordx4 v4, s[4:7], s53 offen lds
    s_waitcnt lgkmcnt(10)
    v_mfma_f32_32x32x16_bf16 v[80:95], v[208:211], v[36:39], v[80:95]
    ds_read_b64_tr_b16 v[60:61], v27 offset:14336
    ds_read_b64_tr_b16 v[62:63], v27 offset:14848
    s_waitcnt lgkmcnt(10)
    v_mfma_f32_32x32x16_bf16 v[64:79], v[212:215], v[40:43], v[64:79]
    ds_read_b64_tr_b16 v[32:33], v26 offset:16384
    ds_read_b64_tr_b16 v[34:35], v26 offset:16896
    s_waitcnt lgkmcnt(10)
    v_mfma_f32_32x32x16_bf16 v[80:95], v[212:215], v[44:47], v[80:95]
    ds_read_b64_tr_b16 v[36:37], v27 offset:16384
    ds_read_b64_tr_b16 v[38:39], v27 offset:16896
    s_waitcnt lgkmcnt(10)
    v_mfma_f32_32x32x16_bf16 v[64:79], v[216:219], v[48:51], v[64:79]
    ds_read_b64_tr_b16 v[40:41], v26 offset:18432
    ds_read_b64_tr_b16 v[42:43], v26 offset:18944
    s_add_u32 s55, s41, 2048
    buffer_store_dwordx4 v[104:107], v1, s[8:11], s55 offen
    s_waitcnt lgkmcnt(10)
    v_mfma_f32_32x32x16_bf16 v[80:95], v[216:219], v[52:55], v[80:95]
    ds_read_b64_tr_b16 v[44:45], v27 offset:18432
    ds_read_b64_tr_b16 v[46:47], v27 offset:18944
    s_waitcnt lgkmcnt(10)
    v_mfma_f32_32x32x16_bf16 v[64:79], v[220:223], v[56:59], v[64:79]
    ds_read_b64_tr_b16 v[48:49], v26 offset:20480
    ds_read_b64_tr_b16 v[50:51], v26 offset:20992
    s_add_u32 m0, s43, 34816
    s_add_u32 s53, s42, 2228480
    buffer_load_dwordx4 v4, s[4:7], s53 offen lds
    s_waitcnt lgkmcnt(10)
    v_mfma_f32_32x32x16_bf16 v[80:95], v[220:223], v[60:63], v[80:95]
    ds_read_b64_tr_b16 v[52:53], v27 offset:20480
    ds_read_b64_tr_b16 v[54:55], v27 offset:20992
    s_waitcnt lgkmcnt(10)
    v_mfma_f32_32x32x16_bf16 v[64:79], v[224:227], v[32:35], v[64:79]
    ds_read_b64_tr_b16 v[56:57], v26 offset:22528
    ds_read_b64_tr_b16 v[58:59], v26 offset:23040
    s_waitcnt lgkmcnt(10)
    v_mfma_f32_32x32x16_bf16 v[80:95], v[224:227], v[36:39], v[80:95]
    ds_read_b64_tr_b16 v[60:61], v27 offset:22528
    ds_read_b64_tr_b16 v[62:63], v27 offset:23040
    s_waitcnt lgkmcnt(10)
    v_mfma_f32_32x32x16_bf16 v[64:79], v[228:231], v[40:43], v[64:79]
    ds_read_b64_tr_b16 v[32:33], v26 offset:24576
    ds_read_b64_tr_b16 v[34:35], v26 offset:25088
    s_waitcnt lgkmcnt(10)
    v_mfma_f32_32x32x16_bf16 v[80:95], v[228:231], v[44:47], v[80:95]
    ds_read_b64_tr_b16 v[36:37], v27 offset:24576
    ds_read_b64_tr_b16 v[38:39], v27 offset:25088
    s_waitcnt lgkmcnt(10)
    v_mfma_f32_32x32x16_bf16 v[64:79], v[232:235], v[48:51], v[64:79]
    ds_read_b64_tr_b16 v[40:41], v26 offset:26624
    ds_read_b64_tr_b16 v[42:43], v26 offset:27136
    s_add_u32 m0, s43, 35840
    s_add_u32 s53, s42, 2294016
    buffer_load_dwordx4 v4, s[4:7], s53 offen lds
    s_waitcnt lgkmcnt(10)
    v_mfma_f32_32x32x16_bf16 v[80:95], v[232:235], v[52:55], v[80:95]
    ds_read_b64_tr_b16 v[44:45], v27 offset:26624
    ds_read_b64_tr_b16 v[46:47], v27 offset:27136
    s_waitcnt lgkmcnt(10)
    v_mfma_f32_32x32x16_bf16 v[64:79], v[236:239], v[56:59], v[64:79]
    ds_read_b64_tr_b16 v[48:49], v26 offset:28672
    ds_read_b64_tr_b16 v[50:51], v26 offset:29184
    s_waitcnt lgkmcnt(10)
    v_mfma_f32_32x32x16_bf16 v[80:95], v[236:239], v[60:63], v[80:95]
    ds_read_b64_tr_b16 v[52:53], v27 offset:28672
    ds_read_b64_tr_b16 v[54:55], v27 offset:29184
    s_waitcnt lgkmcnt(10)
    v_mfma_f32_32x32x16_bf16 v[64:79], v[240:243], v[32:35], v[64:79]
    ds_read_b64_tr_b16 v[56:57], v26 offset:30720
    ds_read_b64_tr_b16 v[58:59], v26 offset:31232
    s_add_u32 s55, s41, 3072
    buffer_store_dwordx4 v[108:111], v1, s[8:11], s55 offen
    s_waitcnt lgkmcnt(10)
    v_mfma_f32_32x32x16_bf16 v[80:95], v[240:243], v[36:39], v[80:95]
    ds_read_b64_tr_b16 v[60:61], v27 offset:30720
    ds_read_b64_tr_b16 v[62:63], v27 offset:31232
    s_waitcnt lgkmcnt(10)
    v_mfma_f32_32x32x16_bf16 v[64:79], v[244:247], v[40:43], v[64:79]
    s_waitcnt lgkmcnt(8)
    v_mfma_f32_32x32x16_bf16 v[80:95], v[244:247], v[44:47], v[80:95]
    s_waitcnt vmcnt(8)
    s_waitcnt lgkmcnt(0)
    s_barrier
    ds_read_b64_tr_b16 v[32:33], v20 offset:0
    ds_read_b64_tr_b16 v[34:35], v20 offset:512
    v_mfma_f32_32x32x16_bf16 v[64:79], v[248:251], v[48:51], v[64:79]
    ds_read_b64_tr_b16 v[36:37], v21 offset:0
    ds_read_b64_tr_b16 v[38:39], v21 offset:512
    v_mfma_f32_32x32x16_bf16 v[80:95], v[248:251], v[52:55], v[80:95]
    ds_read_b64_tr_b16 v[40:41], v20 offset:2048
    ds_read_b64_tr_b16 v[42:43], v20 offset:2560
    v_mfma_f32_32x32x16_bf16 v[64:79], v[252:255], v[56:59], v[64:79]
    ds_read_b64_tr_b16 v[44:45], v21 offset:2048
    ds_read_b64_tr_b16 v[46:47], v21 offset:2560
    v_mfma_f32_32x32x16_bf16 v[80:95], v[252:255], v[60:63], v[80:95]
    ds_read_b64_tr_b16 v[48:49], v20 offset:4096
    ds_read_b64_tr_b16 v[50:51], v20 offset:4608
    ds_read_b64_tr_b16 v[52:53], v21 offset:4096
    ds_read_b64_tr_b16 v[54:55], v21 offset:4608
    s_nop 4
    v_cvt_pk_bf16_f32 v96, v64, v65
    v_cvt_pk_bf16_f32 v97, v66, v67
    v_cvt_pk_bf16_f32 v98, v68, v69
    v_cvt_pk_bf16_f32 v99, v70, v71
    v_cvt_pk_bf16_f32 v100, v72, v73
    v_cvt_pk_bf16_f32 v101, v74, v75
    v_cvt_pk_bf16_f32 v102, v76, v77
    v_cvt_pk_bf16_f32 v103, v78, v79
    s_waitcnt lgkmcnt(10)
    v_mfma_f32_32x32x16_bf16 v[64:79], v[128:131], v[32:35], 0
    ds_read_b64_tr_b16 v[56:57], v20 offset:6144
    ds_read_b64_tr_b16 v[58:59], v20 offset:6656
    v_cvt_pk_bf16_f32 v104, v80, v81
    v_cvt_pk_bf16_f32 v105, v82, v83
    v_cvt_pk_bf16_f32 v106, v84, v85
    v_cvt_pk_bf16_f32 v107, v86, v87
    v_cvt_pk_bf16_f32 v108, v88, v89
    v_cvt_pk_bf16_f32 v109, v90, v91
    v_cvt_pk_bf16_f32 v110, v92, v93
    v_cvt_pk_bf16_f32 v111, v94, v95
    s_waitcnt lgkmcnt(10)
    v_mfma_f32_32x32x16_bf16 v[80:95], v[128:131], v[36:39], 0
    ds_read_b64_tr_b16 v[60:61], v21 offset:6144
    ds_read_b64_tr_b16 v[62:63], v21 offset:6656
    s_waitcnt lgkmcnt(10)
    v_mfma_f32_32x32x16_bf16 v[64:79], v[132:135], v[40:43], v[64:79]
    ds_read_b64_tr_b16 v[32:33], v20 offset:8192
    ds_read_b64_tr_b16 v[34:35], v20 offset:8704
    s_add_u32 m0, s43, 131072
    s_add_u32 s53, s42, 384
    buffer_load_dwordx4 v4, s[4:7], s53 offen lds
    s_waitcnt lgkmcnt(10)
    v_mfma_f32_32x32x16_bf16 v[80:95], v[132:135], v[44:47], v[80:95]
    ds_read_b64_tr_b16 v[36:37], v21 offset:8192
    ds_read_b64_tr_b16 v[38:39], v21 offset:8704
    s_waitcnt lgkmcnt(10)
    v_mfma_f32_32x32x16_bf16 v[64:79], v[136:139], v[48:51], v[64:79]
    ds_read_b64_tr_b16 v[40:41], v20 offset:10240
    ds_read_b64_tr_b16 v[42:43], v20 offset:10752
    s_waitcnt lgkmcnt(10)
    v_mfma_f32_32x32x16_bf16 v[80:95], v[136:139], v[52:55], v[80:95]
    ds_read_b64_tr_b16 v[44:45], v21 offset:10240
    ds_read_b64_tr_b16 v[46:47], v21 offset:10752
    s_waitcnt lgkmcnt(10)
    v_mfma_f32_32x32x16_bf16 v[64:79], v[140:143], v[56:59], v[64:79]
    ds_read_b64_tr_b16 v[48:49], v20 offset:12288
    ds_read_b64_tr_b16 v[50:51], v20 offset:12800
    s_waitcnt lgkmcnt(10)
    v_mfma_f32_32x32x16_bf16 v[80:95], v[140:143], v[60:63], v[80:95]
    ds_read_b64_tr_b16 v[52:53], v21 offset:12288
    ds_read_b64_tr_b16 v[54:55], v21 offset:12800
    s_waitcnt lgkmcnt(10)
    v_mfma_f32_32x32x16_bf16 v[64:79], v[144:147], v[32:35], v[64:79]
    ds_read_b64_tr_b16 v[56:57], v20 offset:14336
    ds_read_b64_tr_b16 v[58:59], v20 offset:14848
    s_add_u32 m0, s43, 132096
    s_add_u32 s53, s42, 65920
    buffer_load_dwordx4 v4, s[4:7], s53 offen lds
    s_waitcnt lgkmcnt(10)
    v_mfma_f32_32x32x16_bf16 v[80:95], v[144:147], v[36:39], v[80:95]
    ds_read_b64_tr_b16 v[60:61], v21 offset:14336
    ds_read_b64_tr_b16 v[62:63], v21 offset:14848
    s_waitcnt lgkmcnt(10)
    v_mfma_f32_32x32x16_bf16 v[64:79], v[148:151], v[40:43], v[64:79]
    ds_read_b64_tr_b16 v[32:33], v20 offset:16384
    ds_read_b64_tr_b16 v[34:35], v20 offset:16896
    s_waitcnt lgkmcnt(10)
    v_mfma_f32_32x32x16_bf16 v[80:95], v[148:151], v[44:47], v[80:95]
    ds_read_b64_tr_b16 v[36:37], v21 offset:16384
    ds_read_b64_tr_b16 v[38:39], v21 offset:16896
    s_waitcnt lgkmcnt(10)
    v_mfma_f32_32x32x16_bf16 v[64:79], v[152:155], v[48:51], v[64:79]
    ds_read_b64_tr_b16 v[40:41], v20 offset:18432
    ds_read_b64_tr_b16 v[42:43], v20 offset:18944
    s_add_u32 s55, s41, 4096
    buffer_store_dwordx4 v[96:99], v1, s[8:11], s55 offen
    s_waitcnt lgkmcnt(10)
    v_mfma_f32_32x32x16_bf16 v[80:95], v[152:155], v[52:55], v[80:95]
    ds_read_b64_tr_b16 v[44:45], v21 offset:18432
    ds_read_b64_tr_b16 v[46:47], v21 offset:18944
    s_waitcnt lgkmcnt(10)
    v_mfma_f32_32x32x16_bf16 v[64:79], v[156:159], v[56:59], v[64:79]
    ds_read_b64_tr_b16 v[48:49], v20 offset:20480
    ds_read_b64_tr_b16 v[50:51], v20 offset:20992
    s_add_u32 m0, s43, 133120
    s_add_u32 s53, s42, 131456
    buffer_load_dwordx4 v4, s[4:7], s53 offen lds
    s_waitcnt lgkmcnt(10)
    v_mfma_f32_32x32x16_bf16 v[80:95], v[156:159], v[60:63], v[80:95]
    ds_read_b64_tr_b16 v[52:53], v21 offset:20480
    ds_read_b64_tr_b16 v[54:55], v21 offset:20992
    s_waitcnt lgkmcnt(10)
    v_mfma_f32_32x32x16_bf16 v[64:79], v[160:163], v[32:35], v[64:79]
    ds_read_b64_tr_b16 v[56:57], v20 offset:22528
    ds_read_b64_tr_b16 v[58:59], v20 offset:23040
    s_waitcnt lgkmcnt(10)
    v_mfma_f32_32x32x16_bf16 v[80:95], v[160:163], v[36:39], v[80:95]
    ds_read_b64_tr_b16 v[60:61], v21 offset:22528
    ds_read_b64_tr_b16 v[62:63], v21 offset:23040
    s_waitcnt lgkmcnt(10)
    v_mfma_f32_32x32x16_bf16 v[64:79], v[164:167], v[40:43], v[64:79]
    ds_read_b64_tr_b16 v[32:33], v20 offset:24576
    ds_read_b64_tr_b16 v[34:35], v20 offset:25088
    s_waitcnt lgkmcnt(10)
    v_mfma_f32_32x32x16_bf16 v[80:95], v[164:167], v[44:47], v[80:95]
    ds_read_b64_tr_b16 v[36:37], v21 offset:24576
    ds_read_b64_tr_b16 v[38:39], v21 offset:25088
    s_waitcnt lgkmcnt(10)
    v_mfma_f32_32x32x16_bf16 v[64:79], v[168:171], v[48:51], v[64:79]
    ds_read_b64_tr_b16 v[40:41], v20 offset:26624
    ds_read_b64_tr_b16 v[42:43], v20 offset:27136
    s_add_u32 m0, s43, 134144
    s_add_u32 s53, s42, 196992
    buffer_load_dwordx4 v4, s[4:7], s53 offen lds
    s_waitcnt lgkmcnt(10)
    v_mfma_f32_32x32x16_bf16 v[80:95], v[168:171], v[52:55], v[80:95]
    ds_read_b64_tr_b16 v[44:45], v21 offset:26624
    ds_read_b64_tr_b16 v[46:47], v21 offset:27136
    s_waitcnt lgkmcnt(10)
    v_mfma_f32_32x32x16_bf16 v[64:79], v[172:175], v[56:59], v[64:79]
    ds_read_b64_tr_b16 v[48:49], v20 offset:28672
    ds_read_b64_tr_b16 v[50:51], v20 offset:29184
    s_waitcnt lgkmcnt(10)
    v_mfma_f32_32x32x16_bf16 v[80:95], v[172:175], v[60:63], v[80:95]
    ds_read_b64_tr_b16 v[52:53], v21 offset:28672
    ds_read_b64_tr_b16 v[54:55], v21 offset:29184
    s_waitcnt lgkmcnt(10)
    v_mfma_f32_32x32x16_bf16 v[64:79], v[176:179], v[32:35], v[64:79]
    ds_read_b64_tr_b16 v[56:57], v20 offset:30720
    ds_read_b64_tr_b16 v[58:59], v20 offset:31232
    s_add_u32 s55, s41, 5120
    buffer_store_dwordx4 v[100:103], v1, s[8:11], s55 offen
    s_waitcnt lgkmcnt(10)
    v_mfma_f32_32x32x16_bf16 v[80:95], v[176:179], v[36:39], v[80:95]
    ds_read_b64_tr_b16 v[60:61], v21 offset:30720
    ds_read_b64_tr_b16 v[62:63], v21 offset:31232
    s_waitcnt lgkmcnt(10)
    v_mfma_f32_32x32x16_bf16 v[64:79], v[180:183], v[40:43], v[64:79]
    s_waitcnt lgkmcnt(8)
    v_mfma_f32_32x32x16_bf16 v[80:95], v[180:183], v[44:47], v[80:95]
    s_waitcnt vmcnt(7)
    s_waitcnt lgkmcnt(0)
    s_barrier
    ds_read_b64_tr_b16 v[32:33], v22 offset:0
    ds_read_b64_tr_b16 v[34:35], v22 offset:512
    v_mfma_f32_32x32x16_bf16 v[64:79], v[184:187], v[48:51], v[64:79]
    ds_read_b64_tr_b16 v[36:37], v23 offset:0
    ds_read_b64_tr_b16 v[38:39], v23 offset:512
    v_mfma_f32_32x32x16_bf16 v[80:95], v[184:187], v[52:55], v[80:95]
    ds_read_b64_tr_b16 v[40:41], v22 offset:2048
    ds_read_b64_tr_b16 v[42:43], v22 offset:2560
    v_mfma_f32_32x32x16_bf16 v[64:79], v[188:191], v[56:59], v[64:79]
    ds_read_b64_tr_b16 v[44:45], v23 offset:2048
    ds_read_b64_tr_b16 v[46:47], v23 offset:2560
    v_mfma_f32_32x32x16_bf16 v[80:95], v[188:191], v[60:63], v[80:95]
    ds_read_b64_tr_b16 v[48:49], v22 offset:4096
    ds_read_b64_tr_b16 v[50:51], v22 offset:4608
    ds_read_b64_tr_b16 v[52:53], v23 offset:4096
    ds_read_b64_tr_b16 v[54:55], v23 offset:4608
    s_waitcnt lgkmcnt(10)
    v_mfma_f32_32x32x16_bf16 v[64:79], v[192:195], v[32:35], v[64:79]
    ds_read_b64_tr_b16 v[56:57], v22 offset:6144
    ds_read_b64_tr_b16 v[58:59], v22 offset:6656
    s_waitcnt lgkmcnt(10)
    v_mfma_f32_32x32x16_bf16 v[80:95], v[192:195], v[36:39], v[80:95]
    ds_read_b64_tr_b16 v[60:61], v23 offset:6144
    ds_read_b64_tr_b16 v[62:63], v23 offset:6656
    s_waitcnt lgkmcnt(10)
    v_mfma_f32_32x32x16_bf16 v[64:79], v[196:199], v[40:43], v[64:79]
    ds_read_b64_tr_b16 v[32:33], v22 offset:8192
    ds_read_b64_tr_b16 v[34:35], v22 offset:8704
    s_add_u32 m0, s43, 65536
    s_add_u32 s53, s42, 2097536
    buffer_load_dwordx4 v4, s[4:7], s53 offen lds
    s_waitcnt lgkmcnt(10)
    v_mfma_f32_32x32x16_bf16 v[80:95], v[196:199], v[44:47], v[80:95]
    ds_read_b64_tr_b16 v[36:37], v23 offset:8192
    ds_read_b64_tr_b16 v[38:39], v23 offset:8704
    s_waitcnt lgkmcnt(10)
    v_mfma_f32_32x32x16_bf16 v[64:79], v[200:203], v[48:51], v[64:79]
    ds_read_b64_tr_b16 v[40:41], v22 offset:10240
    ds_read_b64_tr_b16 v[42:43], v22 offset:10752
    s_waitcnt lgkmcnt(10)
    v_mfma_f32_32x32x16_bf16 v[80:95], v[200:203], v[52:55], v[80:95]
    ds_read_b64_tr_b16 v[44:45], v23 offset:10240
    ds_read_b64_tr_b16 v[46:47], v23 offset:10752
    s_waitcnt lgkmcnt(10)
    v_mfma_f32_32x32x16_bf16 v[64:79], v[204:207], v[56:59], v[64:79]
    ds_read_b64_tr_b16 v[48:49], v22 offset:12288
    ds_read_b64_tr_b16 v[50:51], v22 offset:12800
    s_waitcnt lgkmcnt(10)
    v_mfma_f32_32x32x16_bf16 v[80:95], v[204:207], v[60:63], v[80:95]
    ds_read_b64_tr_b16 v[52:53], v23 offset:12288
    ds_read_b64_tr_b16 v[54:55], v23 offset:12800
    s_waitcnt lgkmcnt(10)
    v_mfma_f32_32x32x16_bf16 v[64:79], v[208:211], v[32:35], v[64:79]
    ds_read_b64_tr_b16 v[56:57], v22 offset:14336
    ds_read_b64_tr_b16 v[58:59], v22 offset:14848
    s_add_u32 m0, s43, 66560
    s_add_u32 s53, s42, 2163072
    buffer_load_dwordx4 v4, s[4:7], s53 offen lds
    s_waitcnt lgkmcnt(10)
    v_mfma_f32_32x32x16_bf16 v[80:95], v[208:211], v[36:39], v[80:95]
    ds_read_b64_tr_b16 v[60:61], v23 offset:14336
    ds_read_b64_tr_b16 v[62:63], v23 offset:14848
    s_waitcnt lgkmcnt(10)
    v_mfma_f32_32x32x16_bf16 v[64:79], v[212:215], v[40:43], v[64:79]
    ds_read_b64_tr_b16 v[32:33], v22 offset:16384
    ds_read_b64_tr_b16 v[34:35], v22 offset:16896
    s_waitcnt lgkmcnt(10)
    v_mfma_f32_32x32x16_bf16 v[80:95], v[212:215], v[44:47], v[80:95]
    ds_read_b64_tr_b16 v[36:37], v23 offset:16384
    ds_read_b64_tr_b16 v[38:39], v23 offset:16896
    s_waitcnt lgkmcnt(10)
    v_mfma_f32_32x32x16_bf16 v[64:79], v[216:219], v[48:51], v[64:79]
    ds_read_b64_tr_b16 v[40:41], v22 offset:18432
    ds_read_b64_tr_b16 v[42:43], v22 offset:18944
    s_add_u32 s55, s41, 6144
    buffer_store_dwordx4 v[104:107], v1, s[8:11], s55 offen
    s_waitcnt lgkmcnt(10)
    v_mfma_f32_32x32x16_bf16 v[80:95], v[216:219], v[52:55], v[80:95]
    ds_read_b64_tr_b16 v[44:45], v23 offset:18432
    ds_read_b64_tr_b16 v[46:47], v23 offset:18944
    s_waitcnt lgkmcnt(10)
    v_mfma_f32_32x32x16_bf16 v[64:79], v[220:223], v[56:59], v[64:79]
    ds_read_b64_tr_b16 v[48:49], v22 offset:20480
    ds_read_b64_tr_b16 v[50:51], v22 offset:20992
    s_add_u32 m0, s43, 67584
    s_add_u32 s53, s42, 2228608
    buffer_load_dwordx4 v4, s[4:7], s53 offen lds
    s_waitcnt lgkmcnt(10)
    v_mfma_f32_32x32x16_bf16 v[80:95], v[220:223], v[60:63], v[80:95]
    ds_read_b64_tr_b16 v[52:53], v23 offset:20480
    ds_read_b64_tr_b16 v[54:55], v23 offset:20992
    s_waitcnt lgkmcnt(10)
    v_mfma_f32_32x32x16_bf16 v[64:79], v[224:227], v[32:35], v[64:79]
    ds_read_b64_tr_b16 v[56:57], v22 offset:22528
    ds_read_b64_tr_b16 v[58:59], v22 offset:23040
    s_waitcnt lgkmcnt(10)
    v_mfma_f32_32x32x16_bf16 v[80:95], v[224:227], v[36:39], v[80:95]
    ds_read_b64_tr_b16 v[60:61], v23 offset:22528
    ds_read_b64_tr_b16 v[62:63], v23 offset:23040
    s_waitcnt lgkmcnt(10)
    v_mfma_f32_32x32x16_bf16 v[64:79], v[228:231], v[40:43], v[64:79]
    ds_read_b64_tr_b16 v[32:33], v22 offset:24576
    ds_read_b64_tr_b16 v[34:35], v22 offset:25088
    s_sub_u32 s29, 15, s24
    s_lshl_b32 s29, s29, 2
    s_lshl_b32 s30, s24, 2
    s_cmp_lg_u32 s20, 0
    s_cbranch_scc1 LF_pi5
    v_mov_b32 v8, 0
    buffer_load_dword v14, v8, s[96:99], s29 offen sc1
    buffer_load_dword v15, v8, s[96:99], s30 offen sc1
LF_pi5:
    s_waitcnt lgkmcnt(10)
    v_mfma_f32_32x32x16_bf16 v[80:95], v[228:231], v[44:47], v[80:95]
    ds_read_b64_tr_b16 v[36:37], v23 offset:24576
    ds_read_b64_tr_b16 v[38:39], v23 offset:25088
    s_waitcnt lgkmcnt(10)
    v_mfma_f32_32x32x16_bf16 v[64:79], v[232:235], v[48:51], v[64:79]
    ds_read_b64_tr_b16 v[40:41], v22 offset:26624
    ds_read_b64_tr_b16 v[42:43], v22 offset:27136
    s_add_u32 m0, s43, 68608
    s_add_u32 s53, s42, 2294144
    buffer_load_dwordx4 v4, s[4:7], s53 offen lds
    s_waitcnt lgkmcnt(10)
    v_mfma_f32_32x32x16_bf16 v[80:95], v[232:235], v[52:55], v[80:95]
    ds_read_b64_tr_b16 v[44:45], v23 offset:26624
    ds_read_b64_tr_b16 v[46:47], v23 offset:27136
    s_waitcnt lgkmcnt(10)
    v_mfma_f32_32x32x16_bf16 v[64:79], v[236:239], v[56:59], v[64:79]
    ds_read_b64_tr_b16 v[48:49], v22 offset:28672
    ds_read_b64_tr_b16 v[50:51], v22 offset:29184
    s_waitcnt lgkmcnt(10)
    v_mfma_f32_32x32x16_bf16 v[80:95], v[236:239], v[60:63], v[80:95]
    ds_read_b64_tr_b16 v[52:53], v23 offset:28672
    ds_read_b64_tr_b16 v[54:55], v23 offset:29184
    s_waitcnt lgkmcnt(10)
    v_mfma_f32_32x32x16_bf16 v[64:79], v[240:243], v[32:35], v[64:79]
    ds_read_b64_tr_b16 v[56:57], v22 offset:30720
    ds_read_b64_tr_b16 v[58:59], v22 offset:31232
    s_add_u32 s55, s41, 7168
    buffer_store_dwordx4 v[108:111], v1, s[8:11], s55 offen
    s_waitcnt lgkmcnt(10)
    v_mfma_f32_32x32x16_bf16 v[80:95], v[240:243], v[36:39], v[80:95]
    ds_read_b64_tr_b16 v[60:61], v23 offset:30720
    ds_read_b64_tr_b16 v[62:63], v23 offset:31232
    s_waitcnt lgkmcnt(10)
    v_mfma_f32_32x32x16_bf16 v[64:79], v[244:247], v[40:43], v[64:79]
    s_waitcnt lgkmcnt(8)
    v_mfma_f32_32x32x16_bf16 v[80:95], v[244:247], v[44:47], v[80:95]
    s_waitcnt vmcnt(7)
    s_waitcnt lgkmcnt(0)
    s_barrier
    s_cmp_lg_u32 s20, 0
    s_cbranch_scc1 LF_pc6
    s_waitcnt vmcnt(2)
    v_readfirstlane_b32 s100, v14
    s_nop 1
    s_cmp_lt_u32 s100, 16
    s_cbranch_scc1 LF_pc6_slow
    s_waitcnt vmcnt(2)
    v_readfirstlane_b32 s100, v15
    s_nop 1
    s_cmp_lt_u32 s100, 16
    s_cbranch_scc1 LF_pc6_slow
LF_pc6_ok:
LF_pc6:
    ds_read_b64_tr_b16 v[32:33], v24 offset:0
    ds_read_b64_tr_b16 v[34:35], v24 offset:512
    v_mfma_f32_32x32x16_bf16 v[64:79], v[248:251], v[48:51], v[64:79]
    ds_read_b64_tr_b16 v[36:37], v25 offset:0
    ds_read_b64_tr_b16 v[38:39], v25 offset:512
    v_mfma_f32_32x32x16_bf16 v[80:95], v[248:251], v[52:55], v[80:95]
    ds_read_b64_tr_b16 v[40:41], v24 offset:2048
    ds_read_b64_tr_b16 v[42:43], v24 offset:2560
    v_mfma_f32_32x32x16_bf16 v[64:79], v[252:255], v[56:59], v[64:79]
    ds_read_b64_tr_b16 v[44:45], v25 offset:2048
    ds_read_b64_tr_b16 v[46:47], v25 offset:2560
    v_mfma_f32_32x32x16_bf16 v[80:95], v[252:255], v[60:63], v[80:95]
    ds_read_b64_tr_b16 v[48:49], v24 offset:4096
    ds_read_b64_tr_b16 v[50:51], v24 offset:4608
    ds_read_b64_tr_b16 v[52:53], v25 offset:4096
    ds_read_b64_tr_b16 v[54:55], v25 offset:4608
    s_nop 4
    v_cvt_pk_bf16_f32 v96, v64, v65
    v_cvt_pk_bf16_f32 v97, v66, v67
    v_cvt_pk_bf16_f32 v98, v68, v69
    v_cvt_pk_bf16_f32 v99, v70, v71
    v_cvt_pk_bf16_f32 v100, v72, v73
    v_cvt_pk_bf16_f32 v101, v74, v75
    v_cvt_pk_bf16_f32 v102, v76, v77
    v_cvt_pk_bf16_f32 v103, v78, v79
    s_waitcnt lgkmcnt(10)
    v_mfma_f32_32x32x16_bf16 v[64:79], v[128:131], v[32:35], 0
    ds_read_b64_tr_b16 v[56:57], v24 offset:6144
    ds_read_b64_tr_b16 v[58:59], v24 offset:6656
    v_cvt_pk_bf16_f32 v104, v80, v81
    v_cvt_pk_bf16_f32 v105, v82, v83
    v_cvt_pk_bf16_f32 v106, v84, v85
    v_cvt_pk_bf16_f32 v107, v86, v87
    v_cvt_pk_bf16_f32 v108, v88, v89
    v_cvt_pk_bf16_f32 v109, v90, v91
    v_cvt_pk_bf16_f32 v110, v92, v93
    v_cvt_pk_bf16_f32 v111, v94, v95
    s_waitcnt lgkmcnt(10)
    v_mfma_f32_32x32x16_bf16 v[80:95], v[128:131], v[36:39], 0
    ds_read_b64_tr_b16 v[60:61], v25 offset:6144
    ds_read_b64_tr_b16 v[62:63], v25 offset:6656
    s_add_u32 m0, s58, 0
    s_nop 0
    buffer_load_dwordx4 v28, s[16:19], s56 offen lds
    s_waitcnt lgkmcnt(10)
    v_mfma_f32_32x32x16_bf16 v[64:79], v[132:135], v[40:43], v[64:79]
    ds_read_b64_tr_b16 v[32:33], v24 offset:8192
    ds_read_b64_tr_b16 v[34:35], v24 offset:8704
    s_waitcnt lgkmcnt(10)
    v_mfma_f32_32x32x16_bf16 v[80:95], v[132:135], v[44:47], v[80:95]
    ds_read_b64_tr_b16 v[36:37], v25 offset:8192
    ds_read_b64_tr_b16 v[38:39], v25 offset:8704
    s_waitcnt lgkmcnt(10)
    v_mfma_f32_32x32x16_bf16 v[64:79], v[136:139], v[48:51], v[64:79]
    ds_read_b64_tr_b16 v[40:41], v24 offset:10240
    ds_read_b64_tr_b16 v[42:43], v24 offset:10752
    s_add_u32 m0, s58, 1024
    s_nop 0
    buffer_load_dwordx4 v29, s[16:19], s56 offen lds
    s_waitcnt lgkmcnt(10)
    v_mfma_f32_32x32x16_bf16 v[80:95], v[136:139], v[52:55], v[80:95]
    ds_read_b64_tr_b16 v[44:45], v25 offset:10240
    ds_read_b64_tr_b16 v[46:47], v25 offset:10752
    s_waitcnt lgkmcnt(10)
    v_mfma_f32_32x32x16_bf16 v[64:79], v[140:143], v[56:59], v[64:79]
    ds_read_b64_tr_b16 v[48:49], v24 offset:12288
    ds_read_b64_tr_b16 v[50:51], v24 offset:12800
    s_waitcnt lgkmcnt(10)
    v_mfma_f32_32x32x16_bf16 v[80:95], v[140:143], v[60:63], v[80:95]
    ds_read_b64_tr_b16 v[52:53], v25 offset:12288
    ds_read_b64_tr_b16 v[54:55], v25 offset:12800
    s_add_u32 m0, s58, 2048
    s_nop 0
    buffer_load_dwordx4 v30, s[16:19], s56 offen lds
    s_waitcnt lgkmcnt(10)
    v_mfma_f32_32x32x16_bf16 v[64:79], v[144:147], v[32:35], v[64:79]
    ds_read_b64_tr_b16 v[56:57], v24 offset:14336
    ds_read_b64_tr_b16 v[58:59], v24 offset:14848
    s_waitcnt lgkmcnt(10)
    v_mfma_f32_32x32x16_bf16 v[80:95], v[144:147], v[36:39], v[80:95]
    ds_read_b64_tr_b16 v[60:61], v25 offset:14336
    ds_read_b64_tr_b16 v[62:63], v25 offset:14848
    s_waitcnt lgkmcnt(10)
    v_mfma_f32_32x32x16_bf16 v[64:79], v[148:151], v[40:43], v[64:79]
    ds_read_b64_tr_b16 v[32:33], v24 offset:16384
    ds_read_b64_tr_b16 v[34:35], v24 offset:16896
    s_add_u32 m0, s59, 0
    s_nop 0
    buffer_load_dwordx4 v31, s[16:19], s56 offen lds
    s_add_u32 s56, s56, s57
    s_waitcnt lgkmcnt(10)
    v_mfma_f32_32x32x16_bf16 v[80:95], v[148:151], v[44:47], v[80:95]
    ds_read_b64_tr_b16 v[36:37], v25 offset:16384
    ds_read_b64_tr_b16 v[38:39], v25 offset:16896
    s_waitcnt lgkmcnt(10)
    v_mfma_f32_32x32x16_bf16 v[64:79], v[152:155], v[48:51], v[64:79]
    ds_read_b64_tr_b16 v[40:41], v24 offset:18432
    ds_read_b64_tr_b16 v[42:43], v24 offset:18944
    s_add_u32 s55, s41, 524288
    buffer_store_dwordx4 v[96:99], v1, s[8:11], s55 offen
    s_waitcnt lgkmcnt(10)
    v_mfma_f32_32x32x16_bf16 v[80:95], v[152:155], v[52:55], v[80:95]
    ds_read_b64_tr_b16 v[44:45], v25 offset:18432
    ds_read_b64_tr_b16 v[46:47], v25 offset:18944
    s_add_u32 m0, s58, 29184
    s_nop 0
    buffer_load_dwordx4 v28, s[16:19], s56 offen lds
    s_waitcnt lgkmcnt(10)
    v_mfma_f32_32x32x16_bf16 v[64:79], v[156:159], v[56:59], v[64:79]
    ds_read_b64_tr_b16 v[48:49], v24 offset:20480
    ds_read_b64_tr_b16 v[50:51], v24 offset:20992
    s_waitcnt lgkmcnt(10)
    v_mfma_f32_32x32x16_bf16 v[80:95], v[156:159], v[60:63], v[80:95]
    ds_read_b64_tr_b16 v[52:53], v25 offset:20480
    ds_read_b64_tr_b16 v[54:55], v25 offset:20992
    s_waitcnt lgkmcnt(10)
    v_mfma_f32_32x32x16_bf16 v[64:79], v[160:163], v[32:35], v[64:79]
    ds_read_b64_tr_b16 v[56:57], v24 offset:22528
    ds_read_b64_tr_b16 v[58:59], v24 offset:23040
    s_add_u32 m0, s58, 30208
    s_nop 0
    buffer_load_dwordx4 v29, s[16:19], s56 offen lds
    s_waitcnt lgkmcnt(10)
    v_mfma_f32_32x32x16_bf16 v[80:95], v[160:163], v[36:39], v[80:95]
    ds_read_b64_tr_b16 v[60:61], v25 offset:22528
    ds_read_b64_tr_b16 v[62:63], v25 offset:23040
    s_waitcnt lgkmcnt(10)
    v_mfma_f32_32x32x16_bf16 v[64:79], v[164:167], v[40:43], v[64:79]
    ds_read_b64_tr_b16 v[32:33], v24 offset:24576
    ds_read_b64_tr_b16 v[34:35], v24 offset:25088
    s_waitcnt lgkmcnt(10)
    v_mfma_f32_32x32x16_bf16 v[80:95], v[164:167], v[44:47], v[80:95]
    ds_read_b64_tr_b16 v[36:37], v25 offset:24576
    ds_read_b64_tr_b16 v[38:39], v25 offset:25088
    s_add_u32 m0, s58, 31232
    s_nop 0
    buffer_load_dwordx4 v30, s[16:19], s56 offen lds
    s_waitcnt lgkmcnt(10)
    v_mfma_f32_32x32x16_bf16 v[64:79], v[168:171], v[48:51], v[64:79]
    ds_read_b64_tr_b16 v[40:41], v24 offset:26624
    ds_read_b64_tr_b16 v[42:43], v24 offset:27136
    s_waitcnt lgkmcnt(10)
    v_mfma_f32_32x32x16_bf16 v[80:95], v[168:171], v[52:55], v[80:95]
    ds_read_b64_tr_b16 v[44:45], v25 offset:26624
    ds_read_b64_tr_b16 v[46:47], v25 offset:27136
    s_waitcnt lgkmcnt(10)
    v_mfma_f32_32x32x16_bf16 v[64:79], v[172:175], v[56:59], v[64:79]
    ds_read_b64_tr_b16 v[48:49], v24 offset:28672
    ds_read_b64_tr_b16 v[50:51], v24 offset:29184
    s_add_u32 m0, s59, 29184
    s_nop 0
    buffer_load_dwordx4 v31, s[16:19], s56 offen lds
    s_add_u32 s56, s56, s57
    s_waitcnt lgkmcnt(10)
    v_mfma_f32_32x32x16_bf16 v[80:95], v[172:175], v[60:63], v[80:95]
    ds_read_b64_tr_b16 v[52:53], v25 offset:28672
    ds_read_b64_tr_b16 v[54:55], v25 offset:29184
    s_waitcnt lgkmcnt(10)
    v_mfma_f32_32x32x16_bf16 v[64:79], v[176:179], v[32:35], v[64:79]
    ds_read_b64_tr_b16 v[56:57], v24 offset:30720
    ds_read_b64_tr_b16 v[58:59], v24 offset:31232
    s_add_u32 s55, s41, 525312
    buffer_store_dwordx4 v[100:103], v1, s[8:11], s55 offen
    s_waitcnt lgkmcnt(10)
    v_mfma_f32_32x32x16_bf16 v[80:95], v[176:179], v[36:39], v[80:95]
    ds_read_b64_tr_b16 v[60:61], v25 offset:30720
    ds_read_b64_tr_b16 v[62:63], v25 offset:31232
    s_waitcnt lgkmcnt(10)
    v_mfma_f32_32x32x16_bf16 v[64:79], v[180:183], v[40:43], v[64:79]
    s_waitcnt lgkmcnt(8)
    v_mfma_f32_32x32x16_bf16 v[80:95], v[180:183], v[44:47], v[80:95]
    s_waitcnt vmcnt(11)
    s_waitcnt lgkmcnt(0)
    s_barrier
    ds_read_b64_tr_b16 v[32:33], v26 offset:0
    ds_read_b64_tr_b16 v[34:35], v26 offset:512
    v_mfma_f32_32x32x16_bf16 v[64:79], v[184:187], v[48:51], v[64:79]
    ds_read_b64_tr_b16 v[36:37], v27 offset:0
    ds_read_b64_tr_b16 v[38:39], v27 offset:512
    v_mfma_f32_32x32x16_bf16 v[80:95], v[184:187], v[52:55], v[80:95]
    ds_read_b64_tr_b16 v[40:41], v26 offset:2048
    ds_read_b64_tr_b16 v[42:43], v26 offset:2560
    v_mfma_f32_32x32x16_bf16 v[64:79], v[188:191], v[56:59], v[64:79]
    ds_read_b64_tr_b16 v[44:45], v27 offset:2048
    ds_read_b64_tr_b16 v[46:47], v27 offset:2560
    v_mfma_f32_32x32x16_bf16 v[80:95], v[188:191], v[60:63], v[80:95]
    ds_read_b64_tr_b16 v[48:49], v26 offset:4096
    ds_read_b64_tr_b16 v[50:51], v26 offset:4608
    ds_read_b64_tr_b16 v[52:53], v27 offset:4096
    ds_read_b64_tr_b16 v[54:55], v27 offset:4608
    s_waitcnt lgkmcnt(10)
    v_mfma_f32_32x32x16_bf16 v[64:79], v[192:195], v[32:35], v[64:79]
    ds_read_b64_tr_b16 v[56:57], v26 offset:6144
    ds_read_b64_tr_b16 v[58:59], v26 offset:6656
    s_waitcnt lgkmcnt(10)
    v_mfma_f32_32x32x16_bf16 v[80:95], v[192:195], v[36:39], v[80:95]
    ds_read_b64_tr_b16 v[60:61], v27 offset:6144
    ds_read_b64_tr_b16 v[62:63], v27 offset:6656
    s_add_u32 s61, s60, 0
    buffer_load_dwordx4 v[128:131], v1, s[8:11], s61 offen offset:0 sc1
    s_waitcnt lgkmcnt(10)
    v_mfma_f32_32x32x16_bf16 v[64:79], v[196:199], v[40:43], v[64:79]
    ds_read_b64_tr_b16 v[32:33], v26 offset:8192
    ds_read_b64_tr_b16 v[34:35], v26 offset:8704
    s_waitcnt lgkmcnt(10)
    v_mfma_f32_32x32x16_bf16 v[80:95], v[196:199], v[44:47], v[80:95]
    ds_read_b64_tr_b16 v[36:37], v27 offset:8192
    ds_read_b64_tr_b16 v[38:39], v27 offset:8704
    s_waitcnt lgkmcnt(10)
    v_mfma_f32_32x32x16_bf16 v[64:79], v[200:203], v[48:51], v[64:79]
    ds_read_b64_tr_b16 v[40:41], v26 offset:10240
    ds_read_b64_tr_b16 v[42:43], v26 offset:10752
    buffer_load_dwordx4 v[132:135], v1, s[8:11], s61 offen offset:1024 sc1
    s_waitcnt lgkmcnt(10)
    v_mfma_f32_32x32x16_bf16 v[80:95], v[200:203], v[52:55], v[80:95]
    ds_read_b64_tr_b16 v[44:45], v27 offset:10240
    ds_read_b64_tr_b16 v[46:47], v27 offset:10752
    s_waitcnt lgkmcnt(10)
    v_mfma_f32_32x32x16_bf16 v[64:79], v[204:207], v[56:59], v[64:79]
    ds_read_b64_tr_b16 v[48:49], v26 offset:12288
    ds_read_b64_tr_b16 v[50:51], v26 offset:12800
    s_waitcnt lgkmcnt(10)
    v_mfma_f32_32x32x16_bf16 v[80:95], v[204:207], v[60:63], v[80:95]
    ds_read_b64_tr_b16 v[52:53], v27 offset:12288
    ds_read_b64_tr_b16 v[54:55], v27 offset:12800
    s_waitcnt lgkmcnt(10)
    v_mfma_f32_32x32x16_bf16 v[64:79], v[208:211], v[32:35], v[64:79]
    ds_read_b64_tr_b16 v[56:57], v26 offset:14336
    ds_read_b64_tr_b16 v[58:59], v26 offset:14848
    buffer_load_dwordx4 v[136:139], v1, s[8:11], s61 offen offset:2048 sc1
    s_waitcnt lgkmcnt(10)
    v_mfma_f32_32x32x16_bf16 v[80:95], v[208:211], v[36:39], v[80:95]
    ds_read_b64_tr_b16 v[60:61], v27 offset:14336
    ds_read_b64_tr_b16 v[62:63], v27 offset:14848
    s_waitcnt lgkmcnt(10)
    v_mfma_f32_32x32x16_bf16 v[64:79], v[212:215], v[40:43], v[64:79]
    ds_read_b64_tr_b16 v[32:33], v26 offset:16384
    ds_read_b64_tr_b16 v[34:35], v26 offset:16896
    s_waitcnt lgkmcnt(10)
    v_mfma_f32_32x32x16_bf16 v[80:95], v[212:215], v[44:47], v[80:95]
    ds_read_b64_tr_b16 v[36:37], v27 offset:16384
    ds_read_b64_tr_b16 v[38:39], v27 offset:16896
    buffer_load_dwordx4 v[140:143], v1, s[8:11], s61 offen offset:3072 sc1
    s_waitcnt lgkmcnt(10)
    v_mfma_f32_32x32x16_bf16 v[64:79], v[216:219], v[48:51], v[64:79]
    ds_read_b64_tr_b16 v[40:41], v26 offset:18432
    ds_read_b64_tr_b16 v[42:43], v26 offset:18944
    s_add_u32 s55, s41, 526336
    buffer_store_dwordx4 v[104:107], v1, s[8:11], s55 offen
    s_waitcnt lgkmcnt(10)
    v_mfma_f32_32x32x16_bf16 v[80:95], v[216:219], v[52:55], v[80:95]
    ds_read_b64_tr_b16 v[44:45], v27 offset:18432
    ds_read_b64_tr_b16 v[46:47], v27 offset:18944
    s_waitcnt lgkmcnt(10)
    v_mfma_f32_32x32x16_bf16 v[64:79], v[220:223], v[56:59], v[64:79]
    ds_read_b64_tr_b16 v[48:49], v26 offset:20480
    ds_read_b64_tr_b16 v[50:51], v26 offset:20992
    s_waitcnt lgkmcnt(10)
    v_mfma_f32_32x32x16_bf16 v[80:95], v[220:223], v[60:63], v[80:95]
    ds_read_b64_tr_b16 v[52:53], v27 offset:20480
    ds_read_b64_tr_b16 v[54:55], v27 offset:20992
    s_add_u32 m0, s58, 131072
    s_nop 0
    buffer_load_dwordx4 v28, s[16:19], s56 offen lds
    s_waitcnt lgkmcnt(10)
    v_mfma_f32_32x32x16_bf16 v[64:79], v[224:227], v[32:35], v[64:79]
    ds_read_b64_tr_b16 v[56:57], v26 offset:22528
    ds_read_b64_tr_b16 v[58:59], v26 offset:23040
    s_waitcnt lgkmcnt(10)
    v_mfma_f32_32x32x16_bf16 v[80:95], v[224:227], v[36:39], v[80:95]
    ds_read_b64_tr_b16 v[60:61], v27 offset:22528
    ds_read_b64_tr_b16 v[62:63], v27 offset:23040
    s_waitcnt lgkmcnt(10)
    v_mfma_f32_32x32x16_bf16 v[64:79], v[228:231], v[40:43], v[64:79]
    ds_read_b64_tr_b16 v[32:33], v26 offset:24576
    ds_read_b64_tr_b16 v[34:35], v26 offset:25088
    s_add_u32 m0, s58, 132096
    s_nop 0
    buffer_load_dwordx4 v29, s[16:19], s56 offen lds
    s_waitcnt lgkmcnt(10)
    v_mfma_f32_32x32x16_bf16 v[80:95], v[228:231], v[44:47], v[80:95]
    ds_read_b64_tr_b16 v[36:37], v27 offset:24576
    ds_read_b64_tr_b16 v[38:39], v27 offset:25088
    s_waitcnt lgkmcnt(10)
    v_mfma_f32_32x32x16_bf16 v[64:79], v[232:235], v[48:51], v[64:79]
    ds_read_b64_tr_b16 v[40:41], v26 offset:26624
    ds_read_b64_tr_b16 v[42:43], v26 offset:27136
    s_waitcnt lgkmcnt(10)
    v_mfma_f32_32x32x16_bf16 v[80:95], v[232:235], v[52:55], v[80:95]
    ds_read_b64_tr_b16 v[44:45], v27 offset:26624
    ds_read_b64_tr_b16 v[46:47], v27 offset:27136
    s_waitcnt lgkmcnt(10)
    v_mfma_f32_32x32x16_bf16 v[64:79], v[236:239], v[56:59], v[64:79]
    ds_read_b64_tr_b16 v[48:49], v26 offset:28672
    ds_read_b64_tr_b16 v[50:51], v26 offset:29184
    s_add_u32 m0, s58, 133120
    s_nop 0
    buffer_load_dwordx4 v30, s[16:19], s56 offen lds
    s_waitcnt lgkmcnt(10)
    v_mfma_f32_32x32x16_bf16 v[80:95], v[236:239], v[60:63], v[80:95]
    ds_read_b64_tr_b16 v[52:53], v27 offset:28672
    ds_read_b64_tr_b16 v[54:55], v27 offset:29184
    s_waitcnt lgkmcnt(10)
    v_mfma_f32_32x32x16_bf16 v[64:79], v[240:243], v[32:35], v[64:79]
    ds_read_b64_tr_b16 v[56:57], v26 offset:30720
    ds_read_b64_tr_b16 v[58:59], v26 offset:31232
    s_add_u32 s55, s41, 527360
    buffer_store_dwordx4 v[108:111], v1, s[8:11], s55 offen
    s_waitcnt lgkmcnt(10)
    v_mfma_f32_32x32x16_bf16 v[80:95], v[240:243], v[36:39], v[80:95]
    ds_read_b64_tr_b16 v[60:61], v27 offset:30720
    ds_read_b64_tr_b16 v[62:63], v27 offset:31232
    s_add_u32 m0, s59, 131072
    s_nop 0
    buffer_load_dwordx4 v31, s[16:19], s56 offen lds
    s_add_u32 s56, s56, s57
    s_waitcnt lgkmcnt(10)
    v_mfma_f32_32x32x16_bf16 v[64:79], v[244:247], v[40:43], v[64:79]
    s_waitcnt lgkmcnt(8)
    v_mfma_f32_32x32x16_bf16 v[80:95], v[244:247], v[44:47], v[80:95]
    s_waitcnt lgkmcnt(6)
    v_mfma_f32_32x32x16_bf16 v[64:79], v[248:251], v[48:51], v[64:79]
    s_waitcnt lgkmcnt(4)
    v_mfma_f32_32x32x16_bf16 v[80:95], v[248:251], v[52:55], v[80:95]
    s_waitcnt lgkmcnt(2)
    v_mfma_f32_32x32x16_bf16 v[64:79], v[252:255], v[56:59], v[64:79]
    s_waitcnt lgkmcnt(0)
    v_mfma_f32_32x32x16_bf16 v[80:95], v[252:255], v[60:63], v[80:95]
    s_nop 9
    v_cvt_pk_bf16_f32 v32, v64, v65
    v_cvt_pk_bf16_f32 v33, v66, v67
    v_cvt_pk_bf16_f32 v34, v68, v69
    v_cvt_pk_bf16_f32 v35, v70, v71
    v_cvt_pk_bf16_f32 v36, v72, v73
    v_cvt_pk_bf16_f32 v37, v74, v75
    v_cvt_pk_bf16_f32 v38, v76, v77
    v_cvt_pk_bf16_f32 v39, v78, v79
    v_cvt_pk_bf16_f32 v40, v80, v81
    v_cvt_pk_bf16_f32 v41, v82, v83
    v_cvt_pk_bf16_f32 v42, v84, v85
    v_cvt_pk_bf16_f32 v43, v86, v87
    v_cvt_pk_bf16_f32 v44, v88, v89
    v_cvt_pk_bf16_f32 v45, v90, v91
    v_cvt_pk_bf16_f32 v46, v92, v93
    v_cvt_pk_bf16_f32 v47, v94, v95
LF_p2:
    s_lshl_b32 s44, s21, 19
    s_lshl_b32 s46, s20, 11
    s_add_u32 s44, s44, s46
    s_add_u32 s45, s44, 0x1200000
    s_add_u32 s44, s44, 0x200000
    s_lshl_b32 s47, s24, 1
    s_add_u32 s47, s47, 2
    s_waitcnt vmcnt(16)
    s_waitcnt lgkmcnt(0)
    s_barrier
    v_add_u32 v9, 0, v6
    v_xor_b32 v10, 64, v9
    v_xor_b32 v11, 128, v9
    v_xor_b32 v12, 192, v9
    v_add_u32 v13, 0, v7
    ds_read_b64_tr_b16 v[192:193], v9 offset:0
    ds_read_b64_tr_b16 v[194:195], v9 offset:1024
    ds_read_b64_tr_b16 v[196:197], v10 offset:0
    ds_read_b64_tr_b16 v[198:199], v10 offset:1024
    ds_read_b64_tr_b16 v[200:201], v11 offset:0
    ds_read_b64_tr_b16 v[202:203], v11 offset:1024
    ds_read_b64_tr_b16 v[204:205], v12 offset:0
    ds_read_b64_tr_b16 v[206:207], v12 offset:1024
    ds_read_b64_tr_b16 v[208:209], v13 offset:0
    ds_read_b64_tr_b16 v[210:211], v13 offset:384
    ds_read_b64_tr_b16 v[212:213], v13 offset:32
    ds_read_b64_tr_b16 v[214:215], v13 offset:416
    ds_read_b64_tr_b16 v[216:217], v13 offset:64
    ds_read_b64_tr_b16 v[218:219], v13 offset:448
    s_waitcnt vmcnt(9) lgkmcnt(12)
    v_mfma_f32_32x32x16_bf16 v[48:63], v[192:195], v[128:131], 0
    ds_read_b64_tr_b16 v[220:221], v9 offset:4096
    ds_read_b64_tr_b16 v[222:223], v9 offset:5120
    s_add_u32 s61, s60, 4096
    s_waitcnt lgkmcnt(12)
    v_mfma_f32_32x32x16_bf16 v[64:79], v[196:199], v[128:131], 0
    ds_read_b64_tr_b16 v[224:225], v10 offset:4096
    ds_read_b64_tr_b16 v[226:227], v10 offset:5120
    buffer_load_dwordx4 v[144:147], v1, s[8:11], s61 offen offset:0 sc1
    s_waitcnt lgkmcnt(12)
    v_mfma_f32_32x32x16_bf16 v[80:95], v[200:203], v[128:131], 0
    ds_read_b64_tr_b16 v[228:229], v11 offset:4096
    ds_read_b64_tr_b16 v[230:231], v11 offset:5120
    buffer_load_dwordx4 v[148:151], v1, s[8:11], s61 offen offset:1024 sc1
    s_waitcnt lgkmcnt(12)
    v_mfma_f32_32x32x16_bf16 v[96:111], v[204:207], v[128:131], 0
    ds_read_b64_tr_b16 v[232:233], v12 offset:4096
    ds_read_b64_tr_b16 v[234:235], v12 offset:5120
    buffer_load_dwordx4 v[152:155], v1, s[8:11], s61 offen offset:2048 sc1
    s_waitcnt lgkmcnt(12)
    v_mfma_f32_32x32x16_bf16 v[112:127], v[208:211], v[128:131], 0
    ds_read_b64_tr_b16 v[236:237], v13 offset:1536
    ds_read_b64_tr_b16 v[238:239], v13 offset:1920
    buffer_load_dwordx4 v[156:159], v1, s[8:11], s61 offen offset:3072 sc1
    s_waitcnt lgkmcnt(12)
    v_mfma_f32_32x32x16_bf16 v[160:175], v[212:215], v[128:131], 0
    ds_read_b64_tr_b16 v[240:241], v13 offset:1568
    ds_read_b64_tr_b16 v[242:243], v13 offset:1952
    s_waitcnt lgkmcnt(12)
    v_mfma_f32_32x32x16_bf16 v[176:191], v[216:219], v[128:131], 0
    ds_read_b64_tr_b16 v[244:245], v13 offset:1600
    ds_read_b64_tr_b16 v[246:247], v13 offset:1984
    s_waitcnt vmcnt(12) lgkmcnt(12)
    v_mfma_f32_32x32x16_bf16 v[48:63], v[220:223], v[132:135], v[48:63]
    ds_read_b64_tr_b16 v[192:193], v9 offset:8192
    ds_read_b64_tr_b16 v[194:195], v9 offset:9216
    s_waitcnt lgkmcnt(12)
    v_mfma_f32_32x32x16_bf16 v[64:79], v[224:227], v[132:135], v[64:79]
    ds_read_b64_tr_b16 v[196:197], v10 offset:8192
    ds_read_b64_tr_b16 v[198:199], v10 offset:9216
    s_waitcnt lgkmcnt(12)
    v_mfma_f32_32x32x16_bf16 v[80:95], v[228:231], v[132:135], v[80:95]
    ds_read_b64_tr_b16 v[200:201], v11 offset:8192
    ds_read_b64_tr_b16 v[202:203], v11 offset:9216
    s_waitcnt lgkmcnt(12)
    v_mfma_f32_32x32x16_bf16 v[96:111], v[232:235], v[132:135], v[96:111]
    ds_read_b64_tr_b16 v[204:205], v12 offset:8192
    ds_read_b64_tr_b16 v[206:207], v12 offset:9216
    s_add_u32 s55, s41, 528384
    buffer_store_dwordx4 v[32:35], v1, s[8:11], s55 offen
    s_waitcnt lgkmcnt(12)
    v_mfma_f32_32x32x16_bf16 v[112:127], v[236:239], v[132:135], v[112:127]
    ds_read_b64_tr_b16 v[208:209], v13 offset:3072
    ds_read_b64_tr_b16 v[210:211], v13 offset:3456
    s_waitcnt lgkmcnt(12)
    v_mfma_f32_32x32x16_bf16 v[160:175], v[240:243], v[132:135], v[160:175]
    ds_read_b64_tr_b16 v[212:213], v13 offset:3104
    ds_read_b64_tr_b16 v[214:215], v13 offset:3488
    s_waitcnt lgkmcnt(12)
    v_mfma_f32_32x32x16_bf16 v[176:191], v[244:247], v[132:135], v[176:191]
    ds_read_b64_tr_b16 v[216:217], v13 offset:3136
    ds_read_b64_tr_b16 v[218:219], v13 offset:3520
    s_waitcnt vmcnt(12) lgkmcnt(12)
    v_mfma_f32_32x32x16_bf16 v[48:63], v[192:195], v[136:139], v[48:63]
    ds_read_b64_tr_b16 v[220:221], v9 offset:12288
    ds_read_b64_tr_b16 v[222:223], v9 offset:13312
    s_waitcnt lgkmcnt(12)
    v_mfma_f32_32x32x16_bf16 v[64:79], v[196:199], v[136:139], v[64:79]
    ds_read_b64_tr_b16 v[224:225], v10 offset:12288
    ds_read_b64_tr_b16 v[226:227], v10 offset:13312
    s_waitcnt lgkmcnt(12)
    v_mfma_f32_32x32x16_bf16 v[80:95], v[200:203], v[136:139], v[80:95]
    ds_read_b64_tr_b16 v[228:229], v11 offset:12288
    ds_read_b64_tr_b16 v[230:231], v11 offset:13312
    s_waitcnt lgkmcnt(12)
    v_mfma_f32_32x32x16_bf16 v[96:111], v[204:207], v[136:139], v[96:111]
    ds_read_b64_tr_b16 v[232:233], v12 offset:12288
    ds_read_b64_tr_b16 v[234:235], v12 offset:13312
    s_barrier
    s_waitcnt lgkmcnt(12)
    v_mfma_f32_32x32x16_bf16 v[112:127], v[208:211], v[136:139], v[112:127]
    ds_read_b64_tr_b16 v[236:237], v13 offset:4608
    ds_read_b64_tr_b16 v[238:239], v13 offset:4992
    s_add_u32 m0, s58, 65536
    s_nop 0
    buffer_load_dwordx4 v28, s[16:19], s56 offen lds
    s_waitcnt lgkmcnt(12)
    v_mfma_f32_32x32x16_bf16 v[160:175], v[212:215], v[136:139], v[160:175]
    ds_read_b64_tr_b16 v[240:241], v13 offset:4640
    ds_read_b64_tr_b16 v[242:243], v13 offset:5024
    s_waitcnt lgkmcnt(12)
    v_mfma_f32_32x32x16_bf16 v[176:191], v[216:219], v[136:139], v[176:191]
    ds_read_b64_tr_b16 v[244:245], v13 offset:4672
    ds_read_b64_tr_b16 v[246:247], v13 offset:5056
    v_add_u32 v9, 29184, v6
    v_xor_b32 v10, 64, v9
    v_xor_b32 v11, 128, v9
    v_xor_b32 v12, 192, v9
    v_add_u32 v13, 29184, v7
    s_waitcnt vmcnt(12) lgkmcnt(12)
    v_mfma_f32_32x32x16_bf16 v[48:63], v[220:223], v[140:143], v[48:63]
    ds_read_b64_tr_b16 v[192:193], v9 offset:0
    ds_read_b64_tr_b16 v[194:195], v9 offset:1024
    s_add_u32 m0, s58, 66560
    s_nop 0
    buffer_load_dwordx4 v29, s[16:19], s56 offen lds
    s_waitcnt lgkmcnt(12)
    v_mfma_f32_32x32x16_bf16 v[64:79], v[224:227], v[140:143], v[64:79]
    ds_read_b64_tr_b16 v[196:197], v10 offset:0
    ds_read_b64_tr_b16 v[198:199], v10 offset:1024
    s_waitcnt lgkmcnt(12)
    v_mfma_f32_32x32x16_bf16 v[80:95], v[228:231], v[140:143], v[80:95]
    ds_read_b64_tr_b16 v[200:201], v11 offset:0
    ds_read_b64_tr_b16 v[202:203], v11 offset:1024
    s_add_u32 m0, s58, 67584
    s_nop 0
    buffer_load_dwordx4 v30, s[16:19], s56 offen lds
    s_waitcnt lgkmcnt(12)
    v_mfma_f32_32x32x16_bf16 v[96:111], v[232:235], v[140:143], v[96:111]
    ds_read_b64_tr_b16 v[204:205], v12 offset:0
    ds_read_b64_tr_b16 v[206:207], v12 offset:1024
    s_waitcnt lgkmcnt(12)
    v_mfma_f32_32x32x16_bf16 v[112:127], v[236:239], v[140:143], v[112:127]
    ds_read_b64_tr_b16 v[208:209], v13 offset:0
    ds_read_b64_tr_b16 v[210:211], v13 offset:384
    s_add_u32 m0, s59, 65536
    s_nop 0
    buffer_load_dwordx4 v31, s[16:19], s56 offen lds
    s_add_u32 s56, s56, s57
    s_waitcnt lgkmcnt(12)
    v_mfma_f32_32x32x16_bf16 v[160:175], v[240:243], v[140:143], v[160:175]
    ds_read_b64_tr_b16 v[212:213], v13 offset:32
    ds_read_b64_tr_b16 v[214:215], v13 offset:416
    s_waitcnt lgkmcnt(12)
    v_mfma_f32_32x32x16_bf16 v[176:191], v[244:247], v[140:143], v[176:191]
    ds_read_b64_tr_b16 v[216:217], v13 offset:64
    ds_read_b64_tr_b16 v[218:219], v13 offset:448
    s_waitcnt vmcnt(8) lgkmcnt(12)
    v_mfma_f32_32x32x16_bf16 v[48:63], v[192:195], v[144:147], v[48:63]
    ds_read_b64_tr_b16 v[220:221], v9 offset:4096
    ds_read_b64_tr_b16 v[222:223], v9 offset:5120
    s_add_u32 s61, s60, 8192
    s_waitcnt lgkmcnt(12)
    v_mfma_f32_32x32x16_bf16 v[64:79], v[196:199], v[144:147], v[64:79]
    ds_read_b64_tr_b16 v[224:225], v10 offset:4096
    ds_read_b64_tr_b16 v[226:227], v10 offset:5120
    buffer_load_dwordx4 v[128:131], v1, s[8:11], s61 offen offset:0 sc1
    s_waitcnt lgkmcnt(12)
    v_mfma_f32_32x32x16_bf16 v[80:95], v[200:203], v[144:147], v[80:95]
    ds_read_b64_tr_b16 v[228:229], v11 offset:4096
    ds_read_b64_tr_b16 v[230:231], v11 offset:5120
    buffer_load_dwordx4 v[132:135], v1, s[8:11], s61 offen offset:1024 sc1
    s_waitcnt lgkmcnt(12)
    v_mfma_f32_32x32x16_bf16 v[96:111], v[204:207], v[144:147], v[96:111]
    ds_read_b64_tr_b16 v[232:233], v12 offset:4096
    ds_read_b64_tr_b16 v[234:235], v12 offset:5120
    buffer_load_dwordx4 v[136:139], v1, s[8:11], s61 offen offset:2048 sc1
    s_waitcnt lgkmcnt(12)
    v_mfma_f32_32x32x16_bf16 v[112:127], v[208:211], v[144:147], v[112:127]
    ds_read_b64_tr_b16 v[236:237], v13 offset:1536
    ds_read_b64_tr_b16 v[238:239], v13 offset:1920
    buffer_load_dwordx4 v[140:143], v1, s[8:11], s61 offen offset:3072 sc1
    s_waitcnt lgkmcnt(12)
    v_mfma_f32_32x32x16_bf16 v[160:175], v[212:215], v[144:147], v[160:175]
    ds_read_b64_tr_b16 v[240:241], v13 offset:1568
    ds_read_b64_tr_b16 v[242:243], v13 offset:1952
    s_waitcnt lgkmcnt(12)
    v_mfma_f32_32x32x16_bf16 v[176:191], v[216:219], v[144:147], v[176:191]
    ds_read_b64_tr_b16 v[244:245], v13 offset:1600
    ds_read_b64_tr_b16 v[246:247], v13 offset:1984
    s_waitcnt vmcnt(11) lgkmcnt(12)
    v_mfma_f32_32x32x16_bf16 v[48:63], v[220:223], v[148:151], v[48:63]
    ds_read_b64_tr_b16 v[192:193], v9 offset:8192
    ds_read_b64_tr_b16 v[194:195], v9 offset:9216
    s_waitcnt lgkmcnt(12)
    v_mfma_f32_32x32x16_bf16 v[64:79], v[224:227], v[148:151], v[64:79]
    ds_read_b64_tr_b16 v[196:197], v10 offset:8192
    ds_read_b64_tr_b16 v[198:199], v10 offset:9216
    s_waitcnt lgkmcnt(12)
    v_mfma_f32_32x32x16_bf16 v[80:95], v[228:231], v[148:151], v[80:95]
    ds_read_b64_tr_b16 v[200:201], v11 offset:8192
    ds_read_b64_tr_b16 v[202:203], v11 offset:9216
    s_waitcnt lgkmcnt(12)
    v_mfma_f32_32x32x16_bf16 v[96:111], v[232:235], v[148:151], v[96:111]
    ds_read_b64_tr_b16 v[204:205], v12 offset:8192
    ds_read_b64_tr_b16 v[206:207], v12 offset:9216
    s_add_u32 s55, s41, 529408
    buffer_store_dwordx4 v[36:39], v1, s[8:11], s55 offen
    s_waitcnt lgkmcnt(12)
    v_mfma_f32_32x32x16_bf16 v[112:127], v[236:239], v[148:151], v[112:127]
    ds_read_b64_tr_b16 v[208:209], v13 offset:3072
    ds_read_b64_tr_b16 v[210:211], v13 offset:3456
    s_waitcnt lgkmcnt(12)
    v_mfma_f32_32x32x16_bf16 v[160:175], v[240:243], v[148:151], v[160:175]
    ds_read_b64_tr_b16 v[212:213], v13 offset:3104
    ds_read_b64_tr_b16 v[214:215], v13 offset:3488
    s_waitcnt lgkmcnt(12)
    v_mfma_f32_32x32x16_bf16 v[176:191], v[244:247], v[148:151], v[176:191]
    ds_read_b64_tr_b16 v[216:217], v13 offset:3136
    ds_read_b64_tr_b16 v[218:219], v13 offset:3520
    s_waitcnt vmcnt(11) lgkmcnt(12)
    v_mfma_f32_32x32x16_bf16 v[48:63], v[192:195], v[152:155], v[48:63]
    ds_read_b64_tr_b16 v[220:221], v9 offset:12288
    ds_read_b64_tr_b16 v[222:223], v9 offset:13312
    s_waitcnt lgkmcnt(12)
    v_mfma_f32_32x32x16_bf16 v[64:79], v[196:199], v[152:155], v[64:79]
    ds_read_b64_tr_b16 v[224:225], v10 offset:12288
    ds_read_b64_tr_b16 v[226:227], v10 offset:13312
    s_waitcnt lgkmcnt(12)
    v_mfma_f32_32x32x16_bf16 v[80:95], v[200:203], v[152:155], v[80:95]
    ds_read_b64_tr_b16 v[228:229], v11 offset:12288
    ds_read_b64_tr_b16 v[230:231], v11 offset:13312
    s_waitcnt lgkmcnt(12)
    v_mfma_f32_32x32x16_bf16 v[96:111], v[204:207], v[152:155], v[96:111]
    ds_read_b64_tr_b16 v[232:233], v12 offset:12288
    ds_read_b64_tr_b16 v[234:235], v12 offset:13312
    s_barrier
    s_waitcnt lgkmcnt(12)
    v_mfma_f32_32x32x16_bf16 v[112:127], v[208:211], v[152:155], v[112:127]
    ds_read_b64_tr_b16 v[236:237], v13 offset:4608
    ds_read_b64_tr_b16 v[238:239], v13 offset:4992
    s_add_u32 m0, s58, 0
    s_nop 0
    buffer_load_dwordx4 v28, s[16:19], s56 offen lds
    s_waitcnt lgkmcnt(12)
    v_mfma_f32_32x32x16_bf16 v[160:175], v[212:215], v[152:155], v[160:175]
    ds_read_b64_tr_b16 v[240:241], v13 offset:4640
    ds_read_b64_tr_b16 v[242:243], v13 offset:5024
    s_waitcnt lgkmcnt(12)
    v_mfma_f32_32x32x16_bf16 v[176:191], v[216:219], v[152:155], v[176:191]
    ds_read_b64_tr_b16 v[244:245], v13 offset:4672
    ds_read_b64_tr_b16 v[246:247], v13 offset:5056
    v_add_u32 v9, 131072, v6
    v_xor_b32 v10, 64, v9
    v_xor_b32 v11, 128, v9
    v_xor_b32 v12, 192, v9
    v_add_u32 v13, 131072, v7
    s_waitcnt vmcnt(11) lgkmcnt(12)
    v_mfma_f32_32x32x16_bf16 v[48:63], v[220:223], v[156:159], v[48:63]
    ds_read_b64_tr_b16 v[192:193], v9 offset:0
    ds_read_b64_tr_b16 v[194:195], v9 offset:1024
    s_add_u32 m0, s58, 1024
    s_nop 0
    buffer_load_dwordx4 v29, s[16:19], s56 offen lds
    s_waitcnt lgkmcnt(12)
    v_mfma_f32_32x32x16_bf16 v[64:79], v[224:227], v[156:159], v[64:79]
    ds_read_b64_tr_b16 v[196:197], v10 offset:0
    ds_read_b64_tr_b16 v[198:199], v10 offset:1024
    s_waitcnt lgkmcnt(12)
    v_mfma_f32_32x32x16_bf16 v[80:95], v[228:231], v[156:159], v[80:95]
    ds_read_b64_tr_b16 v[200:201], v11 offset:0
    ds_read_b64_tr_b16 v[202:203], v11 offset:1024
    s_add_u32 m0, s58, 2048
    s_nop 0
    buffer_load_dwordx4 v30, s[16:19], s56 offen lds
    s_waitcnt lgkmcnt(12)
    v_mfma_f32_32x32x16_bf16 v[96:111], v[232:235], v[156:159], v[96:111]
    ds_read_b64_tr_b16 v[204:205], v12 offset:0
    ds_read_b64_tr_b16 v[206:207], v12 offset:1024
    s_waitcnt lgkmcnt(12)
    v_mfma_f32_32x32x16_bf16 v[112:127], v[236:239], v[156:159], v[112:127]
    ds_read_b64_tr_b16 v[208:209], v13 offset:0
    ds_read_b64_tr_b16 v[210:211], v13 offset:384
    s_add_u32 m0, s59, 0
    s_nop 0
    buffer_load_dwordx4 v31, s[16:19], s56 offen lds
    s_add_u32 s56, s56, s57
    s_waitcnt lgkmcnt(12)
    v_mfma_f32_32x32x16_bf16 v[160:175], v[240:243], v[156:159], v[160:175]
    ds_read_b64_tr_b16 v[212:213], v13 offset:32
    ds_read_b64_tr_b16 v[214:215], v13 offset:416
    s_waitcnt lgkmcnt(12)
    v_mfma_f32_32x32x16_bf16 v[176:191], v[244:247], v[156:159], v[176:191]
    ds_read_b64_tr_b16 v[216:217], v13 offset:64
    ds_read_b64_tr_b16 v[218:219], v13 offset:448
    s_waitcnt vmcnt(8) lgkmcnt(12)
    v_mfma_f32_32x32x16_bf16 v[48:63], v[192:195], v[128:131], v[48:63]
    ds_read_b64_tr_b16 v[220:221], v9 offset:4096
    ds_read_b64_tr_b16 v[222:223], v9 offset:5120
    s_add_u32 s61, s60, 12288
    s_waitcnt lgkmcnt(12)
    v_mfma_f32_32x32x16_bf16 v[64:79], v[196:199], v[128:131], v[64:79]
    ds_read_b64_tr_b16 v[224:225], v10 offset:4096
    ds_read_b64_tr_b16 v[226:227], v10 offset:5120
    buffer_load_dwordx4 v[144:147], v1, s[8:11], s61 offen offset:0 sc1
    s_waitcnt lgkmcnt(12)
    v_mfma_f32_32x32x16_bf16 v[80:95], v[200:203], v[128:131], v[80:95]
    ds_read_b64_tr_b16 v[228:229], v11 offset:4096
    ds_read_b64_tr_b16 v[230:231], v11 offset:5120
    buffer_load_dwordx4 v[148:151], v1, s[8:11], s61 offen offset:1024 sc1
    s_waitcnt lgkmcnt(12)
    v_mfma_f32_32x32x16_bf16 v[96:111], v[204:207], v[128:131], v[96:111]
    ds_read_b64_tr_b16 v[232:233], v12 offset:4096
    ds_read_b64_tr_b16 v[234:235], v12 offset:5120
    buffer_load_dwordx4 v[152:155], v1, s[8:11], s61 offen offset:2048 sc1
    s_waitcnt lgkmcnt(12)
    v_mfma_f32_32x32x16_bf16 v[112:127], v[208:211], v[128:131], v[112:127]
    ds_read_b64_tr_b16 v[236:237], v13 offset:1536
    ds_read_b64_tr_b16 v[238:239], v13 offset:1920
    buffer_load_dwordx4 v[156:159], v1, s[8:11], s61 offen offset:3072 sc1
    s_waitcnt lgkmcnt(12)
    v_mfma_f32_32x32x16_bf16 v[160:175], v[212:215], v[128:131], v[160:175]
    ds_read_b64_tr_b16 v[240:241], v13 offset:1568
    ds_read_b64_tr_b16 v[242:243], v13 offset:1952
    s_waitcnt lgkmcnt(12)
    v_mfma_f32_32x32x16_bf16 v[176:191], v[216:219], v[128:131], v[176:191]
    ds_read_b64_tr_b16 v[244:245], v13 offset:1600
    ds_read_b64_tr_b16 v[246:247], v13 offset:1984
    s_waitcnt vmcnt(11) lgkmcnt(12)
    v_mfma_f32_32x32x16_bf16 v[48:63], v[220:223], v[132:135], v[48:63]
    ds_read_b64_tr_b16 v[192:193], v9 offset:8192
    ds_read_b64_tr_b16 v[194:195], v9 offset:9216
    s_waitcnt lgkmcnt(12)
    v_mfma_f32_32x32x16_bf16 v[64:79], v[224:227], v[132:135], v[64:79]
    ds_read_b64_tr_b16 v[196:197], v10 offset:8192
    ds_read_b64_tr_b16 v[198:199], v10 offset:9216
    s_waitcnt lgkmcnt(12)
    v_mfma_f32_32x32x16_bf16 v[80:95], v[228:231], v[132:135], v[80:95]
    ds_read_b64_tr_b16 v[200:201], v11 offset:8192
    ds_read_b64_tr_b16 v[202:203], v11 offset:9216
    s_waitcnt lgkmcnt(12)
    v_mfma_f32_32x32x16_bf16 v[96:111], v[232:235], v[132:135], v[96:111]
    ds_read_b64_tr_b16 v[204:205], v12 offset:8192
    ds_read_b64_tr_b16 v[206:207], v12 offset:9216
    s_add_u32 s55, s41, 530432
    buffer_store_dwordx4 v[40:43], v1, s[8:11], s55 offen
    s_waitcnt lgkmcnt(12)
    v_mfma_f32_32x32x16_bf16 v[112:127], v[236:239], v[132:135], v[112:127]
    ds_read_b64_tr_b16 v[208:209], v13 offset:3072
    ds_read_b64_tr_b16 v[210:211], v13 offset:3456
    s_waitcnt lgkmcnt(12)
    v_mfma_f32_32x32x16_bf16 v[160:175], v[240:243], v[132:135], v[160:175]
    ds_read_b64_tr_b16 v[212:213], v13 offset:3104
    ds_read_b64_tr_b16 v[214:215], v13 offset:3488
    s_waitcnt lgkmcnt(12)
    v_mfma_f32_32x32x16_bf16 v[176:191], v[244:247], v[132:135], v[176:191]
    ds_read_b64_tr_b16 v[216:217], v13 offset:3136
    ds_read_b64_tr_b16 v[218:219], v13 offset:3520
    s_waitcnt vmcnt(11) lgkmcnt(12)
    v_mfma_f32_32x32x16_bf16 v[48:63], v[192:195], v[136:139], v[48:63]
    ds_read_b64_tr_b16 v[220:221], v9 offset:12288
    ds_read_b64_tr_b16 v[222:223], v9 offset:13312
    s_waitcnt lgkmcnt(12)
    v_mfma_f32_32x32x16_bf16 v[64:79], v[196:199], v[136:139], v[64:79]
    ds_read_b64_tr_b16 v[224:225], v10 offset:12288
    ds_read_b64_tr_b16 v[226:227], v10 offset:13312
    s_waitcnt lgkmcnt(12)
    v_mfma_f32_32x32x16_bf16 v[80:95], v[200:203], v[136:139], v[80:95]
    ds_read_b64_tr_b16 v[228:229], v11 offset:12288
    ds_read_b64_tr_b16 v[230:231], v11 offset:13312
    s_waitcnt lgkmcnt(12)
    v_mfma_f32_32x32x16_bf16 v[96:111], v[204:207], v[136:139], v[96:111]
    ds_read_b64_tr_b16 v[232:233], v12 offset:12288
    ds_read_b64_tr_b16 v[234:235], v12 offset:13312
    s_barrier
    s_waitcnt lgkmcnt(12)
    v_mfma_f32_32x32x16_bf16 v[112:127], v[208:211], v[136:139], v[112:127]
    ds_read_b64_tr_b16 v[236:237], v13 offset:4608
    ds_read_b64_tr_b16 v[238:239], v13 offset:4992
    s_add_u32 m0, s58, 29184
    s_nop 0
    buffer_load_dwordx4 v28, s[16:19], s56 offen lds
    s_waitcnt lgkmcnt(12)
    v_mfma_f32_32x32x16_bf16 v[160:175], v[212:215], v[136:139], v[160:175]
    ds_read_b64_tr_b16 v[240:241], v13 offset:4640
    ds_read_b64_tr_b16 v[242:243], v13 offset:5024
    s_waitcnt lgkmcnt(12)
    v_mfma_f32_32x32x16_bf16 v[176:191], v[216:219], v[136:139], v[176:191]
    ds_read_b64_tr_b16 v[244:245], v13 offset:4672
    ds_read_b64_tr_b16 v[246:247], v13 offset:5056
    v_add_u32 v9, 65536, v6
    v_xor_b32 v10, 64, v9
    v_xor_b32 v11, 128, v9
    v_xor_b32 v12, 192, v9
    v_add_u32 v13, 65536, v7
    s_waitcnt vmcnt(11) lgkmcnt(12)
    v_mfma_f32_32x32x16_bf16 v[48:63], v[220:223], v[140:143], v[48:63]
    ds_read_b64_tr_b16 v[192:193], v9 offset:0
    ds_read_b64_tr_b16 v[194:195], v9 offset:1024
    s_add_u32 m0, s58, 30208
    s_nop 0
    buffer_load_dwordx4 v29, s[16:19], s56 offen lds
    s_waitcnt lgkmcnt(12)
    v_mfma_f32_32x32x16_bf16 v[64:79], v[224:227], v[140:143], v[64:79]
    ds_read_b64_tr_b16 v[196:197], v10 offset:0
    ds_read_b64_tr_b16 v[198:199], v10 offset:1024
    s_waitcnt lgkmcnt(12)
    v_mfma_f32_32x32x16_bf16 v[80:95], v[228:231], v[140:143], v[80:95]
    ds_read_b64_tr_b16 v[200:201], v11 offset:0
    ds_read_b64_tr_b16 v[202:203], v11 offset:1024
    s_add_u32 m0, s58, 31232
    s_nop 0
    buffer_load_dwordx4 v30, s[16:19], s56 offen lds
    s_waitcnt lgkmcnt(12)
    v_mfma_f32_32x32x16_bf16 v[96:111], v[232:235], v[140:143], v[96:111]
    ds_read_b64_tr_b16 v[204:205], v12 offset:0
    ds_read_b64_tr_b16 v[206:207], v12 offset:1024
    s_waitcnt lgkmcnt(12)
    v_mfma_f32_32x32x16_bf16 v[112:127], v[236:239], v[140:143], v[112:127]
    ds_read_b64_tr_b16 v[208:209], v13 offset:0
    ds_read_b64_tr_b16 v[210:211], v13 offset:384
    s_add_u32 m0, s59, 29184
    s_nop 0
    buffer_load_dwordx4 v31, s[16:19], s56 offen lds
    s_add_u32 s56, s56, s57
    s_waitcnt lgkmcnt(12)
    v_mfma_f32_32x32x16_bf16 v[160:175], v[240:243], v[140:143], v[160:175]
    ds_read_b64_tr_b16 v[212:213], v13 offset:32
    ds_read_b64_tr_b16 v[214:215], v13 offset:416
    s_waitcnt lgkmcnt(12)
    v_mfma_f32_32x32x16_bf16 v[176:191], v[244:247], v[140:143], v[176:191]
    ds_read_b64_tr_b16 v[216:217], v13 offset:64
    ds_read_b64_tr_b16 v[218:219], v13 offset:448
    s_waitcnt vmcnt(8) lgkmcnt(12)
    v_mfma_f32_32x32x16_bf16 v[48:63], v[192:195], v[144:147], v[48:63]
    ds_read_b64_tr_b16 v[220:221], v9 offset:4096
    ds_read_b64_tr_b16 v[222:223], v9 offset:5120
    s_add_u32 s61, s60, 16384
    s_waitcnt lgkmcnt(12)
    v_mfma_f32_32x32x16_bf16 v[64:79], v[196:199], v[144:147], v[64:79]
    ds_read_b64_tr_b16 v[224:225], v10 offset:4096
    ds_read_b64_tr_b16 v[226:227], v10 offset:5120
    buffer_load_dwordx4 v[128:131], v1, s[8:11], s61 offen offset:0 sc1
    s_waitcnt lgkmcnt(12)
    v_mfma_f32_32x32x16_bf16 v[80:95], v[200:203], v[144:147], v[80:95]
    ds_read_b64_tr_b16 v[228:229], v11 offset:4096
    ds_read_b64_tr_b16 v[230:231], v11 offset:5120
    buffer_load_dwordx4 v[132:135], v1, s[8:11], s61 offen offset:1024 sc1
    s_waitcnt lgkmcnt(12)
    v_mfma_f32_32x32x16_bf16 v[96:111], v[204:207], v[144:147], v[96:111]
    ds_read_b64_tr_b16 v[232:233], v12 offset:4096
    ds_read_b64_tr_b16 v[234:235], v12 offset:5120
    buffer_load_dwordx4 v[136:139], v1, s[8:11], s61 offen offset:2048 sc1
    s_waitcnt lgkmcnt(12)
    v_mfma_f32_32x32x16_bf16 v[112:127], v[208:211], v[144:147], v[112:127]
    ds_read_b64_tr_b16 v[236:237], v13 offset:1536
    ds_read_b64_tr_b16 v[238:239], v13 offset:1920
    buffer_load_dwordx4 v[140:143], v1, s[8:11], s61 offen offset:3072 sc1
    s_waitcnt lgkmcnt(12)
    v_mfma_f32_32x32x16_bf16 v[160:175], v[212:215], v[144:147], v[160:175]
    ds_read_b64_tr_b16 v[240:241], v13 offset:1568
    ds_read_b64_tr_b16 v[242:243], v13 offset:1952
    s_waitcnt lgkmcnt(12)
    v_mfma_f32_32x32x16_bf16 v[176:191], v[216:219], v[144:147], v[176:191]
    ds_read_b64_tr_b16 v[244:245], v13 offset:1600
    ds_read_b64_tr_b16 v[246:247], v13 offset:1984
    s_cmp_lg_u32 s20, 0
    s_cbranch_scc1 LF_pi7
    v_mov_b32 v8, 0
    buffer_load_dword v14, v8, s[96:99], s101 offen sc1
    buffer_load_dword v15, v8, s[96:99], s101 offen sc1
LF_pi7:
    s_waitcnt vmcnt(11) lgkmcnt(12)
    v_mfma_f32_32x32x16_bf16 v[48:63], v[220:223], v[148:151], v[48:63]
    ds_read_b64_tr_b16 v[192:193], v9 offset:8192
    ds_read_b64_tr_b16 v[194:195], v9 offset:9216
    s_waitcnt lgkmcnt(12)
    v_mfma_f32_32x32x16_bf16 v[64:79], v[224:227], v[148:151], v[64:79]
    ds_read_b64_tr_b16 v[196:197], v10 offset:8192
    ds_read_b64_tr_b16 v[198:199], v10 offset:9216
    s_waitcnt lgkmcnt(12)
    v_mfma_f32_32x32x16_bf16 v[80:95], v[228:231], v[148:151], v[80:95]
    ds_read_b64_tr_b16 v[200:201], v11 offset:8192
    ds_read_b64_tr_b16 v[202:203], v11 offset:9216
    s_waitcnt lgkmcnt(12)
    v_mfma_f32_32x32x16_bf16 v[96:111], v[232:235], v[148:151], v[96:111]
    ds_read_b64_tr_b16 v[204:205], v12 offset:8192
    ds_read_b64_tr_b16 v[206:207], v12 offset:9216
    s_add_u32 s55, s41, 531456
    buffer_store_dwordx4 v[44:47], v1, s[8:11], s55 offen
    s_waitcnt lgkmcnt(12)
    v_mfma_f32_32x32x16_bf16 v[112:127], v[236:239], v[148:151], v[112:127]
    ds_read_b64_tr_b16 v[208:209], v13 offset:3072
    ds_read_b64_tr_b16 v[210:211], v13 offset:3456
    s_waitcnt lgkmcnt(12)
    v_mfma_f32_32x32x16_bf16 v[160:175], v[240:243], v[148:151], v[160:175]
    ds_read_b64_tr_b16 v[212:213], v13 offset:3104
    ds_read_b64_tr_b16 v[214:215], v13 offset:3488
    s_waitcnt lgkmcnt(12)
    v_mfma_f32_32x32x16_bf16 v[176:191], v[244:247], v[148:151], v[176:191]
    ds_read_b64_tr_b16 v[216:217], v13 offset:3136
    ds_read_b64_tr_b16 v[218:219], v13 offset:3520
    s_waitcnt vmcnt(11) lgkmcnt(12)
    v_mfma_f32_32x32x16_bf16 v[48:63], v[192:195], v[152:155], v[48:63]
    ds_read_b64_tr_b16 v[220:221], v9 offset:12288
    ds_read_b64_tr_b16 v[222:223], v9 offset:13312
    s_waitcnt lgkmcnt(12)
    v_mfma_f32_32x32x16_bf16 v[64:79], v[196:199], v[152:155], v[64:79]
    ds_read_b64_tr_b16 v[224:225], v10 offset:12288
    ds_read_b64_tr_b16 v[226:227], v10 offset:13312
    s_waitcnt lgkmcnt(12)
    v_mfma_f32_32x32x16_bf16 v[80:95], v[200:203], v[152:155], v[80:95]
    ds_read_b64_tr_b16 v[228:229], v11 offset:12288
    ds_read_b64_tr_b16 v[230:231], v11 offset:13312
    s_waitcnt lgkmcnt(12)
    v_mfma_f32_32x32x16_bf16 v[96:111], v[204:207], v[152:155], v[96:111]
    ds_read_b64_tr_b16 v[232:233], v12 offset:12288
    ds_read_b64_tr_b16 v[234:235], v12 offset:13312
    s_barrier
    s_waitcnt lgkmcnt(12)
    v_mfma_f32_32x32x16_bf16 v[112:127], v[208:211], v[152:155], v[112:127]
    ds_read_b64_tr_b16 v[236:237], v13 offset:4608
    ds_read_b64_tr_b16 v[238:239], v13 offset:4992
    s_add_u32 m0, s58, 131072
    s_nop 0
    buffer_load_dwordx4 v28, s[16:19], s56 offen lds
    s_waitcnt lgkmcnt(12)
    v_mfma_f32_32x32x16_bf16 v[160:175], v[212:215], v[152:155], v[160:175]
    ds_read_b64_tr_b16 v[240:241], v13 offset:4640
    ds_read_b64_tr_b16 v[242:243], v13 offset:5024
    s_waitcnt lgkmcnt(12)
    v_mfma_f32_32x32x16_bf16 v[176:191], v[216:219], v[152:155], v[176:191]
    ds_read_b64_tr_b16 v[244:245], v13 offset:4672
    ds_read_b64_tr_b16 v[246:247], v13 offset:5056
    v_add_u32 v9, 0, v6
    v_xor_b32 v10, 64, v9
    v_xor_b32 v11, 128, v9
    v_xor_b32 v12, 192, v9
    v_add_u32 v13, 0, v7
    s_waitcnt vmcnt(11) lgkmcnt(12)
    v_mfma_f32_32x32x16_bf16 v[48:63], v[220:223], v[156:159], v[48:63]
    ds_read_b64_tr_b16 v[192:193], v9 offset:0
    ds_read_b64_tr_b16 v[194:195], v9 offset:1024
    s_add_u32 m0, s58, 132096
    s_nop 0
    buffer_load_dwordx4 v29, s[16:19], s56 offen lds
    s_waitcnt lgkmcnt(12)
    v_mfma_f32_32x32x16_bf16 v[64:79], v[224:227], v[156:159], v[64:79]
    ds_read_b64_tr_b16 v[196:197], v10 offset:0
    ds_read_b64_tr_b16 v[198:199], v10 offset:1024
    s_waitcnt lgkmcnt(12)
    v_mfma_f32_32x32x16_bf16 v[80:95], v[228:231], v[156:159], v[80:95]
    ds_read_b64_tr_b16 v[200:201], v11 offset:0
    ds_read_b64_tr_b16 v[202:203], v11 offset:1024
    s_add_u32 m0, s58, 133120
    s_nop 0
    buffer_load_dwordx4 v30, s[16:19], s56 offen lds
    s_waitcnt lgkmcnt(12)
    v_mfma_f32_32x32x16_bf16 v[96:111], v[232:235], v[156:159], v[96:111]
    ds_read_b64_tr_b16 v[204:205], v12 offset:0
    ds_read_b64_tr_b16 v[206:207], v12 offset:1024
    s_waitcnt lgkmcnt(12)
    v_mfma_f32_32x32x16_bf16 v[112:127], v[236:239], v[156:159], v[112:127]
    ds_read_b64_tr_b16 v[208:209], v13 offset:0
    ds_read_b64_tr_b16 v[210:211], v13 offset:384
    s_add_u32 m0, s59, 131072
    s_nop 0
    buffer_load_dwordx4 v31, s[16:19], s56 offen lds
    s_add_u32 s56, s56, s57
    s_waitcnt lgkmcnt(12)
    v_mfma_f32_32x32x16_bf16 v[160:175], v[240:243], v[156:159], v[160:175]
    ds_read_b64_tr_b16 v[212:213], v13 offset:32
    ds_read_b64_tr_b16 v[214:215], v13 offset:416
    s_waitcnt lgkmcnt(12)
    v_mfma_f32_32x32x16_bf16 v[176:191], v[244:247], v[156:159], v[176:191]
    ds_read_b64_tr_b16 v[216:217], v13 offset:64
    ds_read_b64_tr_b16 v[218:219], v13 offset:448
    s_waitcnt vmcnt(8) lgkmcnt(12)
    v_mfma_f32_32x32x16_bf16 v[48:63], v[192:195], v[128:131], v[48:63]
    ds_read_b64_tr_b16 v[220:221], v9 offset:4096
    ds_read_b64_tr_b16 v[222:223], v9 offset:5120
    s_add_u32 s61, s60, 20480
    s_waitcnt lgkmcnt(12)
    v_mfma_f32_32x32x16_bf16 v[64:79], v[196:199], v[128:131], v[64:79]
    ds_read_b64_tr_b16 v[224:225], v10 offset:4096
    ds_read_b64_tr_b16 v[226:227], v10 offset:5120
    buffer_load_dwordx4 v[144:147], v1, s[8:11], s61 offen offset:0 sc1
    s_waitcnt lgkmcnt(12)
    v_mfma_f32_32x32x16_bf16 v[80:95], v[200:203], v[128:131], v[80:95]
    ds_read_b64_tr_b16 v[228:229], v11 offset:4096
    ds_read_b64_tr_b16 v[230:231], v11 offset:5120
    buffer_load_dwordx4 v[148:151], v1, s[8:11], s61 offen offset:1024 sc1
    s_waitcnt lgkmcnt(12)
    v_mfma_f32_32x32x16_bf16 v[96:111], v[204:207], v[128:131], v[96:111]
    ds_read_b64_tr_b16 v[232:233], v12 offset:4096
    ds_read_b64_tr_b16 v[234:235], v12 offset:5120
    buffer_load_dwordx4 v[152:155], v1, s[8:11], s61 offen offset:2048 sc1
    s_waitcnt lgkmcnt(12)
    v_mfma_f32_32x32x16_bf16 v[112:127], v[208:211], v[128:131], v[112:127]
    ds_read_b64_tr_b16 v[236:237], v13 offset:1536
    ds_read_b64_tr_b16 v[238:239], v13 offset:1920
    buffer_load_dwordx4 v[156:159], v1, s[8:11], s61 offen offset:3072 sc1
    s_waitcnt lgkmcnt(12)
    v_mfma_f32_32x32x16_bf16 v[160:175], v[212:215], v[128:131], v[160:175]
    ds_read_b64_tr_b16 v[240:241], v13 offset:1568
    ds_read_b64_tr_b16 v[242:243], v13 offset:1952
    s_waitcnt lgkmcnt(12)
    v_mfma_f32_32x32x16_bf16 v[176:191], v[216:219], v[128:131], v[176:191]
    ds_read_b64_tr_b16 v[244:245], v13 offset:1600
    ds_read_b64_tr_b16 v[246:247], v13 offset:1984
    s_waitcnt vmcnt(11) lgkmcnt(12)
    v_mfma_f32_32x32x16_bf16 v[48:63], v[220:223], v[132:135], v[48:63]
    ds_read_b64_tr_b16 v[192:193], v9 offset:8192
    ds_read_b64_tr_b16 v[194:195], v9 offset:9216
    s_waitcnt lgkmcnt(12)
    v_mfma_f32_32x32x16_bf16 v[64:79], v[224:227], v[132:135], v[64:79]
    ds_read_b64_tr_b16 v[196:197], v10 offset:8192
    ds_read_b64_tr_b16 v[198:199], v10 offset:9216
    s_waitcnt lgkmcnt(12)
    v_mfma_f32_32x32x16_bf16 v[80:95], v[228:231], v[132:135], v[80:95]
    ds_read_b64_tr_b16 v[200:201], v11 offset:8192
    ds_read_b64_tr_b16 v[202:203], v11 offset:9216
    s_waitcnt lgkmcnt(12)
    v_mfma_f32_32x32x16_bf16 v[96:111], v[232:235], v[132:135], v[96:111]
    ds_read_b64_tr_b16 v[204:205], v12 offset:8192
    ds_read_b64_tr_b16 v[206:207], v12 offset:9216
    s_waitcnt lgkmcnt(12)
    v_mfma_f32_32x32x16_bf16 v[112:127], v[236:239], v[132:135], v[112:127]
    ds_read_b64_tr_b16 v[208:209], v13 offset:3072
    ds_read_b64_tr_b16 v[210:211], v13 offset:3456
    s_waitcnt lgkmcnt(12)
    v_mfma_f32_32x32x16_bf16 v[160:175], v[240:243], v[132:135], v[160:175]
    ds_read_b64_tr_b16 v[212:213], v13 offset:3104
    ds_read_b64_tr_b16 v[214:215], v13 offset:3488
    s_waitcnt lgkmcnt(12)
    v_mfma_f32_32x32x16_bf16 v[176:191], v[244:247], v[132:135], v[176:191]
    ds_read_b64_tr_b16 v[216:217], v13 offset:3136
    ds_read_b64_tr_b16 v[218:219], v13 offset:3520
    s_waitcnt vmcnt(10) lgkmcnt(12)
    v_mfma_f32_32x32x16_bf16 v[48:63], v[192:195], v[136:139], v[48:63]
    ds_read_b64_tr_b16 v[220:221], v9 offset:12288
    ds_read_b64_tr_b16 v[222:223], v9 offset:13312
    s_waitcnt lgkmcnt(12)
    v_mfma_f32_32x32x16_bf16 v[64:79], v[196:199], v[136:139], v[64:79]
    ds_read_b64_tr_b16 v[224:225], v10 offset:12288
    ds_read_b64_tr_b16 v[226:227], v10 offset:13312
    s_waitcnt lgkmcnt(12)
    v_mfma_f32_32x32x16_bf16 v[80:95], v[200:203], v[136:139], v[80:95]
    ds_read_b64_tr_b16 v[228:229], v11 offset:12288
    ds_read_b64_tr_b16 v[230:231], v11 offset:13312
    s_waitcnt lgkmcnt(12)
    v_mfma_f32_32x32x16_bf16 v[96:111], v[204:207], v[136:139], v[96:111]
    ds_read_b64_tr_b16 v[232:233], v12 offset:12288
    ds_read_b64_tr_b16 v[234:235], v12 offset:13312
    s_waitcnt vmcnt(8)
    s_barrier
    s_cmp_lg_u32 s20, 0
    s_cbranch_scc1 LF_pkv8
    v_readfirstlane_b32 s100, v15
    s_nop 1
    s_and_b32 s3, s100, 63
    s_bfe_u32 s29, s100, 0x90006
    s_lshr_b32 s30, s100, 15
    s_mul_i32 s29, s29, s29
    s_lshl_b32 s30, s30, 5
    s_cmp_eq_u32 s29, s30
    s_cselect_b32 s94, 1, 0
    s_cmp_eq_u32 s3, 32
    s_cselect_b32 s94, s94, 0
    s_cmp_lg_u32 s94, 0
    s_cbranch_scc1 LF_pkv8_fast
    buffer_wbl2 sc1
    s_waitcnt vmcnt(0)
LF_pkv8_fast:
    v_mov_b32 v14, 1
    v_mov_b32 v15, 0
    s_mov_b64 exec, 1
    buffer_atomic_add v14, v15, s[96:99], s33 offen sc1
    s_mov_b64 exec, -1
LF_pkv8:
    s_waitcnt lgkmcnt(12)
    v_mfma_f32_32x32x16_bf16 v[112:127], v[208:211], v[136:139], v[112:127]
    ds_read_b64_tr_b16 v[236:237], v13 offset:4608
    ds_read_b64_tr_b16 v[238:239], v13 offset:4992
    s_add_u32 m0, s58, 65536
    s_nop 0
    buffer_load_dwordx4 v28, s[16:19], s56 offen lds
    s_waitcnt lgkmcnt(12)
    v_mfma_f32_32x32x16_bf16 v[160:175], v[212:215], v[136:139], v[160:175]
    ds_read_b64_tr_b16 v[240:241], v13 offset:4640
    ds_read_b64_tr_b16 v[242:243], v13 offset:5024
    s_waitcnt lgkmcnt(12)
    v_mfma_f32_32x32x16_bf16 v[176:191], v[216:219], v[136:139], v[176:191]
    ds_read_b64_tr_b16 v[244:245], v13 offset:4672
    ds_read_b64_tr_b16 v[246:247], v13 offset:5056
    v_add_u32 v9, 29184, v6
    v_xor_b32 v10, 64, v9
    v_xor_b32 v11, 128, v9
    v_xor_b32 v12, 192, v9
    v_add_u32 v13, 29184, v7
    s_waitcnt lgkmcnt(12)
    v_mfma_f32_32x32x16_bf16 v[48:63], v[220:223], v[140:143], v[48:63]
    ds_read_b64_tr_b16 v[192:193], v9 offset:0
    ds_read_b64_tr_b16 v[194:195], v9 offset:1024
    s_add_u32 m0, s58, 66560
    s_nop 0
    buffer_load_dwordx4 v29, s[16:19], s56 offen lds
    s_waitcnt lgkmcnt(12)
    v_mfma_f32_32x32x16_bf16 v[64:79], v[224:227], v[140:143], v[64:79]
    ds_read_b64_tr_b16 v[196:197], v10 offset:0
    ds_read_b64_tr_b16 v[198:199], v10 offset:1024
    s_waitcnt lgkmcnt(12)
    v_mfma_f32_32x32x16_bf16 v[80:95], v[228:231], v[140:143], v[80:95]
    ds_read_b64_tr_b16 v[200:201], v11 offset:0
    ds_read_b64_tr_b16 v[202:203], v11 offset:1024
    s_add_u32 m0, s58, 67584
    s_nop 0
    buffer_load_dwordx4 v30, s[16:19], s56 offen lds
    s_waitcnt lgkmcnt(12)
    v_mfma_f32_32x32x16_bf16 v[96:111], v[232:235], v[140:143], v[96:111]
    ds_read_b64_tr_b16 v[204:205], v12 offset:0
    ds_read_b64_tr_b16 v[206:207], v12 offset:1024
    s_waitcnt lgkmcnt(12)
    v_mfma_f32_32x32x16_bf16 v[112:127], v[236:239], v[140:143], v[112:127]
    ds_read_b64_tr_b16 v[208:209], v13 offset:0
    ds_read_b64_tr_b16 v[210:211], v13 offset:384
    s_add_u32 m0, s59, 65536
    s_nop 0
    buffer_load_dwordx4 v31, s[16:19], s56 offen lds
    s_add_u32 s56, s56, s57
    s_waitcnt lgkmcnt(12)
    v_mfma_f32_32x32x16_bf16 v[160:175], v[240:243], v[140:143], v[160:175]
    ds_read_b64_tr_b16 v[212:213], v13 offset:32
    ds_read_b64_tr_b16 v[214:215], v13 offset:416
    s_waitcnt lgkmcnt(12)
    v_mfma_f32_32x32x16_bf16 v[176:191], v[244:247], v[140:143], v[176:191]
    ds_read_b64_tr_b16 v[216:217], v13 offset:64
    ds_read_b64_tr_b16 v[218:219], v13 offset:448
    s_waitcnt vmcnt(7) lgkmcnt(12)
    v_mfma_f32_32x32x16_bf16 v[48:63], v[192:195], v[144:147], v[48:63]
    ds_read_b64_tr_b16 v[220:221], v9 offset:4096
    ds_read_b64_tr_b16 v[222:223], v9 offset:5120
    s_add_u32 s61, s60, 24576
    s_waitcnt lgkmcnt(12)
    v_mfma_f32_32x32x16_bf16 v[64:79], v[196:199], v[144:147], v[64:79]
    ds_read_b64_tr_b16 v[224:225], v10 offset:4096
    ds_read_b64_tr_b16 v[226:227], v10 offset:5120
    buffer_load_dwordx4 v[128:131], v1, s[8:11], s61 offen offset:0 sc1
    s_waitcnt lgkmcnt(12)
    v_mfma_f32_32x32x16_bf16 v[80:95], v[200:203], v[144:147], v[80:95]
    ds_read_b64_tr_b16 v[228:229], v11 offset:4096
    ds_read_b64_tr_b16 v[230:231], v11 offset:5120
    buffer_load_dwordx4 v[132:135], v1, s[8:11], s61 offen offset:1024 sc1
    s_waitcnt lgkmcnt(12)
    v_mfma_f32_32x32x16_bf16 v[96:111], v[204:207], v[144:147], v[96:111]
    ds_read_b64_tr_b16 v[232:233], v12 offset:4096
    ds_read_b64_tr_b16 v[234:235], v12 offset:5120
    buffer_load_dwordx4 v[136:139], v1, s[8:11], s61 offen offset:2048 sc1
    s_waitcnt lgkmcnt(12)
    v_mfma_f32_32x32x16_bf16 v[112:127], v[208:211], v[144:147], v[112:127]
    ds_read_b64_tr_b16 v[236:237], v13 offset:1536
    ds_read_b64_tr_b16 v[238:239], v13 offset:1920
    buffer_load_dwordx4 v[140:143], v1, s[8:11], s61 offen offset:3072 sc1
    s_waitcnt lgkmcnt(12)
    v_mfma_f32_32x32x16_bf16 v[160:175], v[212:215], v[144:147], v[160:175]
    ds_read_b64_tr_b16 v[240:241], v13 offset:1568
    ds_read_b64_tr_b16 v[242:243], v13 offset:1952
    s_waitcnt lgkmcnt(12)
    v_mfma_f32_32x32x16_bf16 v[176:191], v[216:219], v[144:147], v[176:191]
    ds_read_b64_tr_b16 v[244:245], v13 offset:1600
    ds_read_b64_tr_b16 v[246:247], v13 offset:1984
    s_waitcnt vmcnt(10) lgkmcnt(12)
    v_mfma_f32_32x32x16_bf16 v[48:63], v[220:223], v[148:151], v[48:63]
    ds_read_b64_tr_b16 v[192:193], v9 offset:8192
    ds_read_b64_tr_b16 v[194:195], v9 offset:9216
    s_waitcnt lgkmcnt(12)
    v_mfma_f32_32x32x16_bf16 v[64:79], v[224:227], v[148:151], v[64:79]
    ds_read_b64_tr_b16 v[196:197], v10 offset:8192
    ds_read_b64_tr_b16 v[198:199], v10 offset:9216
    s_waitcnt lgkmcnt(12)
    v_mfma_f32_32x32x16_bf16 v[80:95], v[228:231], v[148:151], v[80:95]
    ds_read_b64_tr_b16 v[200:201], v11 offset:8192
    ds_read_b64_tr_b16 v[202:203], v11 offset:9216
    s_waitcnt lgkmcnt(12)
    v_mfma_f32_32x32x16_bf16 v[96:111], v[232:235], v[148:151], v[96:111]
    ds_read_b64_tr_b16 v[204:205], v12 offset:8192
    ds_read_b64_tr_b16 v[206:207], v12 offset:9216
    s_waitcnt lgkmcnt(12)
    v_mfma_f32_32x32x16_bf16 v[112:127], v[236:239], v[148:151], v[112:127]
    ds_read_b64_tr_b16 v[208:209], v13 offset:3072
    ds_read_b64_tr_b16 v[210:211], v13 offset:3456
    s_waitcnt lgkmcnt(12)
    v_mfma_f32_32x32x16_bf16 v[160:175], v[240:243], v[148:151], v[160:175]
    ds_read_b64_tr_b16 v[212:213], v13 offset:3104
    ds_read_b64_tr_b16 v[214:215], v13 offset:3488
    s_waitcnt lgkmcnt(12)
    v_mfma_f32_32x32x16_bf16 v[176:191], v[244:247], v[148:151], v[176:191]
    ds_read_b64_tr_b16 v[216:217], v13 offset:3136
    ds_read_b64_tr_b16 v[218:219], v13 offset:3520
    s_waitcnt vmcnt(9) lgkmcnt(12)
    v_mfma_f32_32x32x16_bf16 v[48:63], v[192:195], v[152:155], v[48:63]
    ds_read_b64_tr_b16 v[220:221], v9 offset:12288
    ds_read_b64_tr_b16 v[222:223], v9 offset:13312
    s_waitcnt lgkmcnt(12)
    v_mfma_f32_32x32x16_bf16 v[64:79], v[196:199], v[152:155], v[64:79]
    ds_read_b64_tr_b16 v[224:225], v10 offset:12288
    ds_read_b64_tr_b16 v[226:227], v10 offset:13312
    s_waitcnt lgkmcnt(12)
    v_mfma_f32_32x32x16_bf16 v[80:95], v[200:203], v[152:155], v[80:95]
    ds_read_b64_tr_b16 v[228:229], v11 offset:12288
    ds_read_b64_tr_b16 v[230:231], v11 offset:13312
    s_waitcnt lgkmcnt(12)
    v_mfma_f32_32x32x16_bf16 v[96:111], v[204:207], v[152:155], v[96:111]
    ds_read_b64_tr_b16 v[232:233], v12 offset:12288
    ds_read_b64_tr_b16 v[234:235], v12 offset:13312
    s_barrier
    s_waitcnt lgkmcnt(12)
    v_mfma_f32_32x32x16_bf16 v[112:127], v[208:211], v[152:155], v[112:127]
    ds_read_b64_tr_b16 v[236:237], v13 offset:4608
    ds_read_b64_tr_b16 v[238:239], v13 offset:4992
    s_waitcnt lgkmcnt(12)
    v_mfma_f32_32x32x16_bf16 v[160:175], v[212:215], v[152:155], v[160:175]
    ds_read_b64_tr_b16 v[240:241], v13 offset:4640
    ds_read_b64_tr_b16 v[242:243], v13 offset:5024
    s_waitcnt lgkmcnt(12)
    v_mfma_f32_32x32x16_bf16 v[176:191], v[216:219], v[152:155], v[176:191]
    ds_read_b64_tr_b16 v[244:245], v13 offset:4672
    ds_read_b64_tr_b16 v[246:247], v13 offset:5056
    v_add_u32 v9, 131072, v6
    v_xor_b32 v10, 64, v9
    v_xor_b32 v11, 128, v9
    v_xor_b32 v12, 192, v9
    v_add_u32 v13, 131072, v7
    s_waitcnt vmcnt(8) lgkmcnt(12)
    v_mfma_f32_32x32x16_bf16 v[48:63], v[220:223], v[156:159], v[48:63]
    ds_read_b64_tr_b16 v[192:193], v9 offset:0
    ds_read_b64_tr_b16 v[194:195], v9 offset:1024
    s_waitcnt lgkmcnt(12)
    v_mfma_f32_32x32x16_bf16 v[64:79], v[224:227], v[156:159], v[64:79]
    ds_read_b64_tr_b16 v[196:197], v10 offset:0
    ds_read_b64_tr_b16 v[198:199], v10 offset:1024
    s_waitcnt lgkmcnt(12)
    v_mfma_f32_32x32x16_bf16 v[80:95], v[228:231], v[156:159], v[80:95]
    ds_read_b64_tr_b16 v[200:201], v11 offset:0
    ds_read_b64_tr_b16 v[202:203], v11 offset:1024
    s_waitcnt lgkmcnt(12)
    v_mfma_f32_32x32x16_bf16 v[96:111], v[232:235], v[156:159], v[96:111]
    ds_read_b64_tr_b16 v[204:205], v12 offset:0
    ds_read_b64_tr_b16 v[206:207], v12 offset:1024
    s_waitcnt lgkmcnt(12)
    v_mfma_f32_32x32x16_bf16 v[112:127], v[236:239], v[156:159], v[112:127]
    ds_read_b64_tr_b16 v[208:209], v13 offset:0
    ds_read_b64_tr_b16 v[210:211], v13 offset:384
    s_waitcnt lgkmcnt(12)
    v_mfma_f32_32x32x16_bf16 v[160:175], v[240:243], v[156:159], v[160:175]
    ds_read_b64_tr_b16 v[212:213], v13 offset:32
    ds_read_b64_tr_b16 v[214:215], v13 offset:416
    s_waitcnt lgkmcnt(12)
    v_mfma_f32_32x32x16_bf16 v[176:191], v[244:247], v[156:159], v[176:191]
    ds_read_b64_tr_b16 v[216:217], v13 offset:64
    ds_read_b64_tr_b16 v[218:219], v13 offset:448
    s_waitcnt vmcnt(3) lgkmcnt(12)
    v_mfma_f32_32x32x16_bf16 v[48:63], v[192:195], v[128:131], v[48:63]
    ds_read_b64_tr_b16 v[220:221], v9 offset:4096
    ds_read_b64_tr_b16 v[222:223], v9 offset:5120
    s_add_u32 s61, s60, 28672
    s_waitcnt lgkmcnt(12)
    v_mfma_f32_32x32x16_bf16 v[64:79], v[196:199], v[128:131], v[64:79]
    ds_read_b64_tr_b16 v[224:225], v10 offset:4096
    ds_read_b64_tr_b16 v[226:227], v10 offset:5120
    buffer_load_dwordx4 v[144:147], v1, s[8:11], s61 offen offset:0 sc1
    s_waitcnt lgkmcnt(12)
    v_mfma_f32_32x32x16_bf16 v[80:95], v[200:203], v[128:131], v[80:95]
    ds_read_b64_tr_b16 v[228:229], v11 offset:4096
    ds_read_b64_tr_b16 v[230:231], v11 offset:5120
    buffer_load_dwordx4 v[148:151], v1, s[8:11], s61 offen offset:1024 sc1
    s_waitcnt lgkmcnt(12)
    v_mfma_f32_32x32x16_bf16 v[96:111], v[204:207], v[128:131], v[96:111]
    ds_read_b64_tr_b16 v[232:233], v12 offset:4096
    ds_read_b64_tr_b16 v[234:235], v12 offset:5120
    buffer_load_dwordx4 v[152:155], v1, s[8:11], s61 offen offset:2048 sc1
    s_waitcnt lgkmcnt(12)
    v_mfma_f32_32x32x16_bf16 v[112:127], v[208:211], v[128:131], v[112:127]
    ds_read_b64_tr_b16 v[236:237], v13 offset:1536
    ds_read_b64_tr_b16 v[238:239], v13 offset:1920
    buffer_load_dwordx4 v[156:159], v1, s[8:11], s61 offen offset:3072 sc1
    s_waitcnt lgkmcnt(12)
    v_mfma_f32_32x32x16_bf16 v[160:175], v[212:215], v[128:131], v[160:175]
    ds_read_b64_tr_b16 v[240:241], v13 offset:1568
    ds_read_b64_tr_b16 v[242:243], v13 offset:1952
    s_waitcnt lgkmcnt(12)
    v_mfma_f32_32x32x16_bf16 v[176:191], v[216:219], v[128:131], v[176:191]
    ds_read_b64_tr_b16 v[244:245], v13 offset:1600
    ds_read_b64_tr_b16 v[246:247], v13 offset:1984
    s_waitcnt vmcnt(6) lgkmcnt(12)
    v_mfma_f32_32x32x16_bf16 v[48:63], v[220:223], v[132:135], v[48:63]
    ds_read_b64_tr_b16 v[192:193], v9 offset:8192
    ds_read_b64_tr_b16 v[194:195], v9 offset:9216
    s_waitcnt lgkmcnt(12)
    v_mfma_f32_32x32x16_bf16 v[64:79], v[224:227], v[132:135], v[64:79]
    ds_read_b64_tr_b16 v[196:197], v10 offset:8192
    ds_read_b64_tr_b16 v[198:199], v10 offset:9216
    s_lshr_b32 s29, s21, 1
    s_add_u32 s29, s29, 16
    s_lshl_b32 s29, s29, 2
    s_cmp_lg_u32 s20, 0
    s_cbranch_scc1 LF_pi9
    v_mov_b32 v8, 0
    buffer_load_dword v14, v8, s[96:99], s29 offen sc1
LF_pi9:
    s_waitcnt lgkmcnt(12)
    v_mfma_f32_32x32x16_bf16 v[80:95], v[228:231], v[132:135], v[80:95]
    ds_read_b64_tr_b16 v[200:201], v11 offset:8192
    ds_read_b64_tr_b16 v[202:203], v11 offset:9216
    s_waitcnt lgkmcnt(12)
    v_mfma_f32_32x32x16_bf16 v[96:111], v[232:235], v[132:135], v[96:111]
    ds_read_b64_tr_b16 v[204:205], v12 offset:8192
    ds_read_b64_tr_b16 v[206:207], v12 offset:9216
    s_waitcnt lgkmcnt(12)
    v_mfma_f32_32x32x16_bf16 v[112:127], v[236:239], v[132:135], v[112:127]
    ds_read_b64_tr_b16 v[208:209], v13 offset:3072
    ds_read_b64_tr_b16 v[210:211], v13 offset:3456
    s_waitcnt lgkmcnt(12)
    v_mfma_f32_32x32x16_bf16 v[160:175], v[240:243], v[132:135], v[160:175]
    ds_read_b64_tr_b16 v[212:213], v13 offset:3104
    ds_read_b64_tr_b16 v[214:215], v13 offset:3488
    s_waitcnt lgkmcnt(12)
    v_mfma_f32_32x32x16_bf16 v[176:191], v[244:247], v[132:135], v[176:191]
    ds_read_b64_tr_b16 v[216:217], v13 offset:3136
    ds_read_b64_tr_b16 v[218:219], v13 offset:3520
    s_waitcnt vmcnt(5) lgkmcnt(12)
    v_mfma_f32_32x32x16_bf16 v[48:63], v[192:195], v[136:139], v[48:63]
    ds_read_b64_tr_b16 v[220:221], v9 offset:12288
    ds_read_b64_tr_b16 v[222:223], v9 offset:13312
    s_waitcnt lgkmcnt(12)
    v_mfma_f32_32x32x16_bf16 v[64:79], v[196:199], v[136:139], v[64:79]
    ds_read_b64_tr_b16 v[224:225], v10 offset:12288
    ds_read_b64_tr_b16 v[226:227], v10 offset:13312
    s_waitcnt lgkmcnt(12)
    v_mfma_f32_32x32x16_bf16 v[80:95], v[200:203], v[136:139], v[80:95]
    ds_read_b64_tr_b16 v[228:229], v11 offset:12288
    ds_read_b64_tr_b16 v[230:231], v11 offset:13312
    s_waitcnt lgkmcnt(12)
    v_mfma_f32_32x32x16_bf16 v[96:111], v[204:207], v[136:139], v[96:111]
    ds_read_b64_tr_b16 v[232:233], v12 offset:12288
    ds_read_b64_tr_b16 v[234:235], v12 offset:13312
    s_barrier
    s_cmp_lg_u32 s20, 0
    s_cbranch_scc1 LF_pc10
    s_waitcnt vmcnt(0)
    v_readfirstlane_b32 s100, v14
    s_nop 1
    s_cmp_lt_u32 s100, 16
    s_cbranch_scc1 LF_pc10_slow
LF_pc10_ok:
    s_cmp_lg_u32 s94, 0
    s_cbranch_scc1 LF_pc10
    buffer_inv sc1
LF_pc10:
    s_waitcnt lgkmcnt(12)
    v_mfma_f32_32x32x16_bf16 v[112:127], v[208:211], v[136:139], v[112:127]
    ds_read_b64_tr_b16 v[236:237], v13 offset:4608
    ds_read_b64_tr_b16 v[238:239], v13 offset:4992
    s_waitcnt lgkmcnt(12)
    v_mfma_f32_32x32x16_bf16 v[160:175], v[212:215], v[136:139], v[160:175]
    ds_read_b64_tr_b16 v[240:241], v13 offset:4640
    ds_read_b64_tr_b16 v[242:243], v13 offset:5024
    s_waitcnt lgkmcnt(12)
    v_mfma_f32_32x32x16_bf16 v[176:191], v[216:219], v[136:139], v[176:191]
    ds_read_b64_tr_b16 v[244:245], v13 offset:4672
    ds_read_b64_tr_b16 v[246:247], v13 offset:5056
    v_add_u32 v9, 65536, v6
    v_xor_b32 v10, 64, v9
    v_xor_b32 v11, 128, v9
    v_xor_b32 v12, 192, v9
    v_add_u32 v13, 65536, v7
    s_waitcnt vmcnt(4) lgkmcnt(12)
    v_mfma_f32_32x32x16_bf16 v[48:63], v[220:223], v[140:143], v[48:63]
    ds_read_b64_tr_b16 v[192:193], v9 offset:0
    ds_read_b64_tr_b16 v[194:195], v9 offset:1024
    s_waitcnt lgkmcnt(12)
    v_mfma_f32_32x32x16_bf16 v[64:79], v[224:227], v[140:143], v[64:79]
    ds_read_b64_tr_b16 v[196:197], v10 offset:0
    ds_read_b64_tr_b16 v[198:199], v10 offset:1024
    s_waitcnt lgkmcnt(12)
    v_mfma_f32_32x32x16_bf16 v[80:95], v[228:231], v[140:143], v[80:95]
    ds_read_b64_tr_b16 v[200:201], v11 offset:0
    ds_read_b64_tr_b16 v[202:203], v11 offset:1024
    s_waitcnt lgkmcnt(12)
    v_mfma_f32_32x32x16_bf16 v[96:111], v[232:235], v[140:143], v[96:111]
    ds_read_b64_tr_b16 v[204:205], v12 offset:0
    ds_read_b64_tr_b16 v[206:207], v12 offset:1024
    s_waitcnt lgkmcnt(12)
    v_mfma_f32_32x32x16_bf16 v[112:127], v[236:239], v[140:143], v[112:127]
    ds_read_b64_tr_b16 v[208:209], v13 offset:0
    ds_read_b64_tr_b16 v[210:211], v13 offset:384
    s_waitcnt lgkmcnt(12)
    v_mfma_f32_32x32x16_bf16 v[160:175], v[240:243], v[140:143], v[160:175]
    ds_read_b64_tr_b16 v[212:213], v13 offset:32
    ds_read_b64_tr_b16 v[214:215], v13 offset:416
    s_waitcnt lgkmcnt(12)
    v_mfma_f32_32x32x16_bf16 v[176:191], v[244:247], v[140:143], v[176:191]
    ds_read_b64_tr_b16 v[216:217], v13 offset:64
    ds_read_b64_tr_b16 v[218:219], v13 offset:448
    s_waitcnt vmcnt(3) lgkmcnt(12)
    v_mfma_f32_32x32x16_bf16 v[48:63], v[192:195], v[144:147], v[48:63]
    ds_read_b64_tr_b16 v[220:221], v9 offset:4096
    ds_read_b64_tr_b16 v[222:223], v9 offset:5120
    s_waitcnt lgkmcnt(12)
    v_mfma_f32_32x32x16_bf16 v[64:79], v[196:199], v[144:147], v[64:79]
    ds_read_b64_tr_b16 v[224:225], v10 offset:4096
    ds_read_b64_tr_b16 v[226:227], v10 offset:5120
    s_waitcnt lgkmcnt(12)
    v_mfma_f32_32x32x16_bf16 v[80:95], v[200:203], v[144:147], v[80:95]
    ds_read_b64_tr_b16 v[228:229], v11 offset:4096
    ds_read_b64_tr_b16 v[230:231], v11 offset:5120
    s_waitcnt lgkmcnt(12)
    v_mfma_f32_32x32x16_bf16 v[96:111], v[204:207], v[144:147], v[96:111]
    ds_read_b64_tr_b16 v[232:233], v12 offset:4096
    ds_read_b64_tr_b16 v[234:235], v12 offset:5120
    s_waitcnt lgkmcnt(12)
    v_mfma_f32_32x32x16_bf16 v[112:127], v[208:211], v[144:147], v[112:127]
    ds_read_b64_tr_b16 v[236:237], v13 offset:1536
    ds_read_b64_tr_b16 v[238:239], v13 offset:1920
    s_waitcnt lgkmcnt(12)
    v_mfma_f32_32x32x16_bf16 v[160:175], v[212:215], v[144:147], v[160:175]
    ds_read_b64_tr_b16 v[240:241], v13 offset:1568
    ds_read_b64_tr_b16 v[242:243], v13 offset:1952
    s_waitcnt lgkmcnt(12)
    v_mfma_f32_32x32x16_bf16 v[176:191], v[216:219], v[144:147], v[176:191]
    ds_read_b64_tr_b16 v[244:245], v13 offset:1600
    ds_read_b64_tr_b16 v[246:247], v13 offset:1984
    s_waitcnt vmcnt(2) lgkmcnt(12)
    v_mfma_f32_32x32x16_bf16 v[48:63], v[220:223], v[148:151], v[48:63]
    ds_read_b64_tr_b16 v[192:193], v9 offset:8192
    ds_read_b64_tr_b16 v[194:195], v9 offset:9216
    s_waitcnt lgkmcnt(12)
    v_mfma_f32_32x32x16_bf16 v[64:79], v[224:227], v[148:151], v[64:79]
    ds_read_b64_tr_b16 v[196:197], v10 offset:8192
    ds_read_b64_tr_b16 v[198:199], v10 offset:9216
    s_waitcnt lgkmcnt(12)
    v_mfma_f32_32x32x16_bf16 v[80:95], v[228:231], v[148:151], v[80:95]
    ds_read_b64_tr_b16 v[200:201], v11 offset:8192
    ds_read_b64_tr_b16 v[202:203], v11 offset:9216
    s_waitcnt lgkmcnt(12)
    v_mfma_f32_32x32x16_bf16 v[96:111], v[232:235], v[148:151], v[96:111]
    ds_read_b64_tr_b16 v[204:205], v12 offset:8192
    ds_read_b64_tr_b16 v[206:207], v12 offset:9216
    s_waitcnt lgkmcnt(12)
    v_mfma_f32_32x32x16_bf16 v[112:127], v[236:239], v[148:151], v[112:127]
    ds_read_b64_tr_b16 v[208:209], v13 offset:3072
    ds_read_b64_tr_b16 v[210:211], v13 offset:3456
    s_waitcnt lgkmcnt(12)
    v_mfma_f32_32x32x16_bf16 v[160:175], v[240:243], v[148:151], v[160:175]
    ds_read_b64_tr_b16 v[212:213], v13 offset:3104
    ds_read_b64_tr_b16 v[214:215], v13 offset:3488
    s_waitcnt lgkmcnt(12)
    v_mfma_f32_32x32x16_bf16 v[176:191], v[244:247], v[148:151], v[176:191]
    ds_read_b64_tr_b16 v[216:217], v13 offset:3136
    ds_read_b64_tr_b16 v[218:219], v13 offset:3520
    s_waitcnt vmcnt(1) lgkmcnt(12)
    v_mfma_f32_32x32x16_bf16 v[48:63], v[192:195], v[152:155], v[48:63]
    ds_read_b64_tr_b16 v[220:221], v9 offset:12288
    ds_read_b64_tr_b16 v[222:223], v9 offset:13312
    s_waitcnt lgkmcnt(12)
    v_mfma_f32_32x32x16_bf16 v[64:79], v[196:199], v[152:155], v[64:79]
    ds_read_b64_tr_b16 v[224:225], v10 offset:12288
    ds_read_b64_tr_b16 v[226:227], v10 offset:13312
    s_waitcnt lgkmcnt(12)
    v_mfma_f32_32x32x16_bf16 v[80:95], v[200:203], v[152:155], v[80:95]
    ds_read_b64_tr_b16 v[228:229], v11 offset:12288
    ds_read_b64_tr_b16 v[230:231], v11 offset:13312
    s_waitcnt lgkmcnt(12)
    v_mfma_f32_32x32x16_bf16 v[96:111], v[204:207], v[152:155], v[96:111]
    ds_read_b64_tr_b16 v[232:233], v12 offset:12288
    ds_read_b64_tr_b16 v[234:235], v12 offset:13312
    s_waitcnt lgkmcnt(12)
    v_mfma_f32_32x32x16_bf16 v[112:127], v[208:211], v[152:155], v[112:127]
    ds_read_b64_tr_b16 v[236:237], v13 offset:4608
    ds_read_b64_tr_b16 v[238:239], v13 offset:4992
    s_waitcnt lgkmcnt(12)
    v_mfma_f32_32x32x16_bf16 v[160:175], v[212:215], v[152:155], v[160:175]
    ds_read_b64_tr_b16 v[240:241], v13 offset:4640
    ds_read_b64_tr_b16 v[242:243], v13 offset:5024
    s_waitcnt lgkmcnt(12)
    v_mfma_f32_32x32x16_bf16 v[176:191], v[216:219], v[152:155], v[176:191]
    ds_read_b64_tr_b16 v[244:245], v13 offset:4672
    ds_read_b64_tr_b16 v[246:247], v13 offset:5056
    s_waitcnt vmcnt(0) lgkmcnt(12)
    v_mfma_f32_32x32x16_bf16 v[48:63], v[220:223], v[156:159], v[48:63]
    s_waitcnt lgkmcnt(10)
    v_mfma_f32_32x32x16_bf16 v[64:79], v[224:227], v[156:159], v[64:79]
    s_waitcnt lgkmcnt(8)
    v_mfma_f32_32x32x16_bf16 v[80:95], v[228:231], v[156:159], v[80:95]
    s_waitcnt lgkmcnt(6)
    v_mfma_f32_32x32x16_bf16 v[96:111], v[232:235], v[156:159], v[96:111]
    s_waitcnt lgkmcnt(4)
    v_mfma_f32_32x32x16_bf16 v[112:127], v[236:239], v[156:159], v[112:127]
    s_waitcnt lgkmcnt(2)
    v_mfma_f32_32x32x16_bf16 v[160:175], v[240:243], v[156:159], v[160:175]
    s_waitcnt lgkmcnt(0)
    v_mfma_f32_32x32x16_bf16 v[176:191], v[244:247], v[156:159], v[176:191]
    s_waitcnt lgkmcnt(0)
    s_cmp_lg_u32 s20, 0
    s_cbranch_scc1 LF_dr11
LF_dr11:
    s_barrier
    s_add_u32 m0, s46, 0
    s_add_u32 s43, s44, 0
    buffer_load_dwordx4 v1, s[8:11], s43 offen sc1 lds
    buffer_load_dwordx4 v1, s[8:11], s43 offen offset:1024 sc1 lds
    s_add_u32 m0, s46, 32768
    s_add_u32 s43, s44, 16384
    buffer_load_dwordx4 v1, s[8:11], s43 offen sc1 lds
    buffer_load_dwordx4 v1, s[8:11], s43 offen offset:1024 sc1 lds
    s_add_u32 m0, s46, 65536
    s_add_u32 s43, s45, 0
    buffer_load_dwordx4 v1, s[8:11], s43 offen sc1 lds
    buffer_load_dwordx4 v1, s[8:11], s43 offen offset:1024 sc1 lds
    s_load_dwordx2 s[56:57], s[0:1], 40
    s_load_dwordx2 s[58:59], s[0:1], 72
    s_waitcnt lgkmcnt(0)
    s_cmp_ge_u32 s20, 2
    s_cselect_b32 s60, s58, s56
    s_cselect_b32 s61, s59, s57
    s_mov_b32 s62, 0x400000
    s_cselect_b32 s62, 0x158000, s62
    s_movk_i32 s35, 0x4000
    s_cselect_b32 s35, 5504, s35
    s_and_b32 s61, s61, 0xffff
    s_mov_b32 s63, 0x00020000
    s_mul_i32 s35, s35, s2
    s_cmp_eq_u32 s20, 1
    s_cselect_b32 s39, 0x2000, 0
    s_add_u32 s35, s35, s39
    s_cmp_ge_u32 s20, 3
    s_cselect_b32 s35, 0x7f000000, s35
    v_lshlrev_b32 v12, 3, v1
    buffer_load_dword v255, v12, s[60:63], s35 offen
    s_lshr_b32 s17, s23, 2
    s_and_b32 s18, s23, 3
    s_cmp_ge_u32 s17, 6
    s_cselect_b32 s12, s58, s56
    s_cselect_b32 s13, s59, s57
    s_mov_b32 s14, 0x400000
    s_cselect_b32 s14, 0x158000, s14
    s_cselect_b32 s19, 6, 0
    s_and_b32 s13, s13, 0xffff
    s_mov_b32 s15, 0x00020000
    s_sub_u32 s19, s17, s19
    s_mul_i32 s16, s19, 43
    s_cmp_eq_u32 s17, 5
    s_cselect_b32 s19, 1, 0
    s_sub_u32 s16, s16, s19
    s_lshl_b32 s16, s16, 4
    s_mul_i32 s18, s18, 84
    s_add_u32 s16, s16, s18
    s_mul_i32 s18, s20, 0
    s_add_u32 s16, s16, s18
    s_lshl_b32 s16, s16, 10
    v_lshlrev_b32 v249, 3, v1
    s_mov_b32 s48, 0x3e0293ee
    s_mov_b32 s49, 0x3e0293ee
    v_pk_mul_f32 v[48:49], v[48:49], s[48:49]
    v_pk_mul_f32 v[50:51], v[50:51], s[48:49]
    v_pk_mul_f32 v[52:53], v[52:53], s[48:49]
    v_pk_mul_f32 v[54:55], v[54:55], s[48:49]
    v_pk_mul_f32 v[56:57], v[56:57], s[48:49]
    v_pk_mul_f32 v[58:59], v[58:59], s[48:49]
    v_pk_mul_f32 v[60:61], v[60:61], s[48:49]
    v_pk_mul_f32 v[62:63], v[62:63], s[48:49]
    v_cvt_pk_bf16_f32 v16, v48, v49
    v_cvt_pk_bf16_f32 v17, v50, v51
    v_cvt_pk_bf16_f32 v18, v52, v53
    v_cvt_pk_bf16_f32 v19, v54, v55
    v_cvt_pk_bf16_f32 v20, v56, v57
    v_cvt_pk_bf16_f32 v21, v58, v59
    v_cvt_pk_bf16_f32 v22, v60, v61
    v_cvt_pk_bf16_f32 v23, v62, v63
    v_pk_mul_f32 v[64:65], v[64:65], s[48:49]
    v_pk_mul_f32 v[66:67], v[66:67], s[48:49]
    v_pk_mul_f32 v[68:69], v[68:69], s[48:49]
    v_pk_mul_f32 v[70:71], v[70:71], s[48:49]
    v_pk_mul_f32 v[72:73], v[72:73], s[48:49]
    v_pk_mul_f32 v[74:75], v[74:75], s[48:49]
    v_pk_mul_f32 v[76:77], v[76:77], s[48:49]
    v_pk_mul_f32 v[78:79], v[78:79], s[48:49]
    v_cvt_pk_bf16_f32 v24, v64, v65
    v_cvt_pk_bf16_f32 v25, v66, v67
    v_cvt_pk_bf16_f32 v26, v68, v69
    v_cvt_pk_bf16_f32 v27, v70, v71
    v_cvt_pk_bf16_f32 v28, v72, v73
    v_cvt_pk_bf16_f32 v29, v74, v75
    v_cvt_pk_bf16_f32 v30, v76, v77
    v_cvt_pk_bf16_f32 v31, v78, v79
    v_pk_mul_f32 v[80:81], v[80:81], s[48:49]
    v_pk_mul_f32 v[82:83], v[82:83], s[48:49]
    v_pk_mul_f32 v[84:85], v[84:85], s[48:49]
    v_pk_mul_f32 v[86:87], v[86:87], s[48:49]
    v_pk_mul_f32 v[88:89], v[88:89], s[48:49]
    v_pk_mul_f32 v[90:91], v[90:91], s[48:49]
    v_pk_mul_f32 v[92:93], v[92:93], s[48:49]
    v_pk_mul_f32 v[94:95], v[94:95], s[48:49]
    v_cvt_pk_bf16_f32 v32, v80, v81
    v_cvt_pk_bf16_f32 v33, v82, v83
    v_cvt_pk_bf16_f32 v34, v84, v85
    v_cvt_pk_bf16_f32 v35, v86, v87
    v_cvt_pk_bf16_f32 v36, v88, v89
    v_cvt_pk_bf16_f32 v37, v90, v91
    v_cvt_pk_bf16_f32 v38, v92, v93
    v_cvt_pk_bf16_f32 v39, v94, v95
    v_pk_mul_f32 v[96:97], v[96:97], s[48:49]
    v_pk_mul_f32 v[98:99], v[98:99], s[48:49]
    v_pk_mul_f32 v[100:101], v[100:101], s[48:49]
    v_pk_mul_f32 v[102:103], v[102:103], s[48:49]
    v_pk_mul_f32 v[104:105], v[104:105], s[48:49]
    v_pk_mul_f32 v[106:107], v[106:107], s[48:49]
    v_pk_mul_f32 v[108:109], v[108:109], s[48:49]
    v_pk_mul_f32 v[110:111], v[110:111], s[48:49]
    v_cvt_pk_bf16_f32 v40, v96, v97
    v_cvt_pk_bf16_f32 v41, v98, v99
    v_cvt_pk_bf16_f32 v42, v100, v101
    v_cvt_pk_bf16_f32 v43, v102, v103
    v_cvt_pk_bf16_f32 v44, v104, v105
    v_cvt_pk_bf16_f32 v45, v106, v107
    v_cvt_pk_bf16_f32 v46, v108, v109
    v_cvt_pk_bf16_f32 v47, v110, v111
    s_lshl_b32 s49, s26, 13
    s_add_u32 s49, s49, 131072
    v_add_u32 v9, s49, v1
    s_cmp_lg_u32 s25, 0
    s_cbranch_scc1 LF_noqx
    ds_write_b128 v9, v[16:19] offset:0
    ds_write_b128 v9, v[20:23] offset:1024
    ds_write_b128 v9, v[24:27] offset:2048
    ds_write_b128 v9, v[28:31] offset:3072
    ds_write_b128 v9, v[32:35] offset:4096
    ds_write_b128 v9, v[36:39] offset:5120
    ds_write_b128 v9, v[40:43] offset:6144
    ds_write_b128 v9, v[44:47] offset:7168
    s_waitcnt lgkmcnt(0)
LF_noqx:
    s_mov_b32 s50, 0xbdd2d3e8
    s_mov_b32 s51, 0xbdd2d3e8
    v_mov_b32 v208, 0xc0135761
    v_mov_b32 v209, 0xc0135761
    s_mul_i32 s52, s27, 350208
    s_mul_i32 s53, s21, 3
    s_add_u32 s54, s53, 256
    s_lshl_b32 s54, s54, 10
    s_add_u32 s52, s52, s54
    s_add_u32 s52, s52, 0x2200000
    s_add_u32 s54, s53, 0
    s_cmp_ge_u32 s54, 86
    s_cbranch_scc1 LF_ffn_skip0
    v_pk_mul_f32 v[192:193], v[112:113], v[112:113]
    v_pk_mul_f32 v[194:195], v[114:115], v[114:115]
    v_pk_mul_f32 v[196:197], v[116:117], v[116:117]
    v_pk_mul_f32 v[198:199], v[118:119], v[118:119]
    v_pk_fma_f32 v[192:193], v[192:193], s[50:51], v[208:209]
    v_pk_fma_f32 v[194:195], v[194:195], s[50:51], v[208:209]
    v_pk_fma_f32 v[196:197], v[196:197], s[50:51], v[208:209]
    v_pk_fma_f32 v[198:199], v[198:199], s[50:51], v[208:209]
    v_pk_mul_f32 v[192:193], v[192:193], v[112:113]
    v_pk_mul_f32 v[194:195], v[194:195], v[114:115]
    v_pk_mul_f32 v[196:197], v[196:197], v[116:117]
    v_pk_mul_f32 v[198:199], v[198:199], v[118:119]
    v_exp_f32 v192, v192
    v_exp_f32 v193, v193
    v_exp_f32 v194, v194
    v_exp_f32 v195, v195
    v_exp_f32 v196, v196
    v_exp_f32 v197, v197
    v_exp_f32 v198, v198
    v_exp_f32 v199, v199
    v_pk_mul_f32 v[200:201], v[112:113], v[120:121]
    v_pk_mul_f32 v[202:203], v[114:115], v[122:123]
    v_pk_mul_f32 v[204:205], v[116:117], v[124:125]
    v_pk_mul_f32 v[206:207], v[118:119], v[126:127]
    v_pk_add_f32 v[192:193], v[192:193], 1.0 op_sel_hi:[1,0]
    v_pk_add_f32 v[194:195], v[194:195], 1.0 op_sel_hi:[1,0]
    v_pk_add_f32 v[196:197], v[196:197], 1.0 op_sel_hi:[1,0]
    v_pk_add_f32 v[198:199], v[198:199], 1.0 op_sel_hi:[1,0]
    v_rcp_f32 v192, v192
    v_rcp_f32 v193, v193
    v_rcp_f32 v194, v194
    v_rcp_f32 v195, v195
    v_rcp_f32 v196, v196
    v_rcp_f32 v197, v197
    v_rcp_f32 v198, v198
    v_rcp_f32 v199, v199
    v_pk_mul_f32 v[192:193], v[192:193], v[200:201]
    v_pk_mul_f32 v[194:195], v[194:195], v[202:203]
    v_pk_mul_f32 v[196:197], v[196:197], v[204:205]
    v_pk_mul_f32 v[198:199], v[198:199], v[206:207]
    v_cvt_pk_bf16_f32 v212, v192, v193
    v_cvt_pk_bf16_f32 v213, v194, v195
    v_cvt_pk_bf16_f32 v214, v196, v197
    v_cvt_pk_bf16_f32 v215, v198, v199
    buffer_store_dwordx4 v[212:215], v1, s[8:11], s52 offen offset:0 sc1
LF_ffn_skip0:
    s_add_u32 s54, s53, 1
    s_cmp_ge_u32 s54, 86
    s_cbranch_scc1 LF_ffn_skip1
    v_pk_mul_f32 v[192:193], v[160:161], v[160:161]
    v_pk_mul_f32 v[194:195], v[162:163], v[162:163]
    v_pk_mul_f32 v[196:197], v[164:165], v[164:165]
    v_pk_mul_f32 v[198:199], v[166:167], v[166:167]
    v_pk_fma_f32 v[192:193], v[192:193], s[50:51], v[208:209]
    v_pk_fma_f32 v[194:195], v[194:195], s[50:51], v[208:209]
    v_pk_fma_f32 v[196:197], v[196:197], s[50:51], v[208:209]
    v_pk_fma_f32 v[198:199], v[198:199], s[50:51], v[208:209]
    v_pk_mul_f32 v[192:193], v[192:193], v[160:161]
    v_pk_mul_f32 v[194:195], v[194:195], v[162:163]
    v_pk_mul_f32 v[196:197], v[196:197], v[164:165]
    v_pk_mul_f32 v[198:199], v[198:199], v[166:167]
    v_exp_f32 v192, v192
    v_exp_f32 v193, v193
    v_exp_f32 v194, v194
    v_exp_f32 v195, v195
    v_exp_f32 v196, v196
    v_exp_f32 v197, v197
    v_exp_f32 v198, v198
    v_exp_f32 v199, v199
    v_pk_mul_f32 v[200:201], v[160:161], v[168:169]
    v_pk_mul_f32 v[202:203], v[162:163], v[170:171]
    v_pk_mul_f32 v[204:205], v[164:165], v[172:173]
    v_pk_mul_f32 v[206:207], v[166:167], v[174:175]
    v_pk_add_f32 v[192:193], v[192:193], 1.0 op_sel_hi:[1,0]
    v_pk_add_f32 v[194:195], v[194:195], 1.0 op_sel_hi:[1,0]
    v_pk_add_f32 v[196:197], v[196:197], 1.0 op_sel_hi:[1,0]
    v_pk_add_f32 v[198:199], v[198:199], 1.0 op_sel_hi:[1,0]
    v_rcp_f32 v192, v192
    v_rcp_f32 v193, v193
    v_rcp_f32 v194, v194
    v_rcp_f32 v195, v195
    v_rcp_f32 v196, v196
    v_rcp_f32 v197, v197
    v_rcp_f32 v198, v198
    v_rcp_f32 v199, v199
    v_pk_mul_f32 v[192:193], v[192:193], v[200:201]
    v_pk_mul_f32 v[194:195], v[194:195], v[202:203]
    v_pk_mul_f32 v[196:197], v[196:197], v[204:205]
    v_pk_mul_f32 v[198:199], v[198:199], v[206:207]
    v_cvt_pk_bf16_f32 v216, v192, v193
    v_cvt_pk_bf16_f32 v217, v194, v195
    v_cvt_pk_bf16_f32 v218, v196, v197
    v_cvt_pk_bf16_f32 v219, v198, v199
    buffer_store_dwordx4 v[216:219], v1, s[8:11], s52 offen offset:1024 sc1
LF_ffn_skip1:
    s_add_u32 s54, s53, 2
    s_cmp_ge_u32 s54, 86
    s_cbranch_scc1 LF_ffn_skip2
    v_pk_mul_f32 v[192:193], v[176:177], v[176:177]
    v_pk_mul_f32 v[194:195], v[178:179], v[178:179]
    v_pk_mul_f32 v[196:197], v[180:181], v[180:181]
    v_pk_mul_f32 v[198:199], v[182:183], v[182:183]
    v_pk_fma_f32 v[192:193], v[192:193], s[50:51], v[208:209]
    v_pk_fma_f32 v[194:195], v[194:195], s[50:51], v[208:209]
    v_pk_fma_f32 v[196:197], v[196:197], s[50:51], v[208:209]
    v_pk_fma_f32 v[198:199], v[198:199], s[50:51], v[208:209]
    v_pk_mul_f32 v[192:193], v[192:193], v[176:177]
    v_pk_mul_f32 v[194:195], v[194:195], v[178:179]
    v_pk_mul_f32 v[196:197], v[196:197], v[180:181]
    v_pk_mul_f32 v[198:199], v[198:199], v[182:183]
    v_exp_f32 v192, v192
    v_exp_f32 v193, v193
    v_exp_f32 v194, v194
    v_exp_f32 v195, v195
    v_exp_f32 v196, v196
    v_exp_f32 v197, v197
    v_exp_f32 v198, v198
    v_exp_f32 v199, v199
    v_pk_mul_f32 v[200:201], v[176:177], v[184:185]
    v_pk_mul_f32 v[202:203], v[178:179], v[186:187]
    v_pk_mul_f32 v[204:205], v[180:181], v[188:189]
    v_pk_mul_f32 v[206:207], v[182:183], v[190:191]
    v_pk_add_f32 v[192:193], v[192:193], 1.0 op_sel_hi:[1,0]
    v_pk_add_f32 v[194:195], v[194:195], 1.0 op_sel_hi:[1,0]
    v_pk_add_f32 v[196:197], v[196:197], 1.0 op_sel_hi:[1,0]
    v_pk_add_f32 v[198:199], v[198:199], 1.0 op_sel_hi:[1,0]
    v_rcp_f32 v192, v192
    v_rcp_f32 v193, v193
    v_rcp_f32 v194, v194
    v_rcp_f32 v195, v195
    v_rcp_f32 v196, v196
    v_rcp_f32 v197, v197
    v_rcp_f32 v198, v198
    v_rcp_f32 v199, v199
    v_pk_mul_f32 v[192:193], v[192:193], v[200:201]
    v_pk_mul_f32 v[194:195], v[194:195], v[202:203]
    v_pk_mul_f32 v[196:197], v[196:197], v[204:205]
    v_pk_mul_f32 v[198:199], v[198:199], v[206:207]
    v_cvt_pk_bf16_f32 v220, v192, v193
    v_cvt_pk_bf16_f32 v221, v194, v195
    v_cvt_pk_bf16_f32 v222, v196, v197
    v_cvt_pk_bf16_f32 v223, v198, v199
    buffer_store_dwordx4 v[220:223], v1, s[8:11], s52 offen offset:2048 sc1
LF_ffn_skip2:
    v_pk_mov_b32 v[48:49], 0, 0
    v_pk_mov_b32 v[50:51], 0, 0
    v_pk_mov_b32 v[52:53], 0, 0
    v_pk_mov_b32 v[54:55], 0, 0
    v_pk_mov_b32 v[56:57], 0, 0
    v_pk_mov_b32 v[58:59], 0, 0
    v_pk_mov_b32 v[60:61], 0, 0
    v_pk_mov_b32 v[62:63], 0, 0
    v_pk_mov_b32 v[64:65], 0, 0
    v_pk_mov_b32 v[66:67], 0, 0
    v_pk_mov_b32 v[68:69], 0, 0
    v_pk_mov_b32 v[70:71], 0, 0
    v_pk_mov_b32 v[72:73], 0, 0
    v_pk_mov_b32 v[74:75], 0, 0
    v_pk_mov_b32 v[76:77], 0, 0
    v_pk_mov_b32 v[78:79], 0, 0
    v_pk_mov_b32 v[80:81], 0, 0
    v_pk_mov_b32 v[82:83], 0, 0
    v_pk_mov_b32 v[84:85], 0, 0
    v_pk_mov_b32 v[86:87], 0, 0
    v_pk_mov_b32 v[88:89], 0, 0
    v_pk_mov_b32 v[90:91], 0, 0
    v_pk_mov_b32 v[92:93], 0, 0
    v_pk_mov_b32 v[94:95], 0, 0
    v_pk_mov_b32 v[96:97], 0, 0
    v_pk_mov_b32 v[98:99], 0, 0
    v_pk_mov_b32 v[100:101], 0, 0
    v_pk_mov_b32 v[102:103], 0, 0
    v_pk_mov_b32 v[104:105], 0, 0
    v_pk_mov_b32 v[106:107], 0, 0
    v_pk_mov_b32 v[108:109], 0, 0
    v_pk_mov_b32 v[110:111], 0, 0
    v_pk_mov_b32 v[160:161], 0, 0
    v_pk_mov_b32 v[162:163], 0, 0
    v_pk_mov_b32 v[164:165], 0, 0
    v_pk_mov_b32 v[166:167], 0, 0
    v_pk_mov_b32 v[168:169], 0, 0
    v_pk_mov_b32 v[170:171], 0, 0
    v_pk_mov_b32 v[172:173], 0, 0
    v_pk_mov_b32 v[174:175], 0, 0
    v_mov_b32 v5, 0
    v_mov_b32 v6, 0
    v_mov_b32 v8, 0
    s_mov_b32 s56, 0x49800000
    s_mov_b32 s57, 0xbf800000
    s_mov_b32 s58, 0xe0ad78ec
    s_mov_b32 s59, 1
    s_mov_b32 s60, 1.0
    s_mov_b32 s61, s27
    s_mov_b32 s62, 0
    s_lshl_b32 s67, s25, 14
    v_add_u32 v2, 0, v1
    v_add_u32 v3, 65536, v1
    v_and_b32 v10, 63, v0
    v_and_b32 v12, 31, v10
    v_lshrrev_b32 v11, 5, v10
    v_lshlrev_b32 v13, 2, v11
    v_sub_u32 v4, v12, v13
    s_mov_b32 s55, 0
    s_mov_b32 s63, 16384
    s_add_u32 s64, s46, 32768
    s_lshl_b32 s49, s47, 1
    s_add_u32 s49, s49, 2
    s_cmp_eq_u32 s25, 0
    s_cselect_b32 s49, 0, s49
    s_cselect_b32 s66, 32, s27
    s_lshl_b32 s68, s47, 1
    s_add_u32 s68, s68, 4
    s_min_u32 s68, s68, 32
    s_cmp_eq_u32 s20, 0
    s_cselect_b32 s66, s68, s66
    s_waitcnt vmcnt(0) lgkmcnt(0)
    s_barrier
    s_cmp_eq_u32 s25, 0
    s_cbranch_scc1 LF_noprio
    s_setprio 1
LF_noprio:
    ds_read_b128 v[176:179], v2 offset:0
    ds_read_b128 v[180:183], v2 offset:1024
    ds_read_b128 v[184:187], v2 offset:2048
    ds_read_b128 v[188:191], v2 offset:3072
    s_cmp_ge_u32 s62, s66
    s_cbranch_scc1 LF_evtfirst0
LF_eretfirst0:
    s_waitcnt lgkmcnt(3)
    v_mfma_f32_32x32x16_bf16 v[112:127], v[176:179], v[16:19], v[160:175]
    ds_read_b128 v[192:195], v2 offset:4096
    s_add_u32 s62, s62, 1
    s_waitcnt lgkmcnt(3)
    v_mfma_f32_32x32x16_bf16 v[112:127], v[180:183], v[20:23], v[112:127]
    ds_read_b128 v[196:199], v2 offset:5120
    s_waitcnt lgkmcnt(3)
    v_mfma_f32_32x32x16_bf16 v[112:127], v[184:187], v[24:27], v[112:127]
    ds_read_b128 v[200:203], v2 offset:6144
    s_waitcnt lgkmcnt(3)
    v_mfma_f32_32x32x16_bf16 v[112:127], v[188:191], v[28:31], v[112:127]
    ds_read_b128 v[204:207], v2 offset:7168
    s_waitcnt lgkmcnt(3)
    v_mfma_f32_32x32x16_bf16 v[112:127], v[192:195], v[32:35], v[112:127]
    ds_read_b128 v[176:179], v2 offset:8192
    s_add_u32 s55, s55, 1
    s_and_b32 s50, s55, 1
    s_waitcnt lgkmcnt(3)
    v_mfma_f32_32x32x16_bf16 v[112:127], v[196:199], v[36:39], v[112:127]
    ds_read_b128 v[180:183], v2 offset:9216
    s_lshl_b32 s50, s50, 15
    s_cmp_ge_u32 s55, s47
    s_waitcnt lgkmcnt(3)
    v_mfma_f32_32x32x16_bf16 v[112:127], v[200:203], v[40:43], v[112:127]
    ds_read_b128 v[184:187], v2 offset:10240
    s_cselect_b32 s69, s67, 0
    s_add_u32 s50, s50, s69
    s_add_u32 s50, s50, 0
    s_waitcnt lgkmcnt(3)
    v_mfma_f32_32x32x16_bf16 v[112:127], v[204:207], v[44:47], v[112:127]
    ds_read_b128 v[188:191], v2 offset:11264
    s_cmp_ge_u32 s62, s66
    s_cbranch_scc1 LF_evtfirst1
LF_eretfirst1:
    s_waitcnt lgkmcnt(3)
    v_mfma_f32_32x32x16_bf16 v[128:143], v[176:179], v[16:19], v[160:175]
    ds_read_b128 v[192:195], v2 offset:12288
    s_nop 5
    v_exp_f32 v208, v112
    v_exp_f32 v209, v113
    v_exp_f32 v210, v114
    s_add_u32 s62, s62, 1
    s_waitcnt lgkmcnt(3)
    v_mfma_f32_32x32x16_bf16 v[128:143], v[180:183], v[20:23], v[128:143]
    ds_read_b128 v[196:199], v2 offset:13312
    v_add_f32 v7, v208, v209
    v_cvt_pk_bf16_f32 v144, v208, v209
    v_add_f32 v7, v7, v210
    v_exp_f32 v211, v115
    v_exp_f32 v212, v116
    v_exp_f32 v213, v117
    s_waitcnt lgkmcnt(3)
    v_mfma_f32_32x32x16_bf16 v[128:143], v[184:187], v[24:27], v[128:143]
    ds_read_b128 v[200:203], v2 offset:14336
    ds_read_b128 v[204:207], v2 offset:15360
    v_add_f32 v7, v7, v211
    v_cvt_pk_bf16_f32 v145, v210, v211
    v_add_f32 v7, v7, v212
    v_add_f32 v7, v7, v213
    v_cvt_pk_bf16_f32 v146, v212, v213
    v_exp_f32 v214, v118
    v_exp_f32 v215, v119
    s_waitcnt lgkmcnt(4)
    v_mfma_f32_32x32x16_bf16 v[128:143], v[188:191], v[28:31], v[128:143]
    v_add_f32 v7, v7, v214
    v_add_f32 v7, v7, v215
    v_cvt_pk_bf16_f32 v147, v214, v215
    v_exp_f32 v208, v120
    v_exp_f32 v209, v121
    v_exp_f32 v210, v122
    s_waitcnt lgkmcnt(3)
    v_mfma_f32_32x32x16_bf16 v[128:143], v[192:195], v[32:35], v[128:143]
    v_add_f32 v7, v7, v208
    v_add_f32 v7, v7, v209
    v_cvt_pk_bf16_f32 v148, v208, v209
    v_add_f32 v7, v7, v210
    v_exp_f32 v211, v123
    v_exp_f32 v212, v124
    v_exp_f32 v213, v125
    s_waitcnt vmcnt(0) lgkmcnt(0)
    s_barrier
    v_add_u32 v3, 0x10000, v2
    v_add_u32 v2, s50, v1
    ds_read_b128 v[176:179], v2 offset:0
    v_mfma_f32_32x32x16_bf16 v[128:143], v[196:199], v[36:39], v[128:143]
    v_add_f32 v7, v7, v211
    v_cvt_pk_bf16_f32 v149, v210, v211
    v_add_f32 v7, v7, v212
    v_add_f32 v7, v7, v213
    v_cvt_pk_bf16_f32 v150, v212, v213
    v_exp_f32 v214, v126
    v_exp_f32 v215, v127
    ds_read_b128 v[180:183], v2 offset:1024
    v_mfma_f32_32x32x16_bf16 v[128:143], v[200:203], v[40:43], v[128:143]
    v_add_f32 v7, v7, v214
    v_add_f32 v7, v7, v215
    v_cvt_pk_bf16_f32 v151, v214, v215
    v_cmp_nge_f32 vcc, s57, v7
    ds_read_b128 v[184:187], v2 offset:2048
    v_mfma_f32_32x32x16_bf16 v[128:143], v[204:207], v[44:47], v[128:143]
    s_cbranch_vccnz LF_rarefirst1
LF_retfirst1:
    v_add_f32 v5, v5, v7
    ds_read_b128 v[188:191], v2 offset:3072
LF_loop:
    s_cmp_ge_u32 s62, s66
    s_cbranch_scc1 LF_evtloop0
LF_eretloop0:
    s_waitcnt lgkmcnt(3)
    v_mfma_f32_32x32x16_bf16 v[112:127], v[176:179], v[16:19], v[160:175]
    ds_read_b128 v[192:195], v2 offset:4096
    s_nop 3
    v_exp_f32 v208, v128
    v_exp_f32 v209, v129
    s_add_u32 s62, s62, 1
    s_waitcnt lgkmcnt(3)
    v_mfma_f32_32x32x16_bf16 v[112:127], v[180:183], v[20:23], v[112:127]
    ds_read_b128 v[196:199], v2 offset:5120
    v_add_f32 v7, v208, v209
    v_cvt_pk_bf16_f32 v152, v208, v209
    v_exp_f32 v210, v130
    s_add_u32 m0, s64, 65536
    s_add_u32 s43, s45, s63
    buffer_load_dwordx4 v1, s[8:11], s43 offen sc1 lds
    s_waitcnt lgkmcnt(3)
    v_mfma_f32_32x32x16_bf16 v[112:127], v[184:187], v[24:27], v[112:127]
    ds_read_b128 v[200:203], v2 offset:6144
    v_add_f32 v7, v7, v210
    v_exp_f32 v211, v131
    s_waitcnt lgkmcnt(3)
    v_mfma_f32_32x32x16_bf16 v[112:127], v[188:191], v[28:31], v[112:127]
    ds_read_b128 v[204:207], v2 offset:7168
    v_add_f32 v7, v7, v211
    v_cvt_pk_bf16_f32 v153, v210, v211
    v_exp_f32 v212, v132
    buffer_load_dwordx4 v1, s[8:11], s43 offen offset:1024 sc1 lds
    s_cmp_lt_u32 s55, s47
    s_waitcnt lgkmcnt(3)
    v_mfma_f32_32x32x16_bf16 v[112:127], v[192:195], v[32:35], v[112:127]
    ds_read_b128 v[176:179], v3 offset:0
    v_add_f32 v7, v7, v212
    v_exp_f32 v213, v133
    s_waitcnt lgkmcnt(3)
    v_mfma_f32_32x32x16_bf16 v[112:127], v[196:199], v[36:39], v[112:127]
    ds_read_b128 v[180:183], v3 offset:1024
    v_add_f32 v7, v7, v213
    v_cvt_pk_bf16_f32 v154, v212, v213
    v_exp_f32 v214, v134
    s_cbranch_scc1 LF_nov2loop
    s_add_u32 m0, s64, 81920
    s_add_u32 s43, s43, 16384
    buffer_load_dwordx4 v1, s[8:11], s43 offen sc1 lds
    buffer_load_dwordx4 v1, s[8:11], s43 offen offset:1024 sc1 lds
    s_add_u32 s63, s63, 16384
LF_nov2loop:
    s_waitcnt lgkmcnt(3)
    v_mfma_f32_32x32x16_bf16 v[112:127], v[200:203], v[40:43], v[112:127]
    ds_read_b128 v[184:187], v3 offset:2048
    v_add_f32 v7, v7, v214
    v_exp_f32 v215, v135
    s_waitcnt lgkmcnt(3)
    v_mfma_f32_32x32x16_bf16 v[112:127], v[204:207], v[44:47], v[112:127]
    ds_read_b128 v[188:191], v3 offset:3072
    v_add_f32 v7, v7, v215
    v_cvt_pk_bf16_f32 v155, v214, v215
    v_exp_f32 v208, v136
    v_exp_f32 v209, v137
    s_add_u32 s63, s63, 16384
    s_xor_b32 s64, s64, 32768
    s_waitcnt lgkmcnt(3)
    v_mfma_f32_32x32x16_bf16 v[48:63], v[176:179], v[144:147], v[48:63]
    ds_read_b128 v[192:195], v3 offset:4096
    v_add_f32 v7, v7, v208
    v_add_f32 v7, v7, v209
    v_cvt_pk_bf16_f32 v156, v208, v209
    v_exp_f32 v210, v138
    s_waitcnt lgkmcnt(3)
    v_mfma_f32_32x32x16_bf16 v[48:63], v[180:183], v[148:151], v[48:63]
    ds_read_b128 v[196:199], v3 offset:5120
    v_add_f32 v7, v7, v210
    v_exp_f32 v211, v139
    s_add_u32 m0, s64, 0
    s_add_u32 s43, s44, s63
    buffer_load_dwordx4 v1, s[8:11], s43 offen sc1 lds
    s_waitcnt lgkmcnt(3)
    v_mfma_f32_32x32x16_bf16 v[64:79], v[184:187], v[144:147], v[64:79]
    ds_read_b128 v[200:203], v3 offset:6144
    v_add_f32 v7, v7, v211
    v_cvt_pk_bf16_f32 v157, v210, v211
    v_exp_f32 v212, v140
    s_waitcnt lgkmcnt(3)
    v_mfma_f32_32x32x16_bf16 v[64:79], v[188:191], v[148:151], v[64:79]
    ds_read_b128 v[204:207], v3 offset:7168
    v_add_f32 v7, v7, v212
    v_exp_f32 v213, v141
    buffer_load_dwordx4 v1, s[8:11], s43 offen offset:1024 sc1 lds
    s_add_u32 s65, s55, 1
    s_cmp_lt_u32 s65, s47
    s_waitcnt lgkmcnt(3)
    v_mfma_f32_32x32x16_bf16 v[80:95], v[192:195], v[144:147], v[80:95]
    ds_read_b128 v[176:179], v2 offset:8192
    v_add_f32 v7, v7, v213
    v_cvt_pk_bf16_f32 v158, v212, v213
    v_exp_f32 v214, v142
    s_waitcnt lgkmcnt(3)
    v_mfma_f32_32x32x16_bf16 v[80:95], v[196:199], v[148:151], v[80:95]
    ds_read_b128 v[180:183], v2 offset:9216
    v_add_f32 v7, v7, v214
    v_exp_f32 v215, v143
    s_cbranch_scc1 LF_nokloop
    s_add_u32 m0, s64, 16384
    s_add_u32 s43, s43, 16384
    buffer_load_dwordx4 v1, s[8:11], s43 offen sc1 lds
    buffer_load_dwordx4 v1, s[8:11], s43 offen offset:1024 sc1 lds
LF_nokloop:
    s_waitcnt lgkmcnt(3)
    v_mfma_f32_32x32x16_bf16 v[96:111], v[200:203], v[144:147], v[96:111]
    ds_read_b128 v[184:187], v2 offset:10240
    v_add_f32 v7, v7, v215
    v_cvt_pk_bf16_f32 v159, v214, v215
    v_cmp_nge_f32 vcc, s56, v7
    s_waitcnt lgkmcnt(3)
    v_mfma_f32_32x32x16_bf16 v[96:111], v[204:207], v[148:151], v[96:111]
    ds_read_b128 v[188:191], v2 offset:11264
    s_cbranch_vccnz LF_rareloop0
LF_retloop0:
    v_add_f32 v5, v5, v7
    s_cmp_ge_u32 s62, s66
    s_cbranch_scc1 LF_evtloop1
LF_eretloop1:
    s_waitcnt lgkmcnt(3)
    v_mfma_f32_32x32x16_bf16 v[128:143], v[176:179], v[16:19], v[160:175]
    ds_read_b128 v[192:195], v2 offset:12288
    v_exp_f32 v208, v112
    v_exp_f32 v209, v113
    s_add_u32 s62, s62, 1
    s_waitcnt lgkmcnt(3)
    v_mfma_f32_32x32x16_bf16 v[128:143], v[180:183], v[20:23], v[128:143]
    ds_read_b128 v[196:199], v2 offset:13312
    v_add_f32 v7, v208, v209
    v_cvt_pk_bf16_f32 v144, v208, v209
    v_exp_f32 v210, v114
    s_waitcnt lgkmcnt(3)
    v_mfma_f32_32x32x16_bf16 v[128:143], v[184:187], v[24:27], v[128:143]
    ds_read_b128 v[200:203], v2 offset:14336
    v_add_f32 v7, v7, v210
    v_exp_f32 v211, v115
    s_waitcnt lgkmcnt(3)
    v_mfma_f32_32x32x16_bf16 v[128:143], v[188:191], v[28:31], v[128:143]
    ds_read_b128 v[204:207], v2 offset:15360
    v_add_f32 v7, v7, v211
    v_cvt_pk_bf16_f32 v145, v210, v211
    v_exp_f32 v212, v116
    s_waitcnt lgkmcnt(3)
    v_mfma_f32_32x32x16_bf16 v[128:143], v[192:195], v[32:35], v[128:143]
    ds_read_b128 v[176:179], v3 offset:8192
    v_add_f32 v7, v7, v212
    v_exp_f32 v213, v117
    s_waitcnt lgkmcnt(3)
    v_mfma_f32_32x32x16_bf16 v[128:143], v[196:199], v[36:39], v[128:143]
    ds_read_b128 v[180:183], v3 offset:9216
    v_add_f32 v7, v7, v213
    v_cvt_pk_bf16_f32 v146, v212, v213
    v_exp_f32 v214, v118
    s_waitcnt lgkmcnt(3)
    v_mfma_f32_32x32x16_bf16 v[128:143], v[200:203], v[40:43], v[128:143]
    ds_read_b128 v[184:187], v3 offset:10240
    v_add_f32 v7, v7, v214
    v_exp_f32 v215, v119
    s_waitcnt lgkmcnt(3)
    v_mfma_f32_32x32x16_bf16 v[128:143], v[204:207], v[44:47], v[128:143]
    ds_read_b128 v[188:191], v3 offset:11264
    v_add_f32 v7, v7, v215
    v_cvt_pk_bf16_f32 v147, v214, v215
    v_exp_f32 v208, v120
    v_exp_f32 v209, v121
    s_add_u32 s55, s55, 1
    s_and_b32 s50, s55, 1
    s_waitcnt lgkmcnt(3)
    v_mfma_f32_32x32x16_bf16 v[48:63], v[176:179], v[152:155], v[48:63]
    ds_read_b128 v[192:195], v3 offset:12288
    v_add_f32 v7, v7, v208
    v_add_f32 v7, v7, v209
    v_cvt_pk_bf16_f32 v148, v208, v209
    v_exp_f32 v210, v122
    s_lshl_b32 s50, s50, 15
    s_cmp_ge_u32 s55, s47
    s_waitcnt lgkmcnt(3)
    v_mfma_f32_32x32x16_bf16 v[48:63], v[180:183], v[156:159], v[48:63]
    ds_read_b128 v[196:199], v3 offset:13312
    v_add_f32 v7, v7, v210
    v_exp_f32 v211, v123
    s_cselect_b32 s69, s67, 0
    s_add_u32 s50, s50, s69
    s_add_u32 s50, s50, 0
    s_waitcnt lgkmcnt(3)
    v_mfma_f32_32x32x16_bf16 v[64:79], v[184:187], v[152:155], v[64:79]
    ds_read_b128 v[200:203], v3 offset:14336
    ds_read_b128 v[204:207], v3 offset:15360
    v_add_f32 v7, v7, v211
    v_cvt_pk_bf16_f32 v149, v210, v211
    v_exp_f32 v212, v124
    s_waitcnt lgkmcnt(4)
    v_mfma_f32_32x32x16_bf16 v[64:79], v[188:191], v[156:159], v[64:79]
    v_add_f32 v7, v7, v212
    v_exp_f32 v213, v125
    s_waitcnt lgkmcnt(3)
    v_mfma_f32_32x32x16_bf16 v[80:95], v[192:195], v[152:155], v[80:95]
    v_add_f32 v7, v7, v213
    v_cvt_pk_bf16_f32 v150, v212, v213
    v_exp_f32 v214, v126
    s_waitcnt vmcnt(0) lgkmcnt(0)
    s_barrier
    v_add_u32 v3, 0x10000, v2
    v_add_u32 v2, s50, v1
    ds_read_b128 v[176:179], v2 offset:0
    v_mfma_f32_32x32x16_bf16 v[80:95], v[196:199], v[156:159], v[80:95]
    v_add_f32 v7, v7, v214
    v_exp_f32 v215, v127
    ds_read_b128 v[180:183], v2 offset:1024
    v_mfma_f32_32x32x16_bf16 v[96:111], v[200:203], v[152:155], v[96:111]
    v_add_f32 v7, v7, v215
    v_cvt_pk_bf16_f32 v151, v214, v215
    v_cmp_nge_f32 vcc, s57, v7
    ds_read_b128 v[184:187], v2 offset:2048
    ds_read_b128 v[188:191], v2 offset:3072
    s_cmp_lt_u32 s55, 17
    v_mfma_f32_32x32x16_bf16 v[96:111], v[204:207], v[156:159], v[96:111]
    s_cbranch_vccnz LF_rareloop1
LF_retloop1:
    v_add_f32 v5, v5, v7
    s_cbranch_scc1 LF_loop
    s_waitcnt lgkmcnt(0)
    ds_read_b128 v[176:179], v3 offset:0
    ds_read_b128 v[180:183], v3 offset:1024
    ds_read_b128 v[184:187], v3 offset:2048
    ds_read_b128 v[188:191], v3 offset:3072
    s_cmp_ge_u32 s62, s66
    s_cbranch_scc1 LF_evtdrain0
LF_eretdrain0:
    s_waitcnt lgkmcnt(3)
    v_mfma_f32_32x32x16_bf16 v[48:63], v[176:179], v[144:147], v[48:63]
    ds_read_b128 v[192:195], v3 offset:4096
    v_exp_f32 v208, v128
    v_exp_f32 v209, v129
    v_exp_f32 v210, v130
    s_add_u32 s62, s62, 1
    s_waitcnt lgkmcnt(3)
    v_mfma_f32_32x32x16_bf16 v[48:63], v[180:183], v[148:151], v[48:63]
    ds_read_b128 v[196:199], v3 offset:5120
    v_add_f32 v7, v208, v209
    v_cvt_pk_bf16_f32 v152, v208, v209
    v_add_f32 v7, v7, v210
    v_exp_f32 v211, v131
    v_exp_f32 v212, v132
    v_exp_f32 v213, v133
    s_waitcnt lgkmcnt(3)
    v_mfma_f32_32x32x16_bf16 v[64:79], v[184:187], v[144:147], v[64:79]
    ds_read_b128 v[200:203], v3 offset:6144
    v_add_f32 v7, v7, v211
    v_cvt_pk_bf16_f32 v153, v210, v211
    v_add_f32 v7, v7, v212
    v_add_f32 v7, v7, v213
    v_cvt_pk_bf16_f32 v154, v212, v213
    v_exp_f32 v214, v134
    v_exp_f32 v215, v135
    s_waitcnt lgkmcnt(3)
    v_mfma_f32_32x32x16_bf16 v[64:79], v[188:191], v[148:151], v[64:79]
    ds_read_b128 v[204:207], v3 offset:7168
    v_add_f32 v7, v7, v214
    v_add_f32 v7, v7, v215
    v_cvt_pk_bf16_f32 v155, v214, v215
    v_exp_f32 v208, v136
    v_exp_f32 v209, v137
    v_exp_f32 v210, v138
    s_waitcnt lgkmcnt(3)
    v_mfma_f32_32x32x16_bf16 v[80:95], v[192:195], v[144:147], v[80:95]
    ds_read_b128 v[176:179], v3 offset:8192
    v_add_f32 v7, v7, v208
    v_add_f32 v7, v7, v209
    v_cvt_pk_bf16_f32 v156, v208, v209
    v_add_f32 v7, v7, v210
    v_exp_f32 v211, v139
    v_exp_f32 v212, v140
    v_exp_f32 v213, v141
    s_waitcnt lgkmcnt(3)
    v_mfma_f32_32x32x16_bf16 v[80:95], v[196:199], v[148:151], v[80:95]
    ds_read_b128 v[180:183], v3 offset:9216
    v_add_f32 v7, v7, v211
    v_cvt_pk_bf16_f32 v157, v210, v211
    v_add_f32 v7, v7, v212
    v_add_f32 v7, v7, v213
    v_cvt_pk_bf16_f32 v158, v212, v213
    v_exp_f32 v214, v142
    v_exp_f32 v215, v143
    s_waitcnt lgkmcnt(3)
    v_mfma_f32_32x32x16_bf16 v[96:111], v[200:203], v[144:147], v[96:111]
    ds_read_b128 v[184:187], v3 offset:10240
    v_add_f32 v7, v7, v214
    v_add_f32 v7, v7, v215
    v_cvt_pk_bf16_f32 v159, v214, v215
    v_cmp_nge_f32 vcc, s56, v7
    s_waitcnt lgkmcnt(3)
    v_mfma_f32_32x32x16_bf16 v[96:111], v[204:207], v[148:151], v[96:111]
    ds_read_b128 v[188:191], v3 offset:11264
    s_cbranch_vccnz LF_raredrain0
LF_retdrain0:
    v_add_f32 v5, v5, v7
    s_waitcnt lgkmcnt(3)
    v_mfma_f32_32x32x16_bf16 v[48:63], v[176:179], v[152:155], v[48:63]
    ds_read_b128 v[192:195], v3 offset:12288
    s_waitcnt lgkmcnt(3)
    v_mfma_f32_32x32x16_bf16 v[48:63], v[180:183], v[156:159], v[48:63]
    ds_read_b128 v[196:199], v3 offset:13312
    s_waitcnt lgkmcnt(3)
    v_mfma_f32_32x32x16_bf16 v[64:79], v[184:187], v[152:155], v[64:79]
    ds_read_b128 v[200:203], v3 offset:14336
    s_waitcnt lgkmcnt(3)
    v_mfma_f32_32x32x16_bf16 v[64:79], v[188:191], v[156:159], v[64:79]
    ds_read_b128 v[204:207], v3 offset:15360
    s_waitcnt lgkmcnt(3)
    v_mfma_f32_32x32x16_bf16 v[80:95], v[192:195], v[152:155], v[80:95]
    s_waitcnt lgkmcnt(2)
    v_mfma_f32_32x32x16_bf16 v[80:95], v[196:199], v[156:159], v[80:95]
    s_waitcnt lgkmcnt(1)
    v_mfma_f32_32x32x16_bf16 v[96:111], v[200:203], v[152:155], v[96:111]
    s_waitcnt lgkmcnt(0)
    v_mfma_f32_32x32x16_bf16 v[96:111], v[204:207], v[156:159], v[96:111]
    s_cmp_ge_u32 s24, 4
    s_cselect_b32 s17, 8, 0
    s_add_u32 s17, s17, s22
    s_add_u32 s17, s17, 32
    s_lshl_b32 s17, s17, 2
    v_mov_b32 v9, v5
    s_nop 1
    v_permlane32_swap_b32 v5, v9
    v_add_f32 v5, v5, v9
    s_waitcnt lgkmcnt(0)
    s_barrier
    s_mul_i32 s49, s20, 8704
    s_xor_b32 s50, s20, 4
    s_mul_i32 s50, s50, 8704
    v_add_u32 v9, s49, v1
    v_add_u32 v10, s50, v1
    v_lshrrev_b32 v11, 1, v1
    v_add_u32 v12, s49, v11
    v_add_u32 v13, s50, v11
    v_mov_b32 v14, v5
    v_mov_b32 v15, v6
    s_cmp_eq_u32 s25, 0
    s_cbranch_scc1 LF_mg0
    ds_write_b128 v9, v[48:51] offset:0
    ds_write_b128 v9, v[52:55] offset:1024
    ds_write_b128 v9, v[56:59] offset:2048
    ds_write_b128 v9, v[60:63] offset:3072
    ds_write_b128 v9, v[64:67] offset:4096
    ds_write_b128 v9, v[68:71] offset:5120
    ds_write_b128 v9, v[72:75] offset:6144
    ds_write_b128 v9, v[76:79] offset:7168
    ds_write_b64 v12, v[14:15] offset:8192
    s_waitcnt lgkmcnt(0)
    s_barrier
    ds_read_b64 v[208:209], v13 offset:8192
    ds_read_b128 v[216:219], v10 offset:0
    ds_read_b128 v[220:223], v10 offset:1024
    ds_read_b128 v[224:227], v10 offset:2048
    ds_read_b128 v[228:231], v10 offset:3072
    ds_read_b128 v[232:235], v10 offset:4096
    ds_read_b128 v[236:239], v10 offset:5120
    ds_read_b128 v[240:243], v10 offset:6144
    ds_read_b128 v[244:247], v10 offset:7168
    s_waitcnt lgkmcnt(8)
    v_max_f32 v210, v6, v209
    v_sub_f32 v212, v6, v210
    v_sub_f32 v214, v209, v210
    v_exp_f32 v212, v212
    v_exp_f32 v214, v214
    v_mul_f32 v211, v212, v5
    v_fmac_f32 v211, v214, v208
    v_rcp_f32 v211, v211
    s_nop 0
    v_mul_f32 v212, v212, v211
    v_mul_f32 v214, v214, v211
    v_pk_mul_f32 v[80:81], v[80:81], v[212:213] op_sel_hi:[1,0]
    s_waitcnt lgkmcnt(7)
    v_pk_fma_f32 v[80:81], v[216:217], v[214:215], v[80:81] op_sel_hi:[1,0,1]
    v_pk_mul_f32 v[82:83], v[82:83], v[212:213] op_sel_hi:[1,0]
    v_pk_fma_f32 v[82:83], v[218:219], v[214:215], v[82:83] op_sel_hi:[1,0,1]
    v_pk_mul_f32 v[84:85], v[84:85], v[212:213] op_sel_hi:[1,0]
    s_waitcnt lgkmcnt(6)
    v_pk_fma_f32 v[84:85], v[220:221], v[214:215], v[84:85] op_sel_hi:[1,0,1]
    v_pk_mul_f32 v[86:87], v[86:87], v[212:213] op_sel_hi:[1,0]
    v_pk_fma_f32 v[86:87], v[222:223], v[214:215], v[86:87] op_sel_hi:[1,0,1]
    v_pk_mul_f32 v[88:89], v[88:89], v[212:213] op_sel_hi:[1,0]
    s_waitcnt lgkmcnt(5)
    v_pk_fma_f32 v[88:89], v[224:225], v[214:215], v[88:89] op_sel_hi:[1,0,1]
    v_pk_mul_f32 v[90:91], v[90:91], v[212:213] op_sel_hi:[1,0]
    v_pk_fma_f32 v[90:91], v[226:227], v[214:215], v[90:91] op_sel_hi:[1,0,1]
    v_pk_mul_f32 v[92:93], v[92:93], v[212:213] op_sel_hi:[1,0]
    s_waitcnt lgkmcnt(4)
    v_pk_fma_f32 v[92:93], v[228:229], v[214:215], v[92:93] op_sel_hi:[1,0,1]
    v_pk_mul_f32 v[94:95], v[94:95], v[212:213] op_sel_hi:[1,0]
    v_pk_fma_f32 v[94:95], v[230:231], v[214:215], v[94:95] op_sel_hi:[1,0,1]
    v_pk_mul_f32 v[96:97], v[96:97], v[212:213] op_sel_hi:[1,0]
    s_waitcnt lgkmcnt(3)
    v_pk_fma_f32 v[96:97], v[232:233], v[214:215], v[96:97] op_sel_hi:[1,0,1]
    v_pk_mul_f32 v[98:99], v[98:99], v[212:213] op_sel_hi:[1,0]
    v_pk_fma_f32 v[98:99], v[234:235], v[214:215], v[98:99] op_sel_hi:[1,0,1]
    v_pk_mul_f32 v[100:101], v[100:101], v[212:213] op_sel_hi:[1,0]
    s_waitcnt lgkmcnt(2)
    v_pk_fma_f32 v[100:101], v[236:237], v[214:215], v[100:101] op_sel_hi:[1,0,1]
    v_pk_mul_f32 v[102:103], v[102:103], v[212:213] op_sel_hi:[1,0]
    v_pk_fma_f32 v[102:103], v[238:239], v[214:215], v[102:103] op_sel_hi:[1,0,1]
    v_pk_mul_f32 v[104:105], v[104:105], v[212:213] op_sel_hi:[1,0]
    s_waitcnt lgkmcnt(1)
    v_pk_fma_f32 v[104:105], v[240:241], v[214:215], v[104:105] op_sel_hi:[1,0,1]
    v_pk_mul_f32 v[106:107], v[106:107], v[212:213] op_sel_hi:[1,0]
    v_pk_fma_f32 v[106:107], v[242:243], v[214:215], v[106:107] op_sel_hi:[1,0,1]
    v_pk_mul_f32 v[108:109], v[108:109], v[212:213] op_sel_hi:[1,0]
    s_waitcnt lgkmcnt(0)
    v_pk_fma_f32 v[108:109], v[244:245], v[214:215], v[108:109] op_sel_hi:[1,0,1]
    v_pk_mul_f32 v[110:111], v[110:111], v[212:213] op_sel_hi:[1,0]
    v_pk_fma_f32 v[110:111], v[246:247], v[214:215], v[110:111] op_sel_hi:[1,0,1]
    v_cvt_pk_bf16_f32 v112, v80, v81
    v_cvt_pk_bf16_f32 v113, v82, v83
    v_cvt_pk_bf16_f32 v114, v84, v85
    v_cvt_pk_bf16_f32 v115, v86, v87
    v_cvt_pk_bf16_f32 v116, v88, v89
    v_cvt_pk_bf16_f32 v117, v90, v91
    v_cvt_pk_bf16_f32 v118, v92, v93
    v_cvt_pk_bf16_f32 v119, v94, v95
    v_cvt_pk_bf16_f32 v120, v96, v97
    v_cvt_pk_bf16_f32 v121, v98, v99
    v_cvt_pk_bf16_f32 v122, v100, v101
    v_cvt_pk_bf16_f32 v123, v102, v103
    v_cvt_pk_bf16_f32 v124, v104, v105
    v_cvt_pk_bf16_f32 v125, v106, v107
    v_cvt_pk_bf16_f32 v126, v108, v109
    v_cvt_pk_bf16_f32 v127, v110, v111
    s_mul_i32 s52, s28, 350208
    s_lshl_b32 s54, s21, 13
    s_add_u32 s52, s52, s54
    s_add_u32 s52, s52, 0x2201000
    buffer_store_dwordx4 v[112:115], v1, s[8:11], s52 offen offset:0 sc1
    buffer_store_dwordx4 v[116:119], v1, s[8:11], s52 offen offset:1024 sc1
    buffer_store_dwordx4 v[120:123], v1, s[8:11], s52 offen offset:2048 sc1
    buffer_store_dwordx4 v[124:127], v1, s[8:11], s52 offen offset:3072 sc1
    s_branch LF_p4
LF_mg0:
    ds_write_b128 v9, v[80:83] offset:0
    ds_write_b128 v9, v[84:87] offset:1024
    ds_write_b128 v9, v[88:91] offset:2048
    ds_write_b128 v9, v[92:95] offset:3072
    ds_write_b128 v9, v[96:99] offset:4096
    ds_write_b128 v9, v[100:103] offset:5120
    ds_write_b128 v9, v[104:107] offset:6144
    ds_write_b128 v9, v[108:111] offset:7168
    ds_write_b64 v12, v[14:15] offset:8192
    s_waitcnt lgkmcnt(0)
    s_barrier
    ds_read_b64 v[208:209], v13 offset:8192
    ds_read_b128 v[216:219], v10 offset:0
    ds_read_b128 v[220:223], v10 offset:1024
    ds_read_b128 v[224:227], v10 offset:2048
    ds_read_b128 v[228:231], v10 offset:3072
    ds_read_b128 v[232:235], v10 offset:4096
    ds_read_b128 v[236:239], v10 offset:5120
    ds_read_b128 v[240:243], v10 offset:6144
    ds_read_b128 v[244:247], v10 offset:7168
    s_waitcnt lgkmcnt(8)
    v_max_f32 v210, v6, v209
    v_sub_f32 v212, v6, v210
    v_sub_f32 v214, v209, v210
    v_exp_f32 v212, v212
    v_exp_f32 v214, v214
    v_mul_f32 v211, v212, v5
    v_fmac_f32 v211, v214, v208
    v_rcp_f32 v211, v211
    s_nop 0
    v_mul_f32 v212, v212, v211
    v_mul_f32 v214, v214, v211
    v_pk_mul_f32 v[48:49], v[48:49], v[212:213] op_sel_hi:[1,0]
    s_waitcnt lgkmcnt(7)
    v_pk_fma_f32 v[48:49], v[216:217], v[214:215], v[48:49] op_sel_hi:[1,0,1]
    v_pk_mul_f32 v[50:51], v[50:51], v[212:213] op_sel_hi:[1,0]
    v_pk_fma_f32 v[50:51], v[218:219], v[214:215], v[50:51] op_sel_hi:[1,0,1]
    v_pk_mul_f32 v[52:53], v[52:53], v[212:213] op_sel_hi:[1,0]
    s_waitcnt lgkmcnt(6)
    v_pk_fma_f32 v[52:53], v[220:221], v[214:215], v[52:53] op_sel_hi:[1,0,1]
    v_pk_mul_f32 v[54:55], v[54:55], v[212:213] op_sel_hi:[1,0]
    v_pk_fma_f32 v[54:55], v[222:223], v[214:215], v[54:55] op_sel_hi:[1,0,1]
    v_pk_mul_f32 v[56:57], v[56:57], v[212:213] op_sel_hi:[1,0]
    s_waitcnt lgkmcnt(5)
    v_pk_fma_f32 v[56:57], v[224:225], v[214:215], v[56:57] op_sel_hi:[1,0,1]
    v_pk_mul_f32 v[58:59], v[58:59], v[212:213] op_sel_hi:[1,0]
    v_pk_fma_f32 v[58:59], v[226:227], v[214:215], v[58:59] op_sel_hi:[1,0,1]
    v_pk_mul_f32 v[60:61], v[60:61], v[212:213] op_sel_hi:[1,0]
    s_waitcnt lgkmcnt(4)
    v_pk_fma_f32 v[60:61], v[228:229], v[214:215], v[60:61] op_sel_hi:[1,0,1]
    v_pk_mul_f32 v[62:63], v[62:63], v[212:213] op_sel_hi:[1,0]
    v_pk_fma_f32 v[62:63], v[230:231], v[214:215], v[62:63] op_sel_hi:[1,0,1]
    v_pk_mul_f32 v[64:65], v[64:65], v[212:213] op_sel_hi:[1,0]
    s_waitcnt lgkmcnt(3)
    v_pk_fma_f32 v[64:65], v[232:233], v[214:215], v[64:65] op_sel_hi:[1,0,1]
    v_pk_mul_f32 v[66:67], v[66:67], v[212:213] op_sel_hi:[1,0]
    v_pk_fma_f32 v[66:67], v[234:235], v[214:215], v[66:67] op_sel_hi:[1,0,1]
    v_pk_mul_f32 v[68:69], v[68:69], v[212:213] op_sel_hi:[1,0]
    s_waitcnt lgkmcnt(2)
    v_pk_fma_f32 v[68:69], v[236:237], v[214:215], v[68:69] op_sel_hi:[1,0,1]
    v_pk_mul_f32 v[70:71], v[70:71], v[212:213] op_sel_hi:[1,0]
    v_pk_fma_f32 v[70:71], v[238:239], v[214:215], v[70:71] op_sel_hi:[1,0,1]
    v_pk_mul_f32 v[72:73], v[72:73], v[212:213] op_sel_hi:[1,0]
    s_waitcnt lgkmcnt(1)
    v_pk_fma_f32 v[72:73], v[240:241], v[214:215], v[72:73] op_sel_hi:[1,0,1]
    v_pk_mul_f32 v[74:75], v[74:75], v[212:213] op_sel_hi:[1,0]
    v_pk_fma_f32 v[74:75], v[242:243], v[214:215], v[74:75] op_sel_hi:[1,0,1]
    v_pk_mul_f32 v[76:77], v[76:77], v[212:213] op_sel_hi:[1,0]
    s_waitcnt lgkmcnt(0)
    v_pk_fma_f32 v[76:77], v[244:245], v[214:215], v[76:77] op_sel_hi:[1,0,1]
    v_pk_mul_f32 v[78:79], v[78:79], v[212:213] op_sel_hi:[1,0]
    v_pk_fma_f32 v[78:79], v[246:247], v[214:215], v[78:79] op_sel_hi:[1,0,1]
    v_cvt_pk_bf16_f32 v112, v48, v49
    v_cvt_pk_bf16_f32 v113, v50, v51
    v_cvt_pk_bf16_f32 v114, v52, v53
    v_cvt_pk_bf16_f32 v115, v54, v55
    v_cvt_pk_bf16_f32 v116, v56, v57
    v_cvt_pk_bf16_f32 v117, v58, v59
    v_cvt_pk_bf16_f32 v118, v60, v61
    v_cvt_pk_bf16_f32 v119, v62, v63
    v_cvt_pk_bf16_f32 v120, v64, v65
    v_cvt_pk_bf16_f32 v121, v66, v67
    v_cvt_pk_bf16_f32 v122, v68, v69
    v_cvt_pk_bf16_f32 v123, v70, v71
    v_cvt_pk_bf16_f32 v124, v72, v73
    v_cvt_pk_bf16_f32 v125, v74, v75
    v_cvt_pk_bf16_f32 v126, v76, v77
    v_cvt_pk_bf16_f32 v127, v78, v79
    s_mul_i32 s52, s28, 350208
    s_lshl_b32 s54, s21, 13
    s_add_u32 s52, s52, s54
    s_add_u32 s52, s52, 0x2200000
    buffer_store_dwordx4 v[112:115], v1, s[8:11], s52 offen offset:0 sc1
    buffer_store_dwordx4 v[116:119], v1, s[8:11], s52 offen offset:1024 sc1
    buffer_store_dwordx4 v[120:123], v1, s[8:11], s52 offen offset:2048 sc1
    buffer_store_dwordx4 v[124:127], v1, s[8:11], s52 offen offset:3072 sc1
LF_p4:
    s_load_dwordx2 s[28:29], s[0:1], 40
    s_load_dwordx4 s[32:35], s[0:1], 72
    s_load_dwordx2 s[30:31], s[0:1], 0
    s_load_dwordx2 s[36:37], s[0:1], 96
    v_and_b32 v10, 63, v0
    v_add_u32 v2, 350208, v1
    v_lshrrev_b32 v11, 3, v10
    v_and_b32 v12, 7, v10
    v_bfe_u32 v13, v10, 4, 1
    v_lshlrev_b32 v13, 2, v13
    v_xor_b32 v12, v12, v13
    v_lshlrev_b32 v12, 4, v12
    v_lshl_add_u32 v3, v11, 10, v12
    v_lshrrev_b32 v11, 5, v10
    v_bfe_u32 v12, v10, 2, 2
    v_lshl_add_u32 v13, v11, 2, v12
    v_lshlrev_b32 v13, 7, v13
    v_lshrrev_b32 v12, 1, v12
    v_lshl_add_u32 v13, v12, 6, v13
    v_bfe_u32 v12, v10, 4, 1
    v_lshl_add_u32 v13, v12, 5, v13
    v_and_b32 v12, 3, v10
    v_lshl_add_u32 v13, v12, 3, v13
    s_mul_i32 s25, s20, 18432
    v_add_u32 v4, s25, v13
    v_xor_b32 v5, 64, v4
    s_mul_i32 s26, s20, 43
    s_cmp_ge_u32 s20, 4
    s_cselect_b32 s27, 1, 0
    s_sub_u32 s26, s26, s27
    s_cmp_ge_u32 s20, 5
    s_cselect_b32 s27, 1, 0
    s_sub_u32 s26, s26, s27
    s_and_b32 s44, s23, 7
    s_bfe_u32 s45, s23, 0x10003
    s_cmp_ge_u32 s24, 4
    s_cselect_b32 s46, 8, 0
    s_add_u32 s46, s46, s22
    s_lshl_b32 s47, s46, 1
    s_add_u32 s47, s47, s45
    s_sub_u32 s48, 15, s24
    s_add_u32 s48, s48, 32
    s_lshl_b32 s48, s48, 2
    s_add_u32 s49, s24, 32
    s_lshl_b32 s49, s49, 2
    s_add_u32 s50, s46, 32
    s_lshl_b32 s50, s50, 2
    s_waitcnt vmcnt(0) lgkmcnt(0)
    s_barrier
    s_cmp_lg_u32 s20, 0
    s_cbranch_scc1 LF_pub12
    v_mov_b32 v14, 1
    v_mov_b32 v15, 0
    s_mov_b64 exec, 1
    buffer_atomic_add v14, v15, s[96:99], s48 offen sc1
    s_mov_b64 exec, -1
LF_pub12:
    s_cmp_lg_u32 s24, 7
    s_cbranch_scc1 LF_nopubS2
    s_cmp_lg_u32 s20, 0
    s_cbranch_scc1 LF_pub13
    v_mov_b32 v14, 1
    v_mov_b32 v15, 0
    s_mov_b64 exec, 1
    buffer_atomic_add v14, v15, s[96:99], s49 offen sc1
    s_mov_b64 exec, -1
LF_pub13:
LF_nopubS2:
    s_mov_b32 s12, s36
    s_and_b32 s13, s37, 0xffff
    s_mov_b32 s14, 0x3760000
    s_mov_b32 s15, 0x00020000
    s_mov_b32 s16, s30
    s_and_b32 s17, s31, 0xffff
    s_mov_b32 s18, 0x200000
    s_mov_b32 s19, 0x00020000
    s_mov_b32 s36, s34
    s_and_b32 s37, s35, 0xffff
    s_mov_b32 s38, 0x200000
    s_mov_b32 s39, 0x00020000
    s_cmp_ge_u32 s20, 6
    s_cselect_b32 s4, s32, s28
    s_cselect_b32 s5, s33, s29
    s_mov_b32 s6, 0x400000
    s_cselect_b32 s6, 0x158000, s6
    s_and_b32 s5, s5, 0xffff
    s_mov_b32 s7, 0x00020000
    s_mul_i32 s40, s47, 700416
    s_lshl_b32 s43, s26, 10
    s_add_u32 s40, s40, s43
    s_add_u32 s40, s40, 0x2200000
    s_cmp_ge_u32 s20, 6
    s_cselect_b32 s43, 256, 0
    s_sub_u32 s43, s26, s43
    s_lshl_b32 s42, s43, 14
    s_lshl_b32 s43, s44, 7
    s_add_u32 s42, s42, s43
    s_sub_u32 s51, s20, 4
    s_cmp_lt_u32 s51, 2
    s_cselect_b32 s41, 0x7fff0000, s40
    s_cselect_b32 s52, 0x4000, 0
    s_add_u32 s52, s52, s42
    s_lshr_b32 s56, s20, 2
    s_bfe_u32 s57, s20, 0x10001
    s_and_b32 s58, s20, 1
    s_lshl_b32 s59, s47, 6
    s_lshl_b32 s60, s57, 5
    s_add_u32 s59, s59, s60
    s_lshl_b32 s59, s59, 10
    s_lshl_b32 s60, s44, 6
    s_lshl_b32 s61, s56, 5
    s_add_u32 s60, s60, s61
    s_lshl_b32 s61, s58, 4
    s_add_u32 s60, s60, s61
    s_lshl_b32 s60, s60, 1
    s_add_u32 s59, s59, s60
    v_and_b32 v11, 31, v10
    v_lshrrev_b32 v12, 5, v10
    v_lshlrev_b32 v11, 10, v11
    v_lshl_add_u32 v9, v12, 3, v11
    buffer_load_dwordx2 v[240:241], v9, s[16:19], s59 offen
    buffer_load_dwordx2 v[242:243], v9, s[16:19], s59 offen offset:16
    s_add_u32 m0, s25, 0
    s_mov_b32 s54, s52
    s_add_u32 s53, s52, 0x2000
    buffer_load_dwordx4 v3, s[4:7], s54 offen lds
    s_add_u32 m0, s25, 1024
    s_nop 0
    buffer_load_dwordx4 v3, s[4:7], s53 offen lds
    s_add_u32 m0, s25, 2048
    s_add_u32 s54, s42, 16384
    s_add_u32 s53, s42, 24576
    buffer_load_dwordx4 v3, s[4:7], s54 offen lds
    s_add_u32 m0, s25, 3072
    s_nop 0
    buffer_load_dwordx4 v3, s[4:7], s53 offen lds
    s_add_u32 m0, s25, 4096
    s_add_u32 s54, s42, 32768
    s_add_u32 s53, s42, 40960
    buffer_load_dwordx4 v3, s[4:7], s54 offen lds
    s_add_u32 m0, s25, 5120
    s_nop 0
    buffer_load_dwordx4 v3, s[4:7], s53 offen lds
    s_add_u32 m0, s25, 6144
    s_add_u32 s54, s42, 49152
    s_add_u32 s53, s42, 57344
    buffer_load_dwordx4 v3, s[4:7], s54 offen lds
    s_add_u32 m0, s25, 7168
    s_nop 0
    buffer_load_dwordx4 v3, s[4:7], s53 offen lds
    s_add_u32 m0, s25, 8192
    s_add_u32 s54, s42, 65536
    s_add_u32 s53, s42, 73728
    buffer_load_dwordx4 v3, s[4:7], s54 offen lds
    s_add_u32 m0, s25, 9216
    s_nop 0
    buffer_load_dwordx4 v3, s[4:7], s53 offen lds
    s_add_u32 m0, s25, 10240
    s_add_u32 s54, s42, 81920
    s_add_u32 s53, s42, 90112
    buffer_load_dwordx4 v3, s[4:7], s54 offen lds
    s_add_u32 m0, s25, 11264
    s_nop 0
    buffer_load_dwordx4 v3, s[4:7], s53 offen lds
    s_add_u32 m0, s25, 12288
    s_add_u32 s54, s42, 98304
    s_add_u32 s53, s42, 106496
    buffer_load_dwordx4 v3, s[4:7], s54 offen lds
    s_add_u32 m0, s25, 13312
    s_nop 0
    buffer_load_dwordx4 v3, s[4:7], s53 offen lds
    s_add_u32 m0, s25, 14336
    s_add_u32 s54, s42, 114688
    s_add_u32 s53, s42, 122880
    buffer_load_dwordx4 v3, s[4:7], s54 offen lds
    s_add_u32 m0, s25, 15360
    s_nop 0
    buffer_load_dwordx4 v3, s[4:7], s53 offen lds
    s_add_u32 m0, s25, 16384
    s_add_u32 s54, s42, 131072
    s_add_u32 s53, s42, 139264
    buffer_load_dwordx4 v3, s[4:7], s54 offen lds
    s_add_u32 m0, s25, 17408
    s_nop 0
    buffer_load_dwordx4 v3, s[4:7], s53 offen lds
    s_waitcnt vmcnt(16)
    ds_read_b64_tr_b16 v[144:145], v4 offset:0
    ds_read_b64_tr_b16 v[146:147], v4 offset:1024
    ds_read_b64_tr_b16 v[148:149], v5 offset:0
    ds_read_b64_tr_b16 v[150:151], v5 offset:1024
    s_waitcnt vmcnt(14)
    ds_read_b64_tr_b16 v[152:153], v4 offset:2048
    ds_read_b64_tr_b16 v[154:155], v4 offset:3072
    ds_read_b64_tr_b16 v[156:157], v5 offset:2048
    ds_read_b64_tr_b16 v[158:159], v5 offset:3072
    s_waitcnt lgkmcnt(4)
    s_add_u32 m0, s25, 0
    s_add_u32 s54, s42, 147456
    s_add_u32 s53, s42, 155648
    buffer_load_dwordx4 v3, s[4:7], s54 offen lds
    s_add_u32 m0, s25, 1024
    s_nop 0
    buffer_load_dwordx4 v3, s[4:7], s53 offen lds
    s_waitcnt vmcnt(14)
    ds_read_b64_tr_b16 v[160:161], v4 offset:4096
    ds_read_b64_tr_b16 v[162:163], v4 offset:5120
    ds_read_b64_tr_b16 v[164:165], v5 offset:4096
    ds_read_b64_tr_b16 v[166:167], v5 offset:5120
    s_waitcnt lgkmcnt(4)
    s_add_u32 m0, s25, 2048
    s_add_u32 s54, s42, 163840
    s_add_u32 s53, s42, 172032
    buffer_load_dwordx4 v3, s[4:7], s54 offen lds
    s_add_u32 m0, s25, 3072
    s_nop 0
    buffer_load_dwordx4 v3, s[4:7], s53 offen lds
    s_waitcnt vmcnt(14)
    ds_read_b64_tr_b16 v[168:169], v4 offset:6144
    ds_read_b64_tr_b16 v[170:171], v4 offset:7168
    ds_read_b64_tr_b16 v[172:173], v5 offset:6144
    ds_read_b64_tr_b16 v[174:175], v5 offset:7168
    s_waitcnt lgkmcnt(4)
    s_add_u32 m0, s25, 4096
    s_add_u32 s54, s42, 180224
    s_add_u32 s53, s42, 188416
    buffer_load_dwordx4 v3, s[4:7], s54 offen lds
    s_add_u32 m0, s25, 5120
    s_nop 0
    buffer_load_dwordx4 v3, s[4:7], s53 offen lds
    s_waitcnt vmcnt(14)
    ds_read_b64_tr_b16 v[176:177], v4 offset:8192
    ds_read_b64_tr_b16 v[178:179], v4 offset:9216
    ds_read_b64_tr_b16 v[180:181], v5 offset:8192
    ds_read_b64_tr_b16 v[182:183], v5 offset:9216
    s_waitcnt lgkmcnt(4)
    s_add_u32 m0, s25, 6144
    s_add_u32 s54, s42, 196608
    s_add_u32 s53, s42, 204800
    buffer_load_dwordx4 v3, s[4:7], s54 offen lds
    s_add_u32 m0, s25, 7168
    s_nop 0
    buffer_load_dwordx4 v3, s[4:7], s53 offen lds
    s_waitcnt vmcnt(14)
    ds_read_b64_tr_b16 v[184:185], v4 offset:10240
    ds_read_b64_tr_b16 v[186:187], v4 offset:11264
    ds_read_b64_tr_b16 v[188:189], v5 offset:10240
    ds_read_b64_tr_b16 v[190:191], v5 offset:11264
    s_waitcnt lgkmcnt(4)
    s_add_u32 m0, s25, 8192
    s_add_u32 s54, s42, 212992
    s_add_u32 s53, s42, 221184
    buffer_load_dwordx4 v3, s[4:7], s54 offen lds
    s_add_u32 m0, s25, 9216
    s_nop 0
    buffer_load_dwordx4 v3, s[4:7], s53 offen lds
    s_waitcnt vmcnt(14)
    ds_read_b64_tr_b16 v[192:193], v4 offset:12288
    ds_read_b64_tr_b16 v[194:195], v4 offset:13312
    ds_read_b64_tr_b16 v[196:197], v5 offset:12288
    ds_read_b64_tr_b16 v[198:199], v5 offset:13312
    s_waitcnt lgkmcnt(4)
    s_add_u32 m0, s25, 10240
    s_add_u32 s54, s42, 229376
    s_add_u32 s53, s42, 237568
    buffer_load_dwordx4 v3, s[4:7], s54 offen lds
    s_add_u32 m0, s25, 11264
    s_nop 0
    buffer_load_dwordx4 v3, s[4:7], s53 offen lds
    s_waitcnt vmcnt(14)
    ds_read_b64_tr_b16 v[200:201], v4 offset:14336
    ds_read_b64_tr_b16 v[202:203], v4 offset:15360
    ds_read_b64_tr_b16 v[204:205], v5 offset:14336
    ds_read_b64_tr_b16 v[206:207], v5 offset:15360
    s_waitcnt lgkmcnt(4)
    s_add_u32 m0, s25, 12288
    s_add_u32 s54, s42, 245760
    s_add_u32 s53, s42, 253952
    buffer_load_dwordx4 v3, s[4:7], s54 offen lds
    s_add_u32 m0, s25, 13312
    s_nop 0
    buffer_load_dwordx4 v3, s[4:7], s53 offen lds
    s_waitcnt vmcnt(14)
    ds_read_b64_tr_b16 v[208:209], v4 offset:16384
    ds_read_b64_tr_b16 v[210:211], v4 offset:17408
    ds_read_b64_tr_b16 v[212:213], v5 offset:16384
    ds_read_b64_tr_b16 v[214:215], v5 offset:17408
    s_waitcnt lgkmcnt(4)
    s_add_u32 m0, s25, 14336
    s_add_u32 s54, s42, 262144
    s_add_u32 s53, s42, 270336
    buffer_load_dwordx4 v3, s[4:7], s54 offen lds
    s_add_u32 m0, s25, 15360
    s_nop 0
    buffer_load_dwordx4 v3, s[4:7], s53 offen lds
    s_waitcnt vmcnt(14)
    ds_read_b64_tr_b16 v[216:217], v4 offset:0
    ds_read_b64_tr_b16 v[218:219], v4 offset:1024
    ds_read_b64_tr_b16 v[220:221], v5 offset:0
    ds_read_b64_tr_b16 v[222:223], v5 offset:1024
    s_waitcnt lgkmcnt(4)
    s_add_u32 m0, s25, 16384
    s_add_u32 s54, s42, 278528
    s_add_u32 s53, s42, 286720
    buffer_load_dwordx4 v3, s[4:7], s54 offen lds
    s_add_u32 m0, s25, 17408
    s_nop 0
    buffer_load_dwordx4 v3, s[4:7], s53 offen lds
    s_waitcnt vmcnt(14)
    ds_read_b64_tr_b16 v[224:225], v4 offset:2048
    ds_read_b64_tr_b16 v[226:227], v4 offset:3072
    ds_read_b64_tr_b16 v[228:229], v5 offset:2048
    ds_read_b64_tr_b16 v[230:231], v5 offset:3072
    s_waitcnt lgkmcnt(4)
    s_add_u32 m0, s25, 0
    s_add_u32 s54, s42, 294912
    s_add_u32 s53, s42, 303104
    buffer_load_dwordx4 v3, s[4:7], s54 offen lds
    s_add_u32 m0, s25, 1024
    s_nop 0
    buffer_load_dwordx4 v3, s[4:7], s53 offen lds
    s_waitcnt vmcnt(14)
    ds_read_b64_tr_b16 v[232:233], v4 offset:4096
    ds_read_b64_tr_b16 v[234:235], v4 offset:5120
    ds_read_b64_tr_b16 v[236:237], v5 offset:4096
    ds_read_b64_tr_b16 v[238:239], v5 offset:5120
    s_waitcnt lgkmcnt(4)
    s_add_u32 m0, s25, 2048
    s_add_u32 s54, s42, 311296
    s_add_u32 s53, s42, 319488
    buffer_load_dwordx4 v3, s[4:7], s54 offen lds
    s_add_u32 m0, s25, 3072
    s_nop 0
    buffer_load_dwordx4 v3, s[4:7], s53 offen lds
    s_waitcnt lgkmcnt(0)
    s_add_u32 m0, s25, 4096
    s_add_u32 s54, s42, 327680
    s_add_u32 s53, s42, 335872
    buffer_load_dwordx4 v3, s[4:7], s54 offen lds
    s_add_u32 m0, s25, 5120
    s_nop 0
    buffer_load_dwordx4 v3, s[4:7], s53 offen lds
    s_cmp_lg_u32 s20, 0
    s_cbranch_scc1 LF_poll14_done
    v_mov_b32 v15, 0
    s_mov_b32 s3, 32768
LF_poll14_0:
    buffer_load_dword v14, v15, s[96:99], s50 offen sc1
    s_waitcnt vmcnt(0)
    s_waitcnt vmcnt(0)
    v_readfirstlane_b32 s100, v14
    s_sub_u32 s3, s3, 1
    s_cmp_eq_u32 s3, 0
    s_cbranch_scc1 LF_poll14_acq
    s_cmp_ge_u32 s100, 32
    s_cbranch_scc1 LF_poll14_0_ok
    s_sleep 2
    s_branch LF_poll14_0
LF_poll14_0_ok:
LF_poll14_acq:
LF_poll14_done:
    s_barrier
    s_mov_b32 s55, s41
    buffer_load_dwordx4 v[16:19], v1, s[12:15], s55 offen sc1
    buffer_load_dwordx4 v[20:23], v2, s[12:15], s55 offen sc1
    s_add_u32 s55, s40, 1024
    buffer_load_dwordx4 v[24:27], v1, s[12:15], s55 offen sc1
    buffer_load_dwordx4 v[28:31], v2, s[12:15], s55 offen sc1
    s_add_u32 s55, s40, 2048
    buffer_load_dwordx4 v[32:35], v1, s[12:15], s55 offen sc1
    buffer_load_dwordx4 v[36:39], v2, s[12:15], s55 offen sc1
    s_add_u32 s55, s40, 3072
    buffer_load_dwordx4 v[40:43], v1, s[12:15], s55 offen sc1
    buffer_load_dwordx4 v[44:47], v2, s[12:15], s55 offen sc1
    s_add_u32 s55, s40, 4096
    buffer_load_dwordx4 v[48:51], v1, s[12:15], s55 offen sc1
    buffer_load_dwordx4 v[52:55], v2, s[12:15], s55 offen sc1
    s_add_u32 s55, s40, 5120
    buffer_load_dwordx4 v[56:59], v1, s[12:15], s55 offen sc1
    buffer_load_dwordx4 v[60:63], v2, s[12:15], s55 offen sc1
    s_waitcnt vmcnt(11)
    v_mfma_f32_32x32x16_bf16 v[80:95], v[144:147], v[16:19], 0
    s_waitcnt vmcnt(10)
    v_mfma_f32_32x32x16_bf16 v[96:111], v[144:147], v[20:23], 0
    v_mfma_f32_32x32x16_bf16 v[112:127], v[148:151], v[16:19], 0
    v_mfma_f32_32x32x16_bf16 v[128:143], v[148:151], v[20:23], 0
    s_add_u32 s55, s40, 6144
    buffer_load_dwordx4 v[16:19], v1, s[12:15], s55 offen sc1
    buffer_load_dwordx4 v[20:23], v2, s[12:15], s55 offen sc1
    s_waitcnt vmcnt(11)
    v_mfma_f32_32x32x16_bf16 v[80:95], v[152:155], v[24:27], v[80:95]
    s_waitcnt vmcnt(10)
    v_mfma_f32_32x32x16_bf16 v[96:111], v[152:155], v[28:31], v[96:111]
    v_mfma_f32_32x32x16_bf16 v[112:127], v[156:159], v[24:27], v[112:127]
    v_mfma_f32_32x32x16_bf16 v[128:143], v[156:159], v[28:31], v[128:143]
    s_add_u32 s55, s40, 7168
    buffer_load_dwordx4 v[24:27], v1, s[12:15], s55 offen sc1
    buffer_load_dwordx4 v[28:31], v2, s[12:15], s55 offen sc1
    s_waitcnt vmcnt(11)
    v_mfma_f32_32x32x16_bf16 v[80:95], v[160:163], v[32:35], v[80:95]
    s_waitcnt vmcnt(10)
    v_mfma_f32_32x32x16_bf16 v[96:111], v[160:163], v[36:39], v[96:111]
    v_mfma_f32_32x32x16_bf16 v[112:127], v[164:167], v[32:35], v[112:127]
    v_mfma_f32_32x32x16_bf16 v[128:143], v[164:167], v[36:39], v[128:143]
    s_add_u32 s55, s40, 8192
    buffer_load_dwordx4 v[32:35], v1, s[12:15], s55 offen sc1
    buffer_load_dwordx4 v[36:39], v2, s[12:15], s55 offen sc1
    s_waitcnt vmcnt(11)
    v_mfma_f32_32x32x16_bf16 v[80:95], v[168:171], v[40:43], v[80:95]
    s_waitcnt vmcnt(10)
    v_mfma_f32_32x32x16_bf16 v[96:111], v[168:171], v[44:47], v[96:111]
    v_mfma_f32_32x32x16_bf16 v[112:127], v[172:175], v[40:43], v[112:127]
    v_mfma_f32_32x32x16_bf16 v[128:143], v[172:175], v[44:47], v[128:143]
    s_add_u32 s55, s40, 9216
    buffer_load_dwordx4 v[40:43], v1, s[12:15], s55 offen sc1
    buffer_load_dwordx4 v[44:47], v2, s[12:15], s55 offen sc1
    s_waitcnt vmcnt(11)
    v_mfma_f32_32x32x16_bf16 v[80:95], v[176:179], v[48:51], v[80:95]
    s_waitcnt vmcnt(10)
    v_mfma_f32_32x32x16_bf16 v[96:111], v[176:179], v[52:55], v[96:111]
    v_mfma_f32_32x32x16_bf16 v[112:127], v[180:183], v[48:51], v[112:127]
    v_mfma_f32_32x32x16_bf16 v[128:143], v[180:183], v[52:55], v[128:143]
    s_add_u32 s55, s40, 10240
    buffer_load_dwordx4 v[48:51], v1, s[12:15], s55 offen sc1
    buffer_load_dwordx4 v[52:55], v2, s[12:15], s55 offen sc1
    s_waitcnt vmcnt(11)
    v_mfma_f32_32x32x16_bf16 v[80:95], v[184:187], v[56:59], v[80:95]
    s_waitcnt vmcnt(10)
    v_mfma_f32_32x32x16_bf16 v[96:111], v[184:187], v[60:63], v[96:111]
    v_mfma_f32_32x32x16_bf16 v[112:127], v[188:191], v[56:59], v[112:127]
    v_mfma_f32_32x32x16_bf16 v[128:143], v[188:191], v[60:63], v[128:143]
    s_add_u32 s55, s40, 11264
    buffer_load_dwordx4 v[56:59], v1, s[12:15], s55 offen sc1
    buffer_load_dwordx4 v[60:63], v2, s[12:15], s55 offen sc1
    s_waitcnt vmcnt(11)
    v_mfma_f32_32x32x16_bf16 v[80:95], v[192:195], v[16:19], v[80:95]
    s_waitcnt vmcnt(10)
    v_mfma_f32_32x32x16_bf16 v[96:111], v[192:195], v[20:23], v[96:111]
    v_mfma_f32_32x32x16_bf16 v[112:127], v[196:199], v[16:19], v[112:127]
    v_mfma_f32_32x32x16_bf16 v[128:143], v[196:199], v[20:23], v[128:143]
    s_add_u32 s55, s40, 12288
    buffer_load_dwordx4 v[16:19], v1, s[12:15], s55 offen sc1
    buffer_load_dwordx4 v[20:23], v2, s[12:15], s55 offen sc1
    s_waitcnt vmcnt(11)
    v_mfma_f32_32x32x16_bf16 v[80:95], v[200:203], v[24:27], v[80:95]
    s_waitcnt vmcnt(10)
    v_mfma_f32_32x32x16_bf16 v[96:111], v[200:203], v[28:31], v[96:111]
    v_mfma_f32_32x32x16_bf16 v[112:127], v[204:207], v[24:27], v[112:127]
    v_mfma_f32_32x32x16_bf16 v[128:143], v[204:207], v[28:31], v[128:143]
    s_add_u32 s55, s40, 13312
    buffer_load_dwordx4 v[24:27], v1, s[12:15], s55 offen sc1
    buffer_load_dwordx4 v[28:31], v2, s[12:15], s55 offen sc1
    s_waitcnt vmcnt(11)
    v_mfma_f32_32x32x16_bf16 v[80:95], v[208:211], v[32:35], v[80:95]
    s_waitcnt vmcnt(10)
    v_mfma_f32_32x32x16_bf16 v[96:111], v[208:211], v[36:39], v[96:111]
    v_mfma_f32_32x32x16_bf16 v[112:127], v[212:215], v[32:35], v[112:127]
    v_mfma_f32_32x32x16_bf16 v[128:143], v[212:215], v[36:39], v[128:143]
    s_add_u32 s55, s40, 14336
    buffer_load_dwordx4 v[32:35], v1, s[12:15], s55 offen sc1
    buffer_load_dwordx4 v[36:39], v2, s[12:15], s55 offen sc1
    s_waitcnt vmcnt(11)
    v_mfma_f32_32x32x16_bf16 v[80:95], v[216:219], v[40:43], v[80:95]
    s_waitcnt vmcnt(10)
    v_mfma_f32_32x32x16_bf16 v[96:111], v[216:219], v[44:47], v[96:111]
    v_mfma_f32_32x32x16_bf16 v[112:127], v[220:223], v[40:43], v[112:127]
    v_mfma_f32_32x32x16_bf16 v[128:143], v[220:223], v[44:47], v[128:143]
    s_add_u32 s55, s40, 15360
    buffer_load_dwordx4 v[40:43], v1, s[12:15], s55 offen sc1
    buffer_load_dwordx4 v[44:47], v2, s[12:15], s55 offen sc1
    s_waitcnt vmcnt(11)
    v_mfma_f32_32x32x16_bf16 v[80:95], v[224:227], v[48:51], v[80:95]
    s_waitcnt vmcnt(10)
    v_mfma_f32_32x32x16_bf16 v[96:111], v[224:227], v[52:55], v[96:111]
    v_mfma_f32_32x32x16_bf16 v[112:127], v[228:231], v[48:51], v[112:127]
    v_mfma_f32_32x32x16_bf16 v[128:143], v[228:231], v[52:55], v[128:143]
    s_add_u32 s55, s40, 16384
    buffer_load_dwordx4 v[48:51], v1, s[12:15], s55 offen sc1
    buffer_load_dwordx4 v[52:55], v2, s[12:15], s55 offen sc1
    ds_read_b64_tr_b16 v[64:65], v4 offset:6144
    ds_read_b64_tr_b16 v[66:67], v4 offset:7168
    ds_read_b64_tr_b16 v[68:69], v5 offset:6144
    ds_read_b64_tr_b16 v[70:71], v5 offset:7168
    s_waitcnt vmcnt(11)
    v_mfma_f32_32x32x16_bf16 v[80:95], v[232:235], v[56:59], v[80:95]
    s_waitcnt vmcnt(10)
    v_mfma_f32_32x32x16_bf16 v[96:111], v[232:235], v[60:63], v[96:111]
    v_mfma_f32_32x32x16_bf16 v[112:127], v[236:239], v[56:59], v[112:127]
    v_mfma_f32_32x32x16_bf16 v[128:143], v[236:239], v[60:63], v[128:143]
    s_add_u32 s55, s40, 17408
    buffer_load_dwordx4 v[56:59], v1, s[12:15], s55 offen sc1
    buffer_load_dwordx4 v[60:63], v2, s[12:15], s55 offen sc1
    ds_read_b64_tr_b16 v[72:73], v4 offset:8192
    ds_read_b64_tr_b16 v[74:75], v4 offset:9216
    ds_read_b64_tr_b16 v[76:77], v5 offset:8192
    ds_read_b64_tr_b16 v[78:79], v5 offset:9216
    s_waitcnt vmcnt(11) lgkmcnt(6)
    v_mfma_f32_32x32x16_bf16 v[80:95], v[64:67], v[16:19], v[80:95]
    s_waitcnt vmcnt(10)
    v_mfma_f32_32x32x16_bf16 v[96:111], v[64:67], v[20:23], v[96:111]
    s_waitcnt lgkmcnt(4)
    v_mfma_f32_32x32x16_bf16 v[112:127], v[68:71], v[16:19], v[112:127]
    v_mfma_f32_32x32x16_bf16 v[128:143], v[68:71], v[20:23], v[128:143]
    s_add_u32 s55, s40, 18432
    buffer_load_dwordx4 v[16:19], v1, s[12:15], s55 offen sc1
    buffer_load_dwordx4 v[20:23], v2, s[12:15], s55 offen sc1
    s_add_u32 m0, s25, 6144
    s_add_u32 s54, s42, 344064
    s_add_u32 s53, s42, 352256
    buffer_load_dwordx4 v3, s[4:7], s54 offen lds
    s_add_u32 m0, s25, 7168
    s_nop 0
    buffer_load_dwordx4 v3, s[4:7], s53 offen lds
    ds_read_b64_tr_b16 v[64:65], v4 offset:10240
    ds_read_b64_tr_b16 v[66:67], v4 offset:11264
    ds_read_b64_tr_b16 v[68:69], v5 offset:10240
    ds_read_b64_tr_b16 v[70:71], v5 offset:11264
    s_waitcnt vmcnt(13) lgkmcnt(6)
    v_mfma_f32_32x32x16_bf16 v[80:95], v[72:75], v[24:27], v[80:95]
    s_waitcnt vmcnt(12)
    v_mfma_f32_32x32x16_bf16 v[96:111], v[72:75], v[28:31], v[96:111]
    s_waitcnt lgkmcnt(4)
    v_mfma_f32_32x32x16_bf16 v[112:127], v[76:79], v[24:27], v[112:127]
    v_mfma_f32_32x32x16_bf16 v[128:143], v[76:79], v[28:31], v[128:143]
    s_add_u32 s55, s40, 19456
    buffer_load_dwordx4 v[24:27], v1, s[12:15], s55 offen sc1
    buffer_load_dwordx4 v[28:31], v2, s[12:15], s55 offen sc1
    s_add_u32 m0, s25, 8192
    s_add_u32 s54, s42, 360448
    s_add_u32 s53, s42, 368640
    buffer_load_dwordx4 v3, s[4:7], s54 offen lds
    s_add_u32 m0, s25, 9216
    s_nop 0
    buffer_load_dwordx4 v3, s[4:7], s53 offen lds
    ds_read_b64_tr_b16 v[72:73], v4 offset:12288
    ds_read_b64_tr_b16 v[74:75], v4 offset:13312
    ds_read_b64_tr_b16 v[76:77], v5 offset:12288
    ds_read_b64_tr_b16 v[78:79], v5 offset:13312
    s_waitcnt vmcnt(15) lgkmcnt(6)
    v_mfma_f32_32x32x16_bf16 v[80:95], v[64:67], v[32:35], v[80:95]
    s_waitcnt vmcnt(14)
    v_mfma_f32_32x32x16_bf16 v[96:111], v[64:67], v[36:39], v[96:111]
    s_waitcnt lgkmcnt(4)
    v_mfma_f32_32x32x16_bf16 v[112:127], v[68:71], v[32:35], v[112:127]
    v_mfma_f32_32x32x16_bf16 v[128:143], v[68:71], v[36:39], v[128:143]
    s_add_u32 s55, s40, 20480
    buffer_load_dwordx4 v[32:35], v1, s[12:15], s55 offen sc1
    buffer_load_dwordx4 v[36:39], v2, s[12:15], s55 offen sc1
    s_add_u32 m0, s25, 10240
    s_add_u32 s54, s42, 376832
    s_add_u32 s53, s42, 385024
    buffer_load_dwordx4 v3, s[4:7], s54 offen lds
    s_add_u32 m0, s25, 11264
    s_nop 0
    buffer_load_dwordx4 v3, s[4:7], s53 offen lds
    ds_read_b64_tr_b16 v[64:65], v4 offset:14336
    ds_read_b64_tr_b16 v[66:67], v4 offset:15360
    ds_read_b64_tr_b16 v[68:69], v5 offset:14336
    ds_read_b64_tr_b16 v[70:71], v5 offset:15360
    s_waitcnt vmcnt(17) lgkmcnt(6)
    v_mfma_f32_32x32x16_bf16 v[80:95], v[72:75], v[40:43], v[80:95]
    s_waitcnt vmcnt(16)
    v_mfma_f32_32x32x16_bf16 v[96:111], v[72:75], v[44:47], v[96:111]
    s_waitcnt lgkmcnt(4)
    v_mfma_f32_32x32x16_bf16 v[112:127], v[76:79], v[40:43], v[112:127]
    v_mfma_f32_32x32x16_bf16 v[128:143], v[76:79], v[44:47], v[128:143]
    s_add_u32 s55, s40, 21504
    buffer_load_dwordx4 v[40:43], v1, s[12:15], s55 offen sc1
    buffer_load_dwordx4 v[44:47], v2, s[12:15], s55 offen sc1
    s_add_u32 m0, s25, 12288
    s_add_u32 s54, s42, 393216
    s_add_u32 s53, s42, 401408
    buffer_load_dwordx4 v3, s[4:7], s54 offen lds
    s_add_u32 m0, s25, 13312
    s_nop 0
    buffer_load_dwordx4 v3, s[4:7], s53 offen lds
    ds_read_b64_tr_b16 v[72:73], v4 offset:16384
    ds_read_b64_tr_b16 v[74:75], v4 offset:17408
    ds_read_b64_tr_b16 v[76:77], v5 offset:16384
    ds_read_b64_tr_b16 v[78:79], v5 offset:17408
    s_waitcnt vmcnt(19) lgkmcnt(6)
    v_mfma_f32_32x32x16_bf16 v[80:95], v[64:67], v[48:51], v[80:95]
    s_waitcnt vmcnt(18)
    v_mfma_f32_32x32x16_bf16 v[96:111], v[64:67], v[52:55], v[96:111]
    s_waitcnt lgkmcnt(4)
    v_mfma_f32_32x32x16_bf16 v[112:127], v[68:71], v[48:51], v[112:127]
    v_mfma_f32_32x32x16_bf16 v[128:143], v[68:71], v[52:55], v[128:143]
    s_add_u32 s55, s40, 22528
    buffer_load_dwordx4 v[48:51], v1, s[12:15], s55 offen sc1
    buffer_load_dwordx4 v[52:55], v2, s[12:15], s55 offen sc1
    s_add_u32 m0, s25, 14336
    s_add_u32 s54, s42, 409600
    s_add_u32 s53, s42, 417792
    buffer_load_dwordx4 v3, s[4:7], s54 offen lds
    s_add_u32 m0, s25, 15360
    s_nop 0
    buffer_load_dwordx4 v3, s[4:7], s53 offen lds
    ds_read_b64_tr_b16 v[64:65], v4 offset:0
    ds_read_b64_tr_b16 v[66:67], v4 offset:1024
    ds_read_b64_tr_b16 v[68:69], v5 offset:0
    ds_read_b64_tr_b16 v[70:71], v5 offset:1024
    s_waitcnt vmcnt(21) lgkmcnt(6)
    v_mfma_f32_32x32x16_bf16 v[80:95], v[72:75], v[56:59], v[80:95]
    s_waitcnt vmcnt(20)
    v_mfma_f32_32x32x16_bf16 v[96:111], v[72:75], v[60:63], v[96:111]
    s_waitcnt lgkmcnt(4)
    v_mfma_f32_32x32x16_bf16 v[112:127], v[76:79], v[56:59], v[112:127]
    v_mfma_f32_32x32x16_bf16 v[128:143], v[76:79], v[60:63], v[128:143]
    s_add_u32 s55, s40, 23552
    buffer_load_dwordx4 v[56:59], v1, s[12:15], s55 offen sc1
    buffer_load_dwordx4 v[60:63], v2, s[12:15], s55 offen sc1
    s_add_u32 m0, s25, 16384
    s_add_u32 s54, s42, 425984
    s_add_u32 s53, s42, 434176
    buffer_load_dwordx4 v3, s[4:7], s54 offen lds
    s_add_u32 m0, s25, 17408
    s_nop 0
    buffer_load_dwordx4 v3, s[4:7], s53 offen lds
    ds_read_b64_tr_b16 v[72:73], v4 offset:2048
    ds_read_b64_tr_b16 v[74:75], v4 offset:3072
    ds_read_b64_tr_b16 v[76:77], v5 offset:2048
    ds_read_b64_tr_b16 v[78:79], v5 offset:3072
    s_waitcnt vmcnt(23) lgkmcnt(6)
    v_mfma_f32_32x32x16_bf16 v[80:95], v[64:67], v[16:19], v[80:95]
    s_waitcnt vmcnt(22)
    v_mfma_f32_32x32x16_bf16 v[96:111], v[64:67], v[20:23], v[96:111]
    s_waitcnt lgkmcnt(4)
    v_mfma_f32_32x32x16_bf16 v[112:127], v[68:71], v[16:19], v[112:127]
    v_mfma_f32_32x32x16_bf16 v[128:143], v[68:71], v[20:23], v[128:143]
    s_add_u32 s55, s40, 24576
    buffer_load_dwordx4 v[16:19], v1, s[12:15], s55 offen sc1
    buffer_load_dwordx4 v[20:23], v2, s[12:15], s55 offen sc1
    s_add_u32 m0, s25, 0
    s_add_u32 s54, s42, 442368
    s_add_u32 s53, s42, 450560
    buffer_load_dwordx4 v3, s[4:7], s54 offen lds
    s_add_u32 m0, s25, 1024
    s_nop 0
    buffer_load_dwordx4 v3, s[4:7], s53 offen lds
    ds_read_b64_tr_b16 v[64:65], v4 offset:4096
    ds_read_b64_tr_b16 v[66:67], v4 offset:5120
    ds_read_b64_tr_b16 v[68:69], v5 offset:4096
    ds_read_b64_tr_b16 v[70:71], v5 offset:5120
    s_waitcnt vmcnt(23) lgkmcnt(6)
    v_mfma_f32_32x32x16_bf16 v[80:95], v[72:75], v[24:27], v[80:95]
    s_waitcnt vmcnt(22)
    v_mfma_f32_32x32x16_bf16 v[96:111], v[72:75], v[28:31], v[96:111]
    s_waitcnt lgkmcnt(4)
    v_mfma_f32_32x32x16_bf16 v[112:127], v[76:79], v[24:27], v[112:127]
    v_mfma_f32_32x32x16_bf16 v[128:143], v[76:79], v[28:31], v[128:143]
    s_add_u32 s55, s40, 25600
    buffer_load_dwordx4 v[24:27], v1, s[12:15], s55 offen sc1
    buffer_load_dwordx4 v[28:31], v2, s[12:15], s55 offen sc1
    s_add_u32 m0, s25, 2048
    s_add_u32 s54, s42, 458752
    s_add_u32 s53, s42, 466944
    buffer_load_dwordx4 v3, s[4:7], s54 offen lds
    s_add_u32 m0, s25, 3072
    s_nop 0
    buffer_load_dwordx4 v3, s[4:7], s53 offen lds
    ds_read_b64_tr_b16 v[72:73], v4 offset:6144
    ds_read_b64_tr_b16 v[74:75], v4 offset:7168
    ds_read_b64_tr_b16 v[76:77], v5 offset:6144
    ds_read_b64_tr_b16 v[78:79], v5 offset:7168
    s_waitcnt vmcnt(23) lgkmcnt(6)
    v_mfma_f32_32x32x16_bf16 v[80:95], v[64:67], v[32:35], v[80:95]
    s_waitcnt vmcnt(22)
    v_mfma_f32_32x32x16_bf16 v[96:111], v[64:67], v[36:39], v[96:111]
    s_waitcnt lgkmcnt(4)
    v_mfma_f32_32x32x16_bf16 v[112:127], v[68:71], v[32:35], v[112:127]
    v_mfma_f32_32x32x16_bf16 v[128:143], v[68:71], v[36:39], v[128:143]
    s_add_u32 s55, s40, 26624
    buffer_load_dwordx4 v[32:35], v1, s[12:15], s55 offen sc1
    buffer_load_dwordx4 v[36:39], v2, s[12:15], s55 offen sc1
    s_add_u32 m0, s25, 4096
    s_add_u32 s54, s42, 475136
    s_add_u32 s53, s42, 483328
    buffer_load_dwordx4 v3, s[4:7], s54 offen lds
    s_add_u32 m0, s25, 5120
    s_nop 0
    buffer_load_dwordx4 v3, s[4:7], s53 offen lds
    ds_read_b64_tr_b16 v[64:65], v4 offset:8192
    ds_read_b64_tr_b16 v[66:67], v4 offset:9216
    ds_read_b64_tr_b16 v[68:69], v5 offset:8192
    ds_read_b64_tr_b16 v[70:71], v5 offset:9216
    s_waitcnt vmcnt(23) lgkmcnt(6)
    v_mfma_f32_32x32x16_bf16 v[80:95], v[72:75], v[40:43], v[80:95]
    s_waitcnt vmcnt(22)
    v_mfma_f32_32x32x16_bf16 v[96:111], v[72:75], v[44:47], v[96:111]
    s_waitcnt lgkmcnt(4)
    v_mfma_f32_32x32x16_bf16 v[112:127], v[76:79], v[40:43], v[112:127]
    v_mfma_f32_32x32x16_bf16 v[128:143], v[76:79], v[44:47], v[128:143]
    s_add_u32 s55, s40, 27648
    buffer_load_dwordx4 v[40:43], v1, s[12:15], s55 offen sc1
    buffer_load_dwordx4 v[44:47], v2, s[12:15], s55 offen sc1
    s_add_u32 m0, s25, 6144
    s_add_u32 s54, s42, 491520
    s_add_u32 s53, s42, 499712
    buffer_load_dwordx4 v3, s[4:7], s54 offen lds
    s_add_u32 m0, s25, 7168
    s_nop 0
    buffer_load_dwordx4 v3, s[4:7], s53 offen lds
    ds_read_b64_tr_b16 v[72:73], v4 offset:10240
    ds_read_b64_tr_b16 v[74:75], v4 offset:11264
    ds_read_b64_tr_b16 v[76:77], v5 offset:10240
    ds_read_b64_tr_b16 v[78:79], v5 offset:11264
    s_waitcnt vmcnt(23) lgkmcnt(6)
    v_mfma_f32_32x32x16_bf16 v[80:95], v[64:67], v[48:51], v[80:95]
    s_waitcnt vmcnt(22)
    v_mfma_f32_32x32x16_bf16 v[96:111], v[64:67], v[52:55], v[96:111]
    s_waitcnt lgkmcnt(4)
    v_mfma_f32_32x32x16_bf16 v[112:127], v[68:71], v[48:51], v[112:127]
    v_mfma_f32_32x32x16_bf16 v[128:143], v[68:71], v[52:55], v[128:143]
    s_add_u32 s55, s40, 28672
    buffer_load_dwordx4 v[48:51], v1, s[12:15], s55 offen sc1
    buffer_load_dwordx4 v[52:55], v2, s[12:15], s55 offen sc1
    s_add_u32 m0, s25, 8192
    s_add_u32 s54, s42, 507904
    s_add_u32 s53, s42, 516096
    buffer_load_dwordx4 v3, s[4:7], s54 offen lds
    s_add_u32 m0, s25, 9216
    s_nop 0
    buffer_load_dwordx4 v3, s[4:7], s53 offen lds
    ds_read_b64_tr_b16 v[64:65], v4 offset:12288
    ds_read_b64_tr_b16 v[66:67], v4 offset:13312
    ds_read_b64_tr_b16 v[68:69], v5 offset:12288
    ds_read_b64_tr_b16 v[70:71], v5 offset:13312
    s_waitcnt vmcnt(23) lgkmcnt(6)
    v_mfma_f32_32x32x16_bf16 v[80:95], v[72:75], v[56:59], v[80:95]
    s_waitcnt vmcnt(22)
    v_mfma_f32_32x32x16_bf16 v[96:111], v[72:75], v[60:63], v[96:111]
    s_waitcnt lgkmcnt(4)
    v_mfma_f32_32x32x16_bf16 v[112:127], v[76:79], v[56:59], v[112:127]
    v_mfma_f32_32x32x16_bf16 v[128:143], v[76:79], v[60:63], v[128:143]
    s_add_u32 s55, s40, 29696
    buffer_load_dwordx4 v[56:59], v1, s[12:15], s55 offen sc1
    buffer_load_dwordx4 v[60:63], v2, s[12:15], s55 offen sc1
    s_add_u32 m0, s25, 10240
    s_add_u32 s54, s42, 524288
    s_add_u32 s53, s42, 532480
    buffer_load_dwordx4 v3, s[4:7], s54 offen lds
    s_add_u32 m0, s25, 11264
    s_nop 0
    buffer_load_dwordx4 v3, s[4:7], s53 offen lds
    ds_read_b64_tr_b16 v[72:73], v4 offset:14336
    ds_read_b64_tr_b16 v[74:75], v4 offset:15360
    ds_read_b64_tr_b16 v[76:77], v5 offset:14336
    ds_read_b64_tr_b16 v[78:79], v5 offset:15360
    s_waitcnt vmcnt(23) lgkmcnt(6)
    v_mfma_f32_32x32x16_bf16 v[80:95], v[64:67], v[16:19], v[80:95]
    s_waitcnt vmcnt(22)
    v_mfma_f32_32x32x16_bf16 v[96:111], v[64:67], v[20:23], v[96:111]
    s_waitcnt lgkmcnt(4)
    v_mfma_f32_32x32x16_bf16 v[112:127], v[68:71], v[16:19], v[112:127]
    v_mfma_f32_32x32x16_bf16 v[128:143], v[68:71], v[20:23], v[128:143]
    s_add_u32 s55, s40, 30720
    buffer_load_dwordx4 v[16:19], v1, s[12:15], s55 offen sc1
    buffer_load_dwordx4 v[20:23], v2, s[12:15], s55 offen sc1
    s_add_u32 m0, s25, 12288
    s_add_u32 s54, s42, 540672
    s_add_u32 s53, s42, 548864
    buffer_load_dwordx4 v3, s[4:7], s54 offen lds
    s_add_u32 m0, s25, 13312
    s_nop 0
    buffer_load_dwordx4 v3, s[4:7], s53 offen lds
    ds_read_b64_tr_b16 v[64:65], v4 offset:16384
    ds_read_b64_tr_b16 v[66:67], v4 offset:17408
    ds_read_b64_tr_b16 v[68:69], v5 offset:16384
    ds_read_b64_tr_b16 v[70:71], v5 offset:17408
    s_waitcnt vmcnt(23) lgkmcnt(6)
    v_mfma_f32_32x32x16_bf16 v[80:95], v[72:75], v[24:27], v[80:95]
    s_waitcnt vmcnt(22)
    v_mfma_f32_32x32x16_bf16 v[96:111], v[72:75], v[28:31], v[96:111]
    s_waitcnt lgkmcnt(4)
    v_mfma_f32_32x32x16_bf16 v[112:127], v[76:79], v[24:27], v[112:127]
    v_mfma_f32_32x32x16_bf16 v[128:143], v[76:79], v[28:31], v[128:143]
    s_add_u32 s55, s40, 31744
    buffer_load_dwordx4 v[24:27], v1, s[12:15], s55 offen sc1
    buffer_load_dwordx4 v[28:31], v2, s[12:15], s55 offen sc1
    s_add_u32 m0, s25, 14336
    s_add_u32 s54, s42, 557056
    s_add_u32 s53, s42, 565248
    buffer_load_dwordx4 v3, s[4:7], s54 offen lds
    s_add_u32 m0, s25, 15360
    s_nop 0
    buffer_load_dwordx4 v3, s[4:7], s53 offen lds
    ds_read_b64_tr_b16 v[72:73], v4 offset:0
    ds_read_b64_tr_b16 v[74:75], v4 offset:1024
    ds_read_b64_tr_b16 v[76:77], v5 offset:0
    ds_read_b64_tr_b16 v[78:79], v5 offset:1024
    s_waitcnt vmcnt(23) lgkmcnt(6)
    v_mfma_f32_32x32x16_bf16 v[80:95], v[64:67], v[32:35], v[80:95]
    s_waitcnt vmcnt(22)
    v_mfma_f32_32x32x16_bf16 v[96:111], v[64:67], v[36:39], v[96:111]
    s_waitcnt lgkmcnt(4)
    v_mfma_f32_32x32x16_bf16 v[112:127], v[68:71], v[32:35], v[112:127]
    v_mfma_f32_32x32x16_bf16 v[128:143], v[68:71], v[36:39], v[128:143]
    s_add_u32 s55, s40, 32768
    buffer_load_dwordx4 v[32:35], v1, s[12:15], s55 offen sc1
    buffer_load_dwordx4 v[36:39], v2, s[12:15], s55 offen sc1
    s_add_u32 m0, s25, 16384
    s_add_u32 s54, s42, 573440
    s_add_u32 s53, s42, 581632
    buffer_load_dwordx4 v3, s[4:7], s54 offen lds
    s_add_u32 m0, s25, 17408
    s_nop 0
    buffer_load_dwordx4 v3, s[4:7], s53 offen lds
    ds_read_b64_tr_b16 v[64:65], v4 offset:2048
    ds_read_b64_tr_b16 v[66:67], v4 offset:3072
    ds_read_b64_tr_b16 v[68:69], v5 offset:2048
    ds_read_b64_tr_b16 v[70:71], v5 offset:3072
    s_waitcnt vmcnt(23) lgkmcnt(6)
    v_mfma_f32_32x32x16_bf16 v[80:95], v[72:75], v[40:43], v[80:95]
    s_waitcnt vmcnt(22)
    v_mfma_f32_32x32x16_bf16 v[96:111], v[72:75], v[44:47], v[96:111]
    s_waitcnt lgkmcnt(4)
    v_mfma_f32_32x32x16_bf16 v[112:127], v[76:79], v[40:43], v[112:127]
    v_mfma_f32_32x32x16_bf16 v[128:143], v[76:79], v[44:47], v[128:143]
    s_add_u32 s55, s40, 33792
    buffer_load_dwordx4 v[40:43], v1, s[12:15], s55 offen sc1
    buffer_load_dwordx4 v[44:47], v2, s[12:15], s55 offen sc1
    s_add_u32 m0, s25, 0
    s_add_u32 s54, s42, 589824
    s_add_u32 s53, s42, 598016
    buffer_load_dwordx4 v3, s[4:7], s54 offen lds
    s_add_u32 m0, s25, 1024
    s_nop 0
    buffer_load_dwordx4 v3, s[4:7], s53 offen lds
    ds_read_b64_tr_b16 v[72:73], v4 offset:4096
    ds_read_b64_tr_b16 v[74:75], v4 offset:5120
    ds_read_b64_tr_b16 v[76:77], v5 offset:4096
    ds_read_b64_tr_b16 v[78:79], v5 offset:5120
    s_waitcnt vmcnt(23) lgkmcnt(6)
    v_mfma_f32_32x32x16_bf16 v[80:95], v[64:67], v[48:51], v[80:95]
    s_waitcnt vmcnt(22)
    v_mfma_f32_32x32x16_bf16 v[96:111], v[64:67], v[52:55], v[96:111]
    s_waitcnt lgkmcnt(4)
    v_mfma_f32_32x32x16_bf16 v[112:127], v[68:71], v[48:51], v[112:127]
    v_mfma_f32_32x32x16_bf16 v[128:143], v[68:71], v[52:55], v[128:143]
    s_add_u32 s55, s40, 34816
    buffer_load_dwordx4 v[48:51], v1, s[12:15], s55 offen sc1
    buffer_load_dwordx4 v[52:55], v2, s[12:15], s55 offen sc1
    s_add_u32 m0, s25, 2048
    s_add_u32 s54, s42, 606208
    s_add_u32 s53, s42, 614400
    buffer_load_dwordx4 v3, s[4:7], s54 offen lds
    s_add_u32 m0, s25, 3072
    s_nop 0
    buffer_load_dwordx4 v3, s[4:7], s53 offen lds
    ds_read_b64_tr_b16 v[64:65], v4 offset:6144
    ds_read_b64_tr_b16 v[66:67], v4 offset:7168
    ds_read_b64_tr_b16 v[68:69], v5 offset:6144
    ds_read_b64_tr_b16 v[70:71], v5 offset:7168
    s_waitcnt vmcnt(23) lgkmcnt(6)
    v_mfma_f32_32x32x16_bf16 v[80:95], v[72:75], v[56:59], v[80:95]
    s_waitcnt vmcnt(22)
    v_mfma_f32_32x32x16_bf16 v[96:111], v[72:75], v[60:63], v[96:111]
    s_waitcnt lgkmcnt(4)
    v_mfma_f32_32x32x16_bf16 v[112:127], v[76:79], v[56:59], v[112:127]
    v_mfma_f32_32x32x16_bf16 v[128:143], v[76:79], v[60:63], v[128:143]
    s_add_u32 s55, s40, 35840
    buffer_load_dwordx4 v[56:59], v1, s[12:15], s55 offen sc1
    buffer_load_dwordx4 v[60:63], v2, s[12:15], s55 offen sc1
    s_add_u32 m0, s25, 4096
    s_add_u32 s54, s42, 622592
    s_add_u32 s53, s42, 630784
    buffer_load_dwordx4 v3, s[4:7], s54 offen lds
    s_add_u32 m0, s25, 5120
    s_nop 0
    buffer_load_dwordx4 v3, s[4:7], s53 offen lds
    ds_read_b64_tr_b16 v[72:73], v4 offset:8192
    ds_read_b64_tr_b16 v[74:75], v4 offset:9216
    ds_read_b64_tr_b16 v[76:77], v5 offset:8192
    ds_read_b64_tr_b16 v[78:79], v5 offset:9216
    s_waitcnt vmcnt(23) lgkmcnt(6)
    v_mfma_f32_32x32x16_bf16 v[80:95], v[64:67], v[16:19], v[80:95]
    s_waitcnt vmcnt(22)
    v_mfma_f32_32x32x16_bf16 v[96:111], v[64:67], v[20:23], v[96:111]
    s_waitcnt lgkmcnt(4)
    v_mfma_f32_32x32x16_bf16 v[112:127], v[68:71], v[16:19], v[112:127]
    v_mfma_f32_32x32x16_bf16 v[128:143], v[68:71], v[20:23], v[128:143]
    s_add_u32 s55, s40, 36864
    buffer_load_dwordx4 v[16:19], v1, s[12:15], s55 offen sc1
    buffer_load_dwordx4 v[20:23], v2, s[12:15], s55 offen sc1
    s_add_u32 m0, s25, 6144
    s_add_u32 s54, s42, 638976
    s_add_u32 s53, s42, 647168
    buffer_load_dwordx4 v3, s[4:7], s54 offen lds
    s_add_u32 m0, s25, 7168
    s_nop 0
    buffer_load_dwordx4 v3, s[4:7], s53 offen lds
    ds_read_b64_tr_b16 v[64:65], v4 offset:10240
    ds_read_b64_tr_b16 v[66:67], v4 offset:11264
    ds_read_b64_tr_b16 v[68:69], v5 offset:10240
    ds_read_b64_tr_b16 v[70:71], v5 offset:11264
    s_waitcnt vmcnt(23) lgkmcnt(6)
    v_mfma_f32_32x32x16_bf16 v[80:95], v[72:75], v[24:27], v[80:95]
    s_waitcnt vmcnt(22)
    v_mfma_f32_32x32x16_bf16 v[96:111], v[72:75], v[28:31], v[96:111]
    s_waitcnt lgkmcnt(4)
    v_mfma_f32_32x32x16_bf16 v[112:127], v[76:79], v[24:27], v[112:127]
    v_mfma_f32_32x32x16_bf16 v[128:143], v[76:79], v[28:31], v[128:143]
    s_add_u32 s55, s40, 37888
    buffer_load_dwordx4 v[24:27], v1, s[12:15], s55 offen sc1
    buffer_load_dwordx4 v[28:31], v2, s[12:15], s55 offen sc1
    s_add_u32 m0, s25, 8192
    s_add_u32 s54, s42, 655360
    s_add_u32 s53, s42, 663552
    buffer_load_dwordx4 v3, s[4:7], s54 offen lds
    s_add_u32 m0, s25, 9216
    s_nop 0
    buffer_load_dwordx4 v3, s[4:7], s53 offen lds
    ds_read_b64_tr_b16 v[72:73], v4 offset:12288
    ds_read_b64_tr_b16 v[74:75], v4 offset:13312
    ds_read_b64_tr_b16 v[76:77], v5 offset:12288
    ds_read_b64_tr_b16 v[78:79], v5 offset:13312
    s_waitcnt vmcnt(23) lgkmcnt(6)
    v_mfma_f32_32x32x16_bf16 v[80:95], v[64:67], v[32:35], v[80:95]
    s_waitcnt vmcnt(22)
    v_mfma_f32_32x32x16_bf16 v[96:111], v[64:67], v[36:39], v[96:111]
    s_waitcnt lgkmcnt(4)
    v_mfma_f32_32x32x16_bf16 v[112:127], v[68:71], v[32:35], v[112:127]
    v_mfma_f32_32x32x16_bf16 v[128:143], v[68:71], v[36:39], v[128:143]
    s_add_u32 s55, s40, 38912
    buffer_load_dwordx4 v[32:35], v1, s[12:15], s55 offen sc1
    buffer_load_dwordx4 v[36:39], v2, s[12:15], s55 offen sc1
    s_add_u32 m0, s25, 10240
    s_add_u32 s54, s42, 671744
    s_add_u32 s53, s42, 679936
    buffer_load_dwordx4 v3, s[4:7], s54 offen lds
    s_add_u32 m0, s25, 11264
    s_nop 0
    buffer_load_dwordx4 v3, s[4:7], s53 offen lds
    ds_read_b64_tr_b16 v[64:65], v4 offset:14336
    ds_read_b64_tr_b16 v[66:67], v4 offset:15360
    ds_read_b64_tr_b16 v[68:69], v5 offset:14336
    ds_read_b64_tr_b16 v[70:71], v5 offset:15360
    s_waitcnt vmcnt(23) lgkmcnt(6)
    v_mfma_f32_32x32x16_bf16 v[80:95], v[72:75], v[40:43], v[80:95]
    s_waitcnt vmcnt(22)
    v_mfma_f32_32x32x16_bf16 v[96:111], v[72:75], v[44:47], v[96:111]
    s_waitcnt lgkmcnt(4)
    v_mfma_f32_32x32x16_bf16 v[112:127], v[76:79], v[40:43], v[112:127]
    v_mfma_f32_32x32x16_bf16 v[128:143], v[76:79], v[44:47], v[128:143]
    s_add_u32 s55, s40, 39936
    buffer_load_dwordx4 v[40:43], v1, s[12:15], s55 offen sc1
    buffer_load_dwordx4 v[44:47], v2, s[12:15], s55 offen sc1
    s_add_u32 m0, s25, 12288
    s_add_u32 s54, s42, 688128
    s_add_u32 s53, s42, 696320
    buffer_load_dwordx4 v3, s[4:7], s54 offen lds
    s_add_u32 m0, s25, 13312
    s_nop 0
    buffer_load_dwordx4 v3, s[4:7], s53 offen lds
    ds_read_b64_tr_b16 v[72:73], v4 offset:16384
    ds_read_b64_tr_b16 v[74:75], v4 offset:17408
    ds_read_b64_tr_b16 v[76:77], v5 offset:16384
    ds_read_b64_tr_b16 v[78:79], v5 offset:17408
    s_waitcnt vmcnt(23) lgkmcnt(6)
    v_mfma_f32_32x32x16_bf16 v[80:95], v[64:67], v[48:51], v[80:95]
    s_waitcnt vmcnt(22)
    v_mfma_f32_32x32x16_bf16 v[96:111], v[64:67], v[52:55], v[96:111]
    s_waitcnt lgkmcnt(4)
    v_mfma_f32_32x32x16_bf16 v[112:127], v[68:71], v[48:51], v[112:127]
    v_mfma_f32_32x32x16_bf16 v[128:143], v[68:71], v[52:55], v[128:143]
    s_add_u32 s55, s40, 40960
    buffer_load_dwordx4 v[48:51], v1, s[12:15], s55 offen sc1
    buffer_load_dwordx4 v[52:55], v2, s[12:15], s55 offen sc1
    ds_read_b64_tr_b16 v[64:65], v4 offset:0
    ds_read_b64_tr_b16 v[66:67], v4 offset:1024
    ds_read_b64_tr_b16 v[68:69], v5 offset:0
    ds_read_b64_tr_b16 v[70:71], v5 offset:1024
    s_waitcnt vmcnt(21) lgkmcnt(6)
    v_mfma_f32_32x32x16_bf16 v[80:95], v[72:75], v[56:59], v[80:95]
    s_waitcnt vmcnt(20)
    v_mfma_f32_32x32x16_bf16 v[96:111], v[72:75], v[60:63], v[96:111]
    s_waitcnt lgkmcnt(4)
    v_mfma_f32_32x32x16_bf16 v[112:127], v[76:79], v[56:59], v[112:127]
    v_mfma_f32_32x32x16_bf16 v[128:143], v[76:79], v[60:63], v[128:143]
    s_add_u32 s55, s40, 41984
    buffer_load_dwordx4 v[56:59], v1, s[12:15], s55 offen sc1
    buffer_load_dwordx4 v[60:63], v2, s[12:15], s55 offen sc1
    ds_read_b64_tr_b16 v[72:73], v4 offset:2048
    ds_read_b64_tr_b16 v[74:75], v4 offset:3072
    ds_read_b64_tr_b16 v[76:77], v5 offset:2048
    ds_read_b64_tr_b16 v[78:79], v5 offset:3072
    s_waitcnt vmcnt(19) lgkmcnt(6)
    v_mfma_f32_32x32x16_bf16 v[80:95], v[64:67], v[16:19], v[80:95]
    s_waitcnt vmcnt(18)
    v_mfma_f32_32x32x16_bf16 v[96:111], v[64:67], v[20:23], v[96:111]
    s_waitcnt lgkmcnt(4)
    v_mfma_f32_32x32x16_bf16 v[112:127], v[68:71], v[16:19], v[112:127]
    v_mfma_f32_32x32x16_bf16 v[128:143], v[68:71], v[20:23], v[128:143]
    s_add_u32 s55, s40, 43008
    buffer_load_dwordx4 v[16:19], v1, s[12:15], s55 offen sc1
    buffer_load_dwordx4 v[20:23], v2, s[12:15], s55 offen sc1
    ds_read_b64_tr_b16 v[64:65], v4 offset:4096
    ds_read_b64_tr_b16 v[66:67], v4 offset:5120
    ds_read_b64_tr_b16 v[68:69], v5 offset:4096
    ds_read_b64_tr_b16 v[70:71], v5 offset:5120
    s_waitcnt vmcnt(17) lgkmcnt(6)
    v_mfma_f32_32x32x16_bf16 v[80:95], v[72:75], v[24:27], v[80:95]
    s_waitcnt vmcnt(16)
    v_mfma_f32_32x32x16_bf16 v[96:111], v[72:75], v[28:31], v[96:111]
    s_waitcnt lgkmcnt(4)
    v_mfma_f32_32x32x16_bf16 v[112:127], v[76:79], v[24:27], v[112:127]
    v_mfma_f32_32x32x16_bf16 v[128:143], v[76:79], v[28:31], v[128:143]
    ds_read_b64_tr_b16 v[72:73], v4 offset:6144
    ds_read_b64_tr_b16 v[74:75], v4 offset:7168
    ds_read_b64_tr_b16 v[76:77], v5 offset:6144
    ds_read_b64_tr_b16 v[78:79], v5 offset:7168
    s_waitcnt vmcnt(13) lgkmcnt(6)
    v_mfma_f32_32x32x16_bf16 v[80:95], v[64:67], v[32:35], v[80:95]
    s_waitcnt vmcnt(12)
    v_mfma_f32_32x32x16_bf16 v[96:111], v[64:67], v[36:39], v[96:111]
    s_waitcnt lgkmcnt(4)
    v_mfma_f32_32x32x16_bf16 v[112:127], v[68:71], v[32:35], v[112:127]
    v_mfma_f32_32x32x16_bf16 v[128:143], v[68:71], v[36:39], v[128:143]
    ds_read_b64_tr_b16 v[64:65], v4 offset:8192
    ds_read_b64_tr_b16 v[66:67], v4 offset:9216
    ds_read_b64_tr_b16 v[68:69], v5 offset:8192
    ds_read_b64_tr_b16 v[70:71], v5 offset:9216
    s_waitcnt vmcnt(9) lgkmcnt(6)
    v_mfma_f32_32x32x16_bf16 v[80:95], v[72:75], v[40:43], v[80:95]
    s_waitcnt vmcnt(8)
    v_mfma_f32_32x32x16_bf16 v[96:111], v[72:75], v[44:47], v[96:111]
    s_waitcnt lgkmcnt(4)
    v_mfma_f32_32x32x16_bf16 v[112:127], v[76:79], v[40:43], v[112:127]
    v_mfma_f32_32x32x16_bf16 v[128:143], v[76:79], v[44:47], v[128:143]
    ds_read_b64_tr_b16 v[72:73], v4 offset:10240
    ds_read_b64_tr_b16 v[74:75], v4 offset:11264
    ds_read_b64_tr_b16 v[76:77], v5 offset:10240
    ds_read_b64_tr_b16 v[78:79], v5 offset:11264
    s_waitcnt vmcnt(5) lgkmcnt(6)
    v_mfma_f32_32x32x16_bf16 v[80:95], v[64:67], v[48:51], v[80:95]
    s_waitcnt vmcnt(4)
    v_mfma_f32_32x32x16_bf16 v[96:111], v[64:67], v[52:55], v[96:111]
    s_waitcnt lgkmcnt(4)
    v_mfma_f32_32x32x16_bf16 v[112:127], v[68:71], v[48:51], v[112:127]
    v_mfma_f32_32x32x16_bf16 v[128:143], v[68:71], v[52:55], v[128:143]
    ds_read_b64_tr_b16 v[64:65], v4 offset:12288
    ds_read_b64_tr_b16 v[66:67], v4 offset:13312
    ds_read_b64_tr_b16 v[68:69], v5 offset:12288
    ds_read_b64_tr_b16 v[70:71], v5 offset:13312
    s_waitcnt vmcnt(3) lgkmcnt(6)
    v_mfma_f32_32x32x16_bf16 v[80:95], v[72:75], v[56:59], v[80:95]
    s_waitcnt vmcnt(2)
    v_mfma_f32_32x32x16_bf16 v[96:111], v[72:75], v[60:63], v[96:111]
    s_waitcnt lgkmcnt(4)
    v_mfma_f32_32x32x16_bf16 v[112:127], v[76:79], v[56:59], v[112:127]
    v_mfma_f32_32x32x16_bf16 v[128:143], v[76:79], v[60:63], v[128:143]
    s_waitcnt vmcnt(1) lgkmcnt(2)
    v_mfma_f32_32x32x16_bf16 v[80:95], v[64:67], v[16:19], v[80:95]
    s_waitcnt vmcnt(0)
    v_mfma_f32_32x32x16_bf16 v[96:111], v[64:67], v[20:23], v[96:111]
    s_waitcnt lgkmcnt(0)
    v_mfma_f32_32x32x16_bf16 v[112:127], v[68:71], v[16:19], v[112:127]
    v_mfma_f32_32x32x16_bf16 v[128:143], v[68:71], v[20:23], v[128:143]
    s_waitcnt vmcnt(0)
    s_waitcnt lgkmcnt(0)
    s_barrier
    s_lshl_b32 s25, s20, 14
    v_add_u32 v6, s25, v1
    s_nop 1
    ds_write_b128 v6, v[80:83] offset:0
    ds_write_b128 v6, v[84:87] offset:1024
    ds_write_b128 v6, v[88:91] offset:2048
    ds_write_b128 v6, v[92:95] offset:3072
    ds_write_b128 v6, v[96:99] offset:4096
    ds_write_b128 v6, v[100:103] offset:5120
    ds_write_b128 v6, v[104:107] offset:6144
    ds_write_b128 v6, v[108:111] offset:7168
    ds_write_b128 v6, v[112:115] offset:8192
    ds_write_b128 v6, v[116:119] offset:9216
    ds_write_b128 v6, v[120:123] offset:10240
    ds_write_b128 v6, v[124:127] offset:11264
    ds_write_b128 v6, v[128:131] offset:12288
    ds_write_b128 v6, v[132:135] offset:13312
    ds_write_b128 v6, v[136:139] offset:14336
    ds_write_b128 v6, v[140:143] offset:15360
    s_lshl_b32 s56, s20, 11
    v_add_u32 v7, s56, v1
    v_add_u32 v8, 0x10000, v7
    s_waitcnt lgkmcnt(0)
    s_barrier
    ds_read_b128 v[16:19], v7 offset:0
    ds_read_b128 v[20:23], v7 offset:1024
    ds_read_b128 v[24:27], v7 offset:16384
    ds_read_b128 v[28:31], v7 offset:17408
    ds_read_b128 v[32:35], v7 offset:32768
    ds_read_b128 v[36:39], v7 offset:33792
    ds_read_b128 v[40:43], v7 offset:49152
    ds_read_b128 v[44:47], v7 offset:50176
    ds_read_b128 v[48:51], v8 offset:0
    ds_read_b128 v[52:55], v8 offset:1024
    ds_read_b128 v[56:59], v8 offset:16384
    ds_read_b128 v[60:63], v8 offset:17408
    ds_read_b128 v[64:67], v8 offset:32768
    ds_read_b128 v[68:71], v8 offset:33792
    ds_read_b128 v[72:75], v8 offset:49152
    ds_read_b128 v[76:79], v8 offset:50176
    s_waitcnt lgkmcnt(13)
    v_add_f32 v16, v16, v24
    s_waitcnt lgkmcnt(9)
    v_add_f32 v32, v32, v40
    s_waitcnt lgkmcnt(5)
    v_add_f32 v48, v48, v56
    s_waitcnt lgkmcnt(1)
    v_add_f32 v64, v64, v72
    v_add_f32 v17, v17, v25
    v_add_f32 v33, v33, v41
    v_add_f32 v49, v49, v57
    v_add_f32 v65, v65, v73
    v_add_f32 v18, v18, v26
    v_add_f32 v34, v34, v42
    v_add_f32 v50, v50, v58
    v_add_f32 v66, v66, v74
    v_add_f32 v19, v19, v27
    v_add_f32 v35, v35, v43
    v_add_f32 v51, v51, v59
    v_add_f32 v67, v67, v75
    v_add_f32 v20, v20, v28
    v_add_f32 v36, v36, v44
    v_add_f32 v52, v52, v60
    s_waitcnt lgkmcnt(0)
    v_add_f32 v68, v68, v76
    v_add_f32 v21, v21, v29
    v_add_f32 v37, v37, v45
    v_add_f32 v53, v53, v61
    v_add_f32 v69, v69, v77
    v_add_f32 v22, v22, v30
    v_add_f32 v38, v38, v46
    v_add_f32 v54, v54, v62
    v_add_f32 v70, v70, v78
    v_add_f32 v23, v23, v31
    v_add_f32 v39, v39, v47
    v_add_f32 v55, v55, v63
    v_add_f32 v71, v71, v79
    v_add_f32 v16, v16, v32
    v_add_f32 v16, v16, v48
    v_add_f32 v17, v17, v33
    v_add_f32 v17, v17, v49
    v_add_f32 v18, v18, v34
    v_add_f32 v18, v18, v50
    v_add_f32 v19, v19, v35
    v_add_f32 v19, v19, v51
    v_add_f32 v20, v20, v36
    v_add_f32 v20, v20, v52
    v_add_f32 v21, v21, v37
    v_add_f32 v21, v21, v53
    v_add_f32 v22, v22, v38
    v_add_f32 v22, v22, v54
    v_add_f32 v23, v23, v39
    v_add_f32 v23, v23, v55
    v_cvt_pk_bf16_f32 v24, v16, v17
    v_cvt_pk_bf16_f32 v72, v64, v65
    v_cvt_pk_bf16_f32 v25, v18, v19
    v_cvt_pk_bf16_f32 v73, v66, v67
    v_cvt_pk_bf16_f32 v26, v20, v21
    v_cvt_pk_bf16_f32 v74, v68, v69
    v_cvt_pk_bf16_f32 v27, v22, v23
    v_cvt_pk_bf16_f32 v75, v70, v71
    v_lshlrev_b32 v16, 16, v24
    v_and_b32 v17, 0xffff0000, v24
    v_lshlrev_b32 v64, 16, v72
    v_and_b32 v65, 0xffff0000, v72
    v_lshlrev_b32 v18, 16, v25
    v_and_b32 v19, 0xffff0000, v25
    v_lshlrev_b32 v66, 16, v73
    v_and_b32 v67, 0xffff0000, v73
    v_lshlrev_b32 v20, 16, v26
    v_and_b32 v21, 0xffff0000, v26
    v_lshlrev_b32 v68, 16, v74
    v_and_b32 v69, 0xffff0000, v74
    v_lshlrev_b32 v22, 16, v27
    v_and_b32 v23, 0xffff0000, v27
    v_lshlrev_b32 v70, 16, v75
    v_and_b32 v71, 0xffff0000, v75
    v_mul_f32 v32, 0xbfb8aa3b, v64
    v_mul_f32 v33, 0xbfb8aa3b, v65
    v_mul_f32 v34, 0xbfb8aa3b, v66
    v_mul_f32 v35, 0xbfb8aa3b, v67
    v_mul_f32 v36, 0xbfb8aa3b, v68
    v_mul_f32 v37, 0xbfb8aa3b, v69
    v_mul_f32 v38, 0xbfb8aa3b, v70
    v_mul_f32 v39, 0xbfb8aa3b, v71
    v_exp_f32 v32, v32
    v_exp_f32 v33, v33
    v_exp_f32 v34, v34
    v_exp_f32 v35, v35
    v_exp_f32 v36, v36
    v_exp_f32 v37, v37
    v_exp_f32 v38, v38
    v_exp_f32 v39, v39
    v_add_f32 v32, 1.0, v32
    v_add_f32 v33, 1.0, v33
    v_add_f32 v34, 1.0, v34
    v_add_f32 v35, 1.0, v35
    v_add_f32 v36, 1.0, v36
    v_add_f32 v37, 1.0, v37
    v_add_f32 v38, 1.0, v38
    v_add_f32 v39, 1.0, v39
    v_rcp_f32 v32, v32
    v_rcp_f32 v33, v33
    v_rcp_f32 v34, v34
    v_rcp_f32 v35, v35
    v_rcp_f32 v36, v36
    v_rcp_f32 v37, v37
    v_rcp_f32 v38, v38
    v_rcp_f32 v39, v39
    v_mul_f32 v32, v32, v64
    v_mul_f32 v33, v33, v65
    v_mul_f32 v34, v34, v66
    v_mul_f32 v35, v35, v67
    v_mul_f32 v36, v36, v68
    v_mul_f32 v37, v37, v69
    v_mul_f32 v38, v38, v70
    v_mul_f32 v39, v39, v71
    v_cvt_pk_bf16_f32 v40, v32, v33
    v_cvt_pk_bf16_f32 v41, v34, v35
    v_cvt_pk_bf16_f32 v42, v36, v37
    v_cvt_pk_bf16_f32 v43, v38, v39
    v_lshlrev_b32 v32, 16, v40
    v_and_b32 v33, 0xffff0000, v40
    v_lshlrev_b32 v34, 16, v41
    v_and_b32 v35, 0xffff0000, v41
    v_lshlrev_b32 v36, 16, v42
    v_and_b32 v37, 0xffff0000, v42
    v_lshlrev_b32 v38, 16, v43
    v_and_b32 v39, 0xffff0000, v43
    v_mul_f32 v32, v32, v16
    v_mul_f32 v33, v33, v17
    v_mul_f32 v34, v34, v18
    v_mul_f32 v35, v35, v19
    v_mul_f32 v36, v36, v20
    v_mul_f32 v37, v37, v21
    v_mul_f32 v38, v38, v22
    v_mul_f32 v39, v39, v23
    v_cvt_pk_bf16_f32 v40, v32, v33
    v_cvt_pk_bf16_f32 v41, v34, v35
    v_cvt_pk_bf16_f32 v42, v36, v37
    v_cvt_pk_bf16_f32 v43, v38, v39
    v_lshlrev_b32 v32, 16, v40
    v_and_b32 v33, 0xffff0000, v40
    v_lshlrev_b32 v48, 16, v240
    v_and_b32 v49, 0xffff0000, v240
    v_lshlrev_b32 v34, 16, v41
    v_and_b32 v35, 0xffff0000, v41
    v_lshlrev_b32 v50, 16, v241
    v_and_b32 v51, 0xffff0000, v241
    v_lshlrev_b32 v36, 16, v42
    v_and_b32 v37, 0xffff0000, v42
    v_lshlrev_b32 v52, 16, v242
    v_and_b32 v53, 0xffff0000, v242
    v_lshlrev_b32 v38, 16, v43
    v_and_b32 v39, 0xffff0000, v43
    v_lshlrev_b32 v54, 16, v243
    v_and_b32 v55, 0xffff0000, v243
    v_add_f32 v32, v32, v48
    v_add_f32 v33, v33, v49
    v_add_f32 v34, v34, v50
    v_add_f32 v35, v35, v51
    v_add_f32 v36, v36, v52
    v_add_f32 v37, v37, v53
    v_add_f32 v38, v38, v54
    v_add_f32 v39, v39, v55
    v_cvt_pk_bf16_f32 v40, v32, v33
    v_cvt_pk_bf16_f32 v41, v34, v35
    v_cvt_pk_bf16_f32 v42, v36, v37
    v_cvt_pk_bf16_f32 v43, v38, v39
    buffer_store_dwordx2 v[40:41], v9, s[36:39], s59 offen
    buffer_store_dwordx2 v[42:43], v9, s[36:39], s59 offen offset:16
    s_endpgm
LF_rarefirst1:
    s_nop 15
    s_nop 7
    v_max3_f32 v9, v112, v113, v114
    v_max3_f32 v9, v9, v115, v116
    v_max3_f32 v9, v9, v117, v118
    v_max3_f32 v9, v9, v119, v120
    v_max3_f32 v9, v9, v121, v122
    v_max3_f32 v9, v9, v123, v124
    v_max3_f32 v9, v9, v125, v126
    v_max_f32 v9, v9, v127
    v_mov_b32 v10, v9
    s_nop 1
    v_permlane32_swap_b32 v9, v10
    v_max_f32 v9, v9, v10
    v_max_f32 v9, s58, v9
    v_sub_f32 v10, 0, v9
    v_min_f32 v10, 0x42fc0000, v10
    v_exp_f32 v10, v10
    v_mul_f32 v11, s60, v9
    v_sub_f32 v112, v112, v9
    v_sub_f32 v113, v113, v9
    v_sub_f32 v114, v114, v9
    v_sub_f32 v115, v115, v9
    v_sub_f32 v116, v116, v9
    v_sub_f32 v117, v117, v9
    v_sub_f32 v118, v118, v9
    v_sub_f32 v119, v119, v9
    v_sub_f32 v120, v120, v9
    v_sub_f32 v121, v121, v9
    v_sub_f32 v122, v122, v9
    v_sub_f32 v123, v123, v9
    v_sub_f32 v124, v124, v9
    v_sub_f32 v125, v125, v9
    v_sub_f32 v126, v126, v9
    v_sub_f32 v127, v127, v9
    v_exp_f32 v216, v112
    v_exp_f32 v217, v113
    v_exp_f32 v218, v114
    v_exp_f32 v219, v115
    v_exp_f32 v220, v116
    v_exp_f32 v221, v117
    v_exp_f32 v222, v118
    v_exp_f32 v223, v119
    v_exp_f32 v224, v120
    v_exp_f32 v225, v121
    v_exp_f32 v226, v122
    v_exp_f32 v227, v123
    v_exp_f32 v228, v124
    v_exp_f32 v229, v125
    v_exp_f32 v230, v126
    v_exp_f32 v231, v127
    v_add_f32 v7, v216, v217
    v_add_f32 v7, v7, v218
    v_add_f32 v7, v7, v219
    v_add_f32 v7, v7, v220
    v_add_f32 v7, v7, v221
    v_add_f32 v7, v7, v222
    v_add_f32 v7, v7, v223
    v_add_f32 v7, v7, v224
    v_add_f32 v7, v7, v225
    v_add_f32 v7, v7, v226
    v_add_f32 v7, v7, v227
    v_add_f32 v7, v7, v228
    v_add_f32 v7, v7, v229
    v_add_f32 v7, v7, v230
    v_add_f32 v7, v7, v231
    v_cvt_pk_bf16_f32 v144, v216, v217
    v_cvt_pk_bf16_f32 v145, v218, v219
    v_cvt_pk_bf16_f32 v146, v220, v221
    v_cvt_pk_bf16_f32 v147, v222, v223
    v_cvt_pk_bf16_f32 v148, v224, v225
    v_cvt_pk_bf16_f32 v149, v226, v227
    v_cvt_pk_bf16_f32 v150, v228, v229
    v_cvt_pk_bf16_f32 v151, v230, v231
    v_sub_f32 v128, v128, v11
    v_sub_f32 v129, v129, v11
    v_sub_f32 v130, v130, v11
    v_sub_f32 v131, v131, v11
    v_sub_f32 v132, v132, v11
    v_sub_f32 v133, v133, v11
    v_sub_f32 v134, v134, v11
    v_sub_f32 v135, v135, v11
    v_sub_f32 v136, v136, v11
    v_sub_f32 v137, v137, v11
    v_sub_f32 v138, v138, v11
    v_sub_f32 v139, v139, v11
    v_sub_f32 v140, v140, v11
    v_sub_f32 v141, v141, v11
    v_sub_f32 v142, v142, v11
    v_sub_f32 v143, v143, v11
    v_sub_f32 v160, v160, v11
    v_sub_f32 v161, v161, v11
    v_sub_f32 v162, v162, v11
    v_sub_f32 v163, v163, v11
    v_sub_f32 v164, v164, v11
    v_sub_f32 v165, v165, v11
    v_sub_f32 v166, v166, v11
    v_sub_f32 v167, v167, v11
    v_sub_f32 v168, v168, v11
    v_sub_f32 v169, v169, v11
    v_sub_f32 v170, v170, v11
    v_sub_f32 v171, v171, v11
    v_sub_f32 v172, v172, v11
    v_sub_f32 v173, v173, v11
    v_sub_f32 v174, v174, v11
    v_sub_f32 v175, v175, v11
    v_add_f32 v6, v6, v11
    v_mul_f32 v5, v5, v10
    s_cmp_lg_u32 s59, 0
    s_cbranch_scc1 LF_rskipfirst1
    v_mul_f32 v48, v48, v10
    v_mul_f32 v49, v49, v10
    v_mul_f32 v50, v50, v10
    v_mul_f32 v51, v51, v10
    v_mul_f32 v52, v52, v10
    v_mul_f32 v53, v53, v10
    v_mul_f32 v54, v54, v10
    v_mul_f32 v55, v55, v10
    v_mul_f32 v56, v56, v10
    v_mul_f32 v57, v57, v10
    v_mul_f32 v58, v58, v10
    v_mul_f32 v59, v59, v10
    v_mul_f32 v60, v60, v10
    v_mul_f32 v61, v61, v10
    v_mul_f32 v62, v62, v10
    v_mul_f32 v63, v63, v10
    v_mul_f32 v64, v64, v10
    v_mul_f32 v65, v65, v10
    v_mul_f32 v66, v66, v10
    v_mul_f32 v67, v67, v10
    v_mul_f32 v68, v68, v10
    v_mul_f32 v69, v69, v10
    v_mul_f32 v70, v70, v10
    v_mul_f32 v71, v71, v10
    v_mul_f32 v72, v72, v10
    v_mul_f32 v73, v73, v10
    v_mul_f32 v74, v74, v10
    v_mul_f32 v75, v75, v10
    v_mul_f32 v76, v76, v10
    v_mul_f32 v77, v77, v10
    v_mul_f32 v78, v78, v10
    v_mul_f32 v79, v79, v10
    v_mul_f32 v80, v80, v10
    v_mul_f32 v81, v81, v10
    v_mul_f32 v82, v82, v10
    v_mul_f32 v83, v83, v10
    v_mul_f32 v84, v84, v10
    v_mul_f32 v85, v85, v10
    v_mul_f32 v86, v86, v10
    v_mul_f32 v87, v87, v10
    v_mul_f32 v88, v88, v10
    v_mul_f32 v89, v89, v10
    v_mul_f32 v90, v90, v10
    v_mul_f32 v91, v91, v10
    v_mul_f32 v92, v92, v10
    v_mul_f32 v93, v93, v10
    v_mul_f32 v94, v94, v10
    v_mul_f32 v95, v95, v10
    v_mul_f32 v96, v96, v10
    v_mul_f32 v97, v97, v10
    v_mul_f32 v98, v98, v10
    v_mul_f32 v99, v99, v10
    v_mul_f32 v100, v100, v10
    v_mul_f32 v101, v101, v10
    v_mul_f32 v102, v102, v10
    v_mul_f32 v103, v103, v10
    v_mul_f32 v104, v104, v10
    v_mul_f32 v105, v105, v10
    v_mul_f32 v106, v106, v10
    v_mul_f32 v107, v107, v10
    v_mul_f32 v108, v108, v10
    v_mul_f32 v109, v109, v10
    v_mul_f32 v110, v110, v10
    v_mul_f32 v111, v111, v10
LF_rskipfirst1:
    s_mov_b32 s57, 0x49800000
    s_mov_b32 s58, 0
    s_mov_b32 s59, 0
    s_branch LF_retfirst1
LF_evtfirst0:
    s_lshl_b32 s68, s47, 1
    s_lshr_b32 s68, s62, 1
    s_lshl_b32 s69, s68, 1
    s_sub_u32 s69, s69, s47
    s_add_u32 s69, s69, s25
    s_cmp_ge_u32 s68, s47
    s_cselect_b32 s68, s69, s68
    s_lshl_b32 s68, s68, 1
    s_add_u32 s68, s68, 0
    s_cmp_lt_u32 s68, s61
    s_cbranch_scc1 LF_nomaskfirst0
    s_sub_u32 s68, s61, s68
    s_lshl_b32 s68, s68, 5
    v_add_u32 v9, s68, v4
    v_mov_b32 v10, 0xf149f2ca
    v_cmp_gt_i32 vcc, 0, v9
    s_nop 1
    v_cndmask_b32 v160, v160, v10, vcc
    v_cmp_gt_i32 vcc, 1, v9
    s_nop 1
    v_cndmask_b32 v161, v161, v10, vcc
    v_cmp_gt_i32 vcc, 2, v9
    s_nop 1
    v_cndmask_b32 v162, v162, v10, vcc
    v_cmp_gt_i32 vcc, 3, v9
    s_nop 1
    v_cndmask_b32 v163, v163, v10, vcc
    v_cmp_gt_i32 vcc, 8, v9
    s_nop 1
    v_cndmask_b32 v164, v164, v10, vcc
    v_cmp_gt_i32 vcc, 9, v9
    s_nop 1
    v_cndmask_b32 v165, v165, v10, vcc
    v_cmp_gt_i32 vcc, 10, v9
    s_nop 1
    v_cndmask_b32 v166, v166, v10, vcc
    v_cmp_gt_i32 vcc, 11, v9
    s_nop 1
    v_cndmask_b32 v167, v167, v10, vcc
    v_cmp_gt_i32 vcc, 16, v9
    s_nop 1
    v_cndmask_b32 v168, v168, v10, vcc
    v_cmp_gt_i32 vcc, 17, v9
    s_nop 1
    v_cndmask_b32 v169, v169, v10, vcc
    v_cmp_gt_i32 vcc, 18, v9
    s_nop 1
    v_cndmask_b32 v170, v170, v10, vcc
    v_cmp_gt_i32 vcc, 19, v9
    s_nop 1
    v_cndmask_b32 v171, v171, v10, vcc
    v_cmp_gt_i32 vcc, 24, v9
    s_nop 1
    v_cndmask_b32 v172, v172, v10, vcc
    v_cmp_gt_i32 vcc, 25, v9
    s_nop 1
    v_cndmask_b32 v173, v173, v10, vcc
    v_cmp_gt_i32 vcc, 26, v9
    s_nop 1
    v_cndmask_b32 v174, v174, v10, vcc
    v_cmp_gt_i32 vcc, 27, v9
    s_nop 1
    v_cndmask_b32 v175, v175, v10, vcc
LF_nomaskfirst0:
    s_add_u32 s68, s62, 1
    s_max_u32 s66, s68, 32
    s_cmp_le_u32 s68, s49
    s_cselect_b32 s66, s68, s66
    s_branch LF_eretfirst0
LF_evtfirst1:
    s_lshl_b32 s68, s47, 1
    s_lshr_b32 s68, s62, 1
    s_lshl_b32 s69, s68, 1
    s_sub_u32 s69, s69, s47
    s_add_u32 s69, s69, s25
    s_cmp_ge_u32 s68, s47
    s_cselect_b32 s68, s69, s68
    s_lshl_b32 s68, s68, 1
    s_add_u32 s68, s68, 1
    s_cmp_lt_u32 s68, s61
    s_cbranch_scc1 LF_nomaskfirst1
    s_sub_u32 s68, s61, s68
    s_lshl_b32 s68, s68, 5
    v_add_u32 v9, s68, v4
    v_mov_b32 v10, 0xf149f2ca
    v_cmp_gt_i32 vcc, 0, v9
    s_nop 1
    v_cndmask_b32 v160, v160, v10, vcc
    v_cmp_gt_i32 vcc, 1, v9
    s_nop 1
    v_cndmask_b32 v161, v161, v10, vcc
    v_cmp_gt_i32 vcc, 2, v9
    s_nop 1
    v_cndmask_b32 v162, v162, v10, vcc
    v_cmp_gt_i32 vcc, 3, v9
    s_nop 1
    v_cndmask_b32 v163, v163, v10, vcc
    v_cmp_gt_i32 vcc, 8, v9
    s_nop 1
    v_cndmask_b32 v164, v164, v10, vcc
    v_cmp_gt_i32 vcc, 9, v9
    s_nop 1
    v_cndmask_b32 v165, v165, v10, vcc
    v_cmp_gt_i32 vcc, 10, v9
    s_nop 1
    v_cndmask_b32 v166, v166, v10, vcc
    v_cmp_gt_i32 vcc, 11, v9
    s_nop 1
    v_cndmask_b32 v167, v167, v10, vcc
    v_cmp_gt_i32 vcc, 16, v9
    s_nop 1
    v_cndmask_b32 v168, v168, v10, vcc
    v_cmp_gt_i32 vcc, 17, v9
    s_nop 1
    v_cndmask_b32 v169, v169, v10, vcc
    v_cmp_gt_i32 vcc, 18, v9
    s_nop 1
    v_cndmask_b32 v170, v170, v10, vcc
    v_cmp_gt_i32 vcc, 19, v9
    s_nop 1
    v_cndmask_b32 v171, v171, v10, vcc
    v_cmp_gt_i32 vcc, 24, v9
    s_nop 1
    v_cndmask_b32 v172, v172, v10, vcc
    v_cmp_gt_i32 vcc, 25, v9
    s_nop 1
    v_cndmask_b32 v173, v173, v10, vcc
    v_cmp_gt_i32 vcc, 26, v9
    s_nop 1
    v_cndmask_b32 v174, v174, v10, vcc
    v_cmp_gt_i32 vcc, 27, v9
    s_nop 1
    v_cndmask_b32 v175, v175, v10, vcc
LF_nomaskfirst1:
    s_add_u32 s68, s62, 1
    s_max_u32 s66, s68, 32
    s_cmp_le_u32 s68, s49
    s_cselect_b32 s66, s68, s66
    s_branch LF_eretfirst1
LF_rareloop0:
    s_nop 15
    s_nop 7
    v_max3_f32 v9, v128, v129, v130
    v_max3_f32 v9, v9, v131, v132
    v_max3_f32 v9, v9, v133, v134
    v_max3_f32 v9, v9, v135, v136
    v_max3_f32 v9, v9, v137, v138
    v_max3_f32 v9, v9, v139, v140
    v_max3_f32 v9, v9, v141, v142
    v_max_f32 v9, v9, v143
    v_mov_b32 v10, v9
    s_nop 1
    v_permlane32_swap_b32 v9, v10
    v_max_f32 v9, v9, v10
    v_max_f32 v9, s58, v9
    v_sub_f32 v10, 0, v9
    v_min_f32 v10, 0x42fc0000, v10
    v_exp_f32 v10, v10
    v_mul_f32 v11, s60, v9
    v_sub_f32 v128, v128, v9
    v_sub_f32 v129, v129, v9
    v_sub_f32 v130, v130, v9
    v_sub_f32 v131, v131, v9
    v_sub_f32 v132, v132, v9
    v_sub_f32 v133, v133, v9
    v_sub_f32 v134, v134, v9
    v_sub_f32 v135, v135, v9
    v_sub_f32 v136, v136, v9
    v_sub_f32 v137, v137, v9
    v_sub_f32 v138, v138, v9
    v_sub_f32 v139, v139, v9
    v_sub_f32 v140, v140, v9
    v_sub_f32 v141, v141, v9
    v_sub_f32 v142, v142, v9
    v_sub_f32 v143, v143, v9
    v_exp_f32 v216, v128
    v_exp_f32 v217, v129
    v_exp_f32 v218, v130
    v_exp_f32 v219, v131
    v_exp_f32 v220, v132
    v_exp_f32 v221, v133
    v_exp_f32 v222, v134
    v_exp_f32 v223, v135
    v_exp_f32 v224, v136
    v_exp_f32 v225, v137
    v_exp_f32 v226, v138
    v_exp_f32 v227, v139
    v_exp_f32 v228, v140
    v_exp_f32 v229, v141
    v_exp_f32 v230, v142
    v_exp_f32 v231, v143
    v_add_f32 v7, v216, v217
    v_add_f32 v7, v7, v218
    v_add_f32 v7, v7, v219
    v_add_f32 v7, v7, v220
    v_add_f32 v7, v7, v221
    v_add_f32 v7, v7, v222
    v_add_f32 v7, v7, v223
    v_add_f32 v7, v7, v224
    v_add_f32 v7, v7, v225
    v_add_f32 v7, v7, v226
    v_add_f32 v7, v7, v227
    v_add_f32 v7, v7, v228
    v_add_f32 v7, v7, v229
    v_add_f32 v7, v7, v230
    v_add_f32 v7, v7, v231
    v_cvt_pk_bf16_f32 v152, v216, v217
    v_cvt_pk_bf16_f32 v153, v218, v219
    v_cvt_pk_bf16_f32 v154, v220, v221
    v_cvt_pk_bf16_f32 v155, v222, v223
    v_cvt_pk_bf16_f32 v156, v224, v225
    v_cvt_pk_bf16_f32 v157, v226, v227
    v_cvt_pk_bf16_f32 v158, v228, v229
    v_cvt_pk_bf16_f32 v159, v230, v231
    v_sub_f32 v112, v112, v11
    v_sub_f32 v113, v113, v11
    v_sub_f32 v114, v114, v11
    v_sub_f32 v115, v115, v11
    v_sub_f32 v116, v116, v11
    v_sub_f32 v117, v117, v11
    v_sub_f32 v118, v118, v11
    v_sub_f32 v119, v119, v11
    v_sub_f32 v120, v120, v11
    v_sub_f32 v121, v121, v11
    v_sub_f32 v122, v122, v11
    v_sub_f32 v123, v123, v11
    v_sub_f32 v124, v124, v11
    v_sub_f32 v125, v125, v11
    v_sub_f32 v126, v126, v11
    v_sub_f32 v127, v127, v11
    v_sub_f32 v160, v160, v11
    v_sub_f32 v161, v161, v11
    v_sub_f32 v162, v162, v11
    v_sub_f32 v163, v163, v11
    v_sub_f32 v164, v164, v11
    v_sub_f32 v165, v165, v11
    v_sub_f32 v166, v166, v11
    v_sub_f32 v167, v167, v11
    v_sub_f32 v168, v168, v11
    v_sub_f32 v169, v169, v11
    v_sub_f32 v170, v170, v11
    v_sub_f32 v171, v171, v11
    v_sub_f32 v172, v172, v11
    v_sub_f32 v173, v173, v11
    v_sub_f32 v174, v174, v11
    v_sub_f32 v175, v175, v11
    v_add_f32 v6, v6, v11
    v_mul_f32 v5, v5, v10
    s_cmp_lg_u32 s59, 0
    s_cbranch_scc1 LF_rskiploop0
    v_mul_f32 v48, v48, v10
    v_mul_f32 v49, v49, v10
    v_mul_f32 v50, v50, v10
    v_mul_f32 v51, v51, v10
    v_mul_f32 v52, v52, v10
    v_mul_f32 v53, v53, v10
    v_mul_f32 v54, v54, v10
    v_mul_f32 v55, v55, v10
    v_mul_f32 v56, v56, v10
    v_mul_f32 v57, v57, v10
    v_mul_f32 v58, v58, v10
    v_mul_f32 v59, v59, v10
    v_mul_f32 v60, v60, v10
    v_mul_f32 v61, v61, v10
    v_mul_f32 v62, v62, v10
    v_mul_f32 v63, v63, v10
    v_mul_f32 v64, v64, v10
    v_mul_f32 v65, v65, v10
    v_mul_f32 v66, v66, v10
    v_mul_f32 v67, v67, v10
    v_mul_f32 v68, v68, v10
    v_mul_f32 v69, v69, v10
    v_mul_f32 v70, v70, v10
    v_mul_f32 v71, v71, v10
    v_mul_f32 v72, v72, v10
    v_mul_f32 v73, v73, v10
    v_mul_f32 v74, v74, v10
    v_mul_f32 v75, v75, v10
    v_mul_f32 v76, v76, v10
    v_mul_f32 v77, v77, v10
    v_mul_f32 v78, v78, v10
    v_mul_f32 v79, v79, v10
    v_mul_f32 v80, v80, v10
    v_mul_f32 v81, v81, v10
    v_mul_f32 v82, v82, v10
    v_mul_f32 v83, v83, v10
    v_mul_f32 v84, v84, v10
    v_mul_f32 v85, v85, v10
    v_mul_f32 v86, v86, v10
    v_mul_f32 v87, v87, v10
    v_mul_f32 v88, v88, v10
    v_mul_f32 v89, v89, v10
    v_mul_f32 v90, v90, v10
    v_mul_f32 v91, v91, v10
    v_mul_f32 v92, v92, v10
    v_mul_f32 v93, v93, v10
    v_mul_f32 v94, v94, v10
    v_mul_f32 v95, v95, v10
    v_mul_f32 v96, v96, v10
    v_mul_f32 v97, v97, v10
    v_mul_f32 v98, v98, v10
    v_mul_f32 v99, v99, v10
    v_mul_f32 v100, v100, v10
    v_mul_f32 v101, v101, v10
    v_mul_f32 v102, v102, v10
    v_mul_f32 v103, v103, v10
    v_mul_f32 v104, v104, v10
    v_mul_f32 v105, v105, v10
    v_mul_f32 v106, v106, v10
    v_mul_f32 v107, v107, v10
    v_mul_f32 v108, v108, v10
    v_mul_f32 v109, v109, v10
    v_mul_f32 v110, v110, v10
    v_mul_f32 v111, v111, v10
LF_rskiploop0:
    s_mov_b32 s56, 0x49800000
    s_branch LF_retloop0
LF_rareloop1:
    s_nop 15
    s_nop 7
    v_max3_f32 v9, v112, v113, v114
    v_max3_f32 v9, v9, v115, v116
    v_max3_f32 v9, v9, v117, v118
    v_max3_f32 v9, v9, v119, v120
    v_max3_f32 v9, v9, v121, v122
    v_max3_f32 v9, v9, v123, v124
    v_max3_f32 v9, v9, v125, v126
    v_max_f32 v9, v9, v127
    v_mov_b32 v10, v9
    s_nop 1
    v_permlane32_swap_b32 v9, v10
    v_max_f32 v9, v9, v10
    v_max_f32 v9, s58, v9
    v_sub_f32 v10, 0, v9
    v_min_f32 v10, 0x42fc0000, v10
    v_exp_f32 v10, v10
    v_mul_f32 v11, s60, v9
    v_sub_f32 v112, v112, v9
    v_sub_f32 v113, v113, v9
    v_sub_f32 v114, v114, v9
    v_sub_f32 v115, v115, v9
    v_sub_f32 v116, v116, v9
    v_sub_f32 v117, v117, v9
    v_sub_f32 v118, v118, v9
    v_sub_f32 v119, v119, v9
    v_sub_f32 v120, v120, v9
    v_sub_f32 v121, v121, v9
    v_sub_f32 v122, v122, v9
    v_sub_f32 v123, v123, v9
    v_sub_f32 v124, v124, v9
    v_sub_f32 v125, v125, v9
    v_sub_f32 v126, v126, v9
    v_sub_f32 v127, v127, v9
    v_exp_f32 v216, v112
    v_exp_f32 v217, v113
    v_exp_f32 v218, v114
    v_exp_f32 v219, v115
    v_exp_f32 v220, v116
    v_exp_f32 v221, v117
    v_exp_f32 v222, v118
    v_exp_f32 v223, v119
    v_exp_f32 v224, v120
    v_exp_f32 v225, v121
    v_exp_f32 v226, v122
    v_exp_f32 v227, v123
    v_exp_f32 v228, v124
    v_exp_f32 v229, v125
    v_exp_f32 v230, v126
    v_exp_f32 v231, v127
    v_add_f32 v7, v216, v217
    v_add_f32 v7, v7, v218
    v_add_f32 v7, v7, v219
    v_add_f32 v7, v7, v220
    v_add_f32 v7, v7, v221
    v_add_f32 v7, v7, v222
    v_add_f32 v7, v7, v223
    v_add_f32 v7, v7, v224
    v_add_f32 v7, v7, v225
    v_add_f32 v7, v7, v226
    v_add_f32 v7, v7, v227
    v_add_f32 v7, v7, v228
    v_add_f32 v7, v7, v229
    v_add_f32 v7, v7, v230
    v_add_f32 v7, v7, v231
    v_cvt_pk_bf16_f32 v144, v216, v217
    v_cvt_pk_bf16_f32 v145, v218, v219
    v_cvt_pk_bf16_f32 v146, v220, v221
    v_cvt_pk_bf16_f32 v147, v222, v223
    v_cvt_pk_bf16_f32 v148, v224, v225
    v_cvt_pk_bf16_f32 v149, v226, v227
    v_cvt_pk_bf16_f32 v150, v228, v229
    v_cvt_pk_bf16_f32 v151, v230, v231
    v_sub_f32 v128, v128, v11
    v_sub_f32 v129, v129, v11
    v_sub_f32 v130, v130, v11
    v_sub_f32 v131, v131, v11
    v_sub_f32 v132, v132, v11
    v_sub_f32 v133, v133, v11
    v_sub_f32 v134, v134, v11
    v_sub_f32 v135, v135, v11
    v_sub_f32 v136, v136, v11
    v_sub_f32 v137, v137, v11
    v_sub_f32 v138, v138, v11
    v_sub_f32 v139, v139, v11
    v_sub_f32 v140, v140, v11
    v_sub_f32 v141, v141, v11
    v_sub_f32 v142, v142, v11
    v_sub_f32 v143, v143, v11
    v_sub_f32 v160, v160, v11
    v_sub_f32 v161, v161, v11
    v_sub_f32 v162, v162, v11
    v_sub_f32 v163, v163, v11
    v_sub_f32 v164, v164, v11
    v_sub_f32 v165, v165, v11
    v_sub_f32 v166, v166, v11
    v_sub_f32 v167, v167, v11
    v_sub_f32 v168, v168, v11
    v_sub_f32 v169, v169, v11
    v_sub_f32 v170, v170, v11
    v_sub_f32 v171, v171, v11
    v_sub_f32 v172, v172, v11
    v_sub_f32 v173, v173, v11
    v_sub_f32 v174, v174, v11
    v_sub_f32 v175, v175, v11
    v_add_f32 v6, v6, v11
    v_mul_f32 v5, v5, v10
    s_cmp_lg_u32 s59, 0
    s_cbranch_scc1 LF_rskiploop1
    v_mul_f32 v48, v48, v10
    v_mul_f32 v49, v49, v10
    v_mul_f32 v50, v50, v10
    v_mul_f32 v51, v51, v10
    v_mul_f32 v52, v52, v10
    v_mul_f32 v53, v53, v10
    v_mul_f32 v54, v54, v10
    v_mul_f32 v55, v55, v10
    v_mul_f32 v56, v56, v10
    v_mul_f32 v57, v57, v10
    v_mul_f32 v58, v58, v10
    v_mul_f32 v59, v59, v10
    v_mul_f32 v60, v60, v10
    v_mul_f32 v61, v61, v10
    v_mul_f32 v62, v62, v10
    v_mul_f32 v63, v63, v10
    v_mul_f32 v64, v64, v10
    v_mul_f32 v65, v65, v10
    v_mul_f32 v66, v66, v10
    v_mul_f32 v67, v67, v10
    v_mul_f32 v68, v68, v10
    v_mul_f32 v69, v69, v10
    v_mul_f32 v70, v70, v10
    v_mul_f32 v71, v71, v10
    v_mul_f32 v72, v72, v10
    v_mul_f32 v73, v73, v10
    v_mul_f32 v74, v74, v10
    v_mul_f32 v75, v75, v10
    v_mul_f32 v76, v76, v10
    v_mul_f32 v77, v77, v10
    v_mul_f32 v78, v78, v10
    v_mul_f32 v79, v79, v10
    v_mul_f32 v80, v80, v10
    v_mul_f32 v81, v81, v10
    v_mul_f32 v82, v82, v10
    v_mul_f32 v83, v83, v10
    v_mul_f32 v84, v84, v10
    v_mul_f32 v85, v85, v10
    v_mul_f32 v86, v86, v10
    v_mul_f32 v87, v87, v10
    v_mul_f32 v88, v88, v10
    v_mul_f32 v89, v89, v10
    v_mul_f32 v90, v90, v10
    v_mul_f32 v91, v91, v10
    v_mul_f32 v92, v92, v10
    v_mul_f32 v93, v93, v10
    v_mul_f32 v94, v94, v10
    v_mul_f32 v95, v95, v10
    v_mul_f32 v96, v96, v10
    v_mul_f32 v97, v97, v10
    v_mul_f32 v98, v98, v10
    v_mul_f32 v99, v99, v10
    v_mul_f32 v100, v100, v10
    v_mul_f32 v101, v101, v10
    v_mul_f32 v102, v102, v10
    v_mul_f32 v103, v103, v10
    v_mul_f32 v104, v104, v10
    v_mul_f32 v105, v105, v10
    v_mul_f32 v106, v106, v10
    v_mul_f32 v107, v107, v10
    v_mul_f32 v108, v108, v10
    v_mul_f32 v109, v109, v10
    v_mul_f32 v110, v110, v10
    v_mul_f32 v111, v111, v10
LF_rskiploop1:
    s_mov_b32 s57, 0x49800000
    s_mov_b32 s58, 0
    s_mov_b32 s59, 0
    s_cmp_lt_u32 s55, 17
    s_branch LF_retloop1
LF_evtloop0:
    s_lshl_b32 s68, s47, 1
    s_add_u32 s69, s68, 2
    s_cmp_lg_u32 s62, s69
    s_cbranch_scc1 LF_nofinloop0
    s_cmp_eq_u32 s25, 0
    s_cbranch_scc1 LF_nofinloop0
    s_nop 15
    s_nop 7
    v_mov_b32 v9, v8
    s_nop 1
    v_permlane32_swap_b32 v8, v9
    v_add_f32 v9, v8, v9
    v_rcp_f32 v9, v9
    s_mul_i32 s52, s27, 350208
    s_lshl_b32 s54, s21, 13
    s_add_u32 s52, s52, s54
    s_add_u32 s52, s52, 0x2200000
    s_add_u32 s53, s52, 4096
    v_mul_f32 v48, v48, v9
    v_mul_f32 v49, v49, v9
    v_mul_f32 v50, v50, v9
    v_mul_f32 v51, v51, v9
    v_mul_f32 v52, v52, v9
    v_mul_f32 v53, v53, v9
    v_mul_f32 v54, v54, v9
    v_mul_f32 v55, v55, v9
    v_mul_f32 v56, v56, v9
    v_mul_f32 v57, v57, v9
    v_mul_f32 v58, v58, v9
    v_mul_f32 v59, v59, v9
    v_mul_f32 v60, v60, v9
    v_mul_f32 v61, v61, v9
    v_mul_f32 v62, v62, v9
    v_mul_f32 v63, v63, v9
    v_mul_f32 v64, v64, v9
    v_mul_f32 v65, v65, v9
    v_mul_f32 v66, v66, v9
    v_mul_f32 v67, v67, v9
    v_mul_f32 v68, v68, v9
    v_mul_f32 v69, v69, v9
    v_mul_f32 v70, v70, v9
    v_mul_f32 v71, v71, v9
    v_mul_f32 v72, v72, v9
    v_mul_f32 v73, v73, v9
    v_mul_f32 v74, v74, v9
    v_mul_f32 v75, v75, v9
    v_mul_f32 v76, v76, v9
    v_mul_f32 v77, v77, v9
    v_mul_f32 v78, v78, v9
    v_mul_f32 v79, v79, v9
    v_cvt_pk_bf16_f32 v216, v48, v49
    v_cvt_pk_bf16_f32 v217, v50, v51
    v_cvt_pk_bf16_f32 v218, v52, v53
    v_cvt_pk_bf16_f32 v219, v54, v55
    v_cvt_pk_bf16_f32 v220, v56, v57
    v_cvt_pk_bf16_f32 v221, v58, v59
    v_cvt_pk_bf16_f32 v222, v60, v61
    v_cvt_pk_bf16_f32 v223, v62, v63
    v_cvt_pk_bf16_f32 v224, v64, v65
    v_cvt_pk_bf16_f32 v225, v66, v67
    v_cvt_pk_bf16_f32 v226, v68, v69
    v_cvt_pk_bf16_f32 v227, v70, v71
    v_cvt_pk_bf16_f32 v228, v72, v73
    v_cvt_pk_bf16_f32 v229, v74, v75
    v_cvt_pk_bf16_f32 v230, v76, v77
    v_cvt_pk_bf16_f32 v231, v78, v79
    buffer_store_dwordx4 v[216:219], v1, s[8:11], s52 offen offset:0 sc1
    buffer_store_dwordx4 v[220:223], v1, s[8:11], s52 offen offset:1024 sc1
    buffer_store_dwordx4 v[224:227], v1, s[8:11], s52 offen offset:2048 sc1
    buffer_store_dwordx4 v[228:231], v1, s[8:11], s52 offen offset:3072 sc1
    v_mul_f32 v80, v80, v9
    v_mul_f32 v81, v81, v9
    v_mul_f32 v82, v82, v9
    v_mul_f32 v83, v83, v9
    v_mul_f32 v84, v84, v9
    v_mul_f32 v85, v85, v9
    v_mul_f32 v86, v86, v9
    v_mul_f32 v87, v87, v9
    v_mul_f32 v88, v88, v9
    v_mul_f32 v89, v89, v9
    v_mul_f32 v90, v90, v9
    v_mul_f32 v91, v91, v9
    v_mul_f32 v92, v92, v9
    v_mul_f32 v93, v93, v9
    v_mul_f32 v94, v94, v9
    v_mul_f32 v95, v95, v9
    v_mul_f32 v96, v96, v9
    v_mul_f32 v97, v97, v9
    v_mul_f32 v98, v98, v9
    v_mul_f32 v99, v99, v9
    v_mul_f32 v100, v100, v9
    v_mul_f32 v101, v101, v9
    v_mul_f32 v102, v102, v9
    v_mul_f32 v103, v103, v9
    v_mul_f32 v104, v104, v9
    v_mul_f32 v105, v105, v9
    v_mul_f32 v106, v106, v9
    v_mul_f32 v107, v107, v9
    v_mul_f32 v108, v108, v9
    v_mul_f32 v109, v109, v9
    v_mul_f32 v110, v110, v9
    v_mul_f32 v111, v111, v9
    v_cvt_pk_bf16_f32 v232, v80, v81
    v_cvt_pk_bf16_f32 v233, v82, v83
    v_cvt_pk_bf16_f32 v234, v84, v85
    v_cvt_pk_bf16_f32 v235, v86, v87
    v_cvt_pk_bf16_f32 v236, v88, v89
    v_cvt_pk_bf16_f32 v237, v90, v91
    v_cvt_pk_bf16_f32 v238, v92, v93
    v_cvt_pk_bf16_f32 v239, v94, v95
    v_cvt_pk_bf16_f32 v240, v96, v97
    v_cvt_pk_bf16_f32 v241, v98, v99
    v_cvt_pk_bf16_f32 v242, v100, v101
    v_cvt_pk_bf16_f32 v243, v102, v103
    v_cvt_pk_bf16_f32 v244, v104, v105
    v_cvt_pk_bf16_f32 v245, v106, v107
    v_cvt_pk_bf16_f32 v246, v108, v109
    v_cvt_pk_bf16_f32 v247, v110, v111
    buffer_store_dwordx4 v[232:235], v1, s[8:11], s53 offen offset:0 sc1
    buffer_store_dwordx4 v[236:239], v1, s[8:11], s53 offen offset:1024 sc1
    buffer_store_dwordx4 v[240:243], v1, s[8:11], s53 offen offset:2048 sc1
    buffer_store_dwordx4 v[244:247], v1, s[8:11], s53 offen offset:3072 sc1
    v_mov_b32 v48, 0
    v_mov_b32 v49, 0
    v_mov_b32 v50, 0
    v_mov_b32 v51, 0
    v_mov_b32 v52, 0
    v_mov_b32 v53, 0
    v_mov_b32 v54, 0
    v_mov_b32 v55, 0
    v_mov_b32 v56, 0
    v_mov_b32 v57, 0
    v_mov_b32 v58, 0
    v_mov_b32 v59, 0
    v_mov_b32 v60, 0
    v_mov_b32 v61, 0
    v_mov_b32 v62, 0
    v_mov_b32 v63, 0
    v_mov_b32 v64, 0
    v_mov_b32 v65, 0
    v_mov_b32 v66, 0
    v_mov_b32 v67, 0
    v_mov_b32 v68, 0
    v_mov_b32 v69, 0
    v_mov_b32 v70, 0
    v_mov_b32 v71, 0
    v_mov_b32 v72, 0
    v_mov_b32 v73, 0
    v_mov_b32 v74, 0
    v_mov_b32 v75, 0
    v_mov_b32 v76, 0
    v_mov_b32 v77, 0
    v_mov_b32 v78, 0
    v_mov_b32 v79, 0
    v_mov_b32 v80, 0
    v_mov_b32 v81, 0
    v_mov_b32 v82, 0
    v_mov_b32 v83, 0
    v_mov_b32 v84, 0
    v_mov_b32 v85, 0
    v_mov_b32 v86, 0
    v_mov_b32 v87, 0
    v_mov_b32 v88, 0
    v_mov_b32 v89, 0
    v_mov_b32 v90, 0
    v_mov_b32 v91, 0
    v_mov_b32 v92, 0
    v_mov_b32 v93, 0
    v_mov_b32 v94, 0
    v_mov_b32 v95, 0
    v_mov_b32 v96, 0
    v_mov_b32 v97, 0
    v_mov_b32 v98, 0
    v_mov_b32 v99, 0
    v_mov_b32 v100, 0
    v_mov_b32 v101, 0
    v_mov_b32 v102, 0
    v_mov_b32 v103, 0
    v_mov_b32 v104, 0
    v_mov_b32 v105, 0
    v_mov_b32 v106, 0
    v_mov_b32 v107, 0
    v_mov_b32 v108, 0
    v_mov_b32 v109, 0
    v_mov_b32 v110, 0
    v_mov_b32 v111, 0
LF_nofinloop0:
    s_add_u32 s69, s68, 4
    s_cmp_lg_u32 s62, s69
    s_cbranch_scc1 LF_nopubS
    s_add_u32 s69, s24, 32
    s_lshl_b32 s69, s69, 2
    s_cmp_lg_u32 s20, 0
    s_cbranch_scc1 LF_pub15
    v_mov_b32 v14, 1
    v_mov_b32 v15, 0
    s_mov_b64 exec, 1
    buffer_atomic_add v14, v15, s[96:99], s69 offen sc1
    s_mov_b64 exec, -1
LF_pub15:
LF_nopubS:
    s_cmp_lg_u32 s62, s68
    s_cbranch_scc1 LF_nosw
    s_cmp_eq_u32 s25, 0
    s_cbranch_scc1 LF_nosw
    s_lshl_b32 s69, s26, 13
    s_add_u32 s69, s69, 131072
    v_add_u32 v9, s69, v1
    s_nop 7
    ds_read_b128 v[16:19], v9 offset:0
    ds_read_b128 v[20:23], v9 offset:1024
    ds_read_b128 v[24:27], v9 offset:2048
    ds_read_b128 v[28:31], v9 offset:3072
    ds_read_b128 v[32:35], v9 offset:4096
    ds_read_b128 v[36:39], v9 offset:5120
    ds_read_b128 v[40:43], v9 offset:6144
    ds_read_b128 v[44:47], v9 offset:7168
    v_mov_b32 v160, 0
    v_mov_b32 v161, 0
    v_mov_b32 v162, 0
    v_mov_b32 v163, 0
    v_mov_b32 v164, 0
    v_mov_b32 v165, 0
    v_mov_b32 v166, 0
    v_mov_b32 v167, 0
    v_mov_b32 v168, 0
    v_mov_b32 v169, 0
    v_mov_b32 v170, 0
    v_mov_b32 v171, 0
    v_mov_b32 v172, 0
    v_mov_b32 v173, 0
    v_mov_b32 v174, 0
    v_mov_b32 v175, 0
    v_mov_b32 v6, 0
    s_mov_b32 s61, s28
    s_mov_b32 s60, 0
    s_waitcnt lgkmcnt(0)
LF_nosw:
    s_lshr_b32 s68, s62, 1
    s_lshl_b32 s69, s68, 1
    s_sub_u32 s69, s69, s47
    s_add_u32 s69, s69, s25
    s_cmp_ge_u32 s68, s47
    s_cselect_b32 s68, s69, s68
    s_lshl_b32 s68, s68, 1
    s_add_u32 s68, s68, 0
    s_cmp_lt_u32 s68, s61
    s_cbranch_scc1 LF_nomaskloop0
    s_sub_u32 s68, s61, s68
    s_lshl_b32 s68, s68, 5
    v_add_u32 v9, s68, v4
    v_mov_b32 v10, 0xf149f2ca
    v_cmp_gt_i32 vcc, 0, v9
    s_nop 1
    v_cndmask_b32 v160, v160, v10, vcc
    v_cmp_gt_i32 vcc, 1, v9
    s_nop 1
    v_cndmask_b32 v161, v161, v10, vcc
    v_cmp_gt_i32 vcc, 2, v9
    s_nop 1
    v_cndmask_b32 v162, v162, v10, vcc
    v_cmp_gt_i32 vcc, 3, v9
    s_nop 1
    v_cndmask_b32 v163, v163, v10, vcc
    v_cmp_gt_i32 vcc, 8, v9
    s_nop 1
    v_cndmask_b32 v164, v164, v10, vcc
    v_cmp_gt_i32 vcc, 9, v9
    s_nop 1
    v_cndmask_b32 v165, v165, v10, vcc
    v_cmp_gt_i32 vcc, 10, v9
    s_nop 1
    v_cndmask_b32 v166, v166, v10, vcc
    v_cmp_gt_i32 vcc, 11, v9
    s_nop 1
    v_cndmask_b32 v167, v167, v10, vcc
    v_cmp_gt_i32 vcc, 16, v9
    s_nop 1
    v_cndmask_b32 v168, v168, v10, vcc
    v_cmp_gt_i32 vcc, 17, v9
    s_nop 1
    v_cndmask_b32 v169, v169, v10, vcc
    v_cmp_gt_i32 vcc, 18, v9
    s_nop 1
    v_cndmask_b32 v170, v170, v10, vcc
    v_cmp_gt_i32 vcc, 19, v9
    s_nop 1
    v_cndmask_b32 v171, v171, v10, vcc
    v_cmp_gt_i32 vcc, 24, v9
    s_nop 1
    v_cndmask_b32 v172, v172, v10, vcc
    v_cmp_gt_i32 vcc, 25, v9
    s_nop 1
    v_cndmask_b32 v173, v173, v10, vcc
    v_cmp_gt_i32 vcc, 26, v9
    s_nop 1
    v_cndmask_b32 v174, v174, v10, vcc
    v_cmp_gt_i32 vcc, 27, v9
    s_nop 1
    v_cndmask_b32 v175, v175, v10, vcc
LF_nomaskloop0:
    s_add_u32 s68, s62, 1
    s_max_u32 s66, s68, 32
    s_cmp_le_u32 s68, s49
    s_cselect_b32 s66, s68, s66
    s_branch LF_eretloop0
LF_evtloop1:
    s_lshl_b32 s68, s47, 1
    s_add_u32 s69, s68, 1
    s_cmp_lg_u32 s62, s69
    s_cbranch_scc1 LF_nomid
    s_cmp_eq_u32 s25, 0
    s_cbranch_scc1 LF_nomid
    v_mov_b32 v8, v5
    v_mov_b32 v5, 0
    s_mov_b32 s60, 1.0
    s_mov_b32 s57, 0xbf800000
    s_mov_b32 s58, 0xe0ad78ec
    s_mov_b32 s59, 1
LF_nomid:
    s_lshr_b32 s68, s62, 1
    s_lshl_b32 s69, s68, 1
    s_sub_u32 s69, s69, s47
    s_add_u32 s69, s69, s25
    s_cmp_ge_u32 s68, s47
    s_cselect_b32 s68, s69, s68
    s_lshl_b32 s68, s68, 1
    s_add_u32 s68, s68, 1
    s_cmp_lt_u32 s68, s61
    s_cbranch_scc1 LF_nomaskloop1
    s_sub_u32 s68, s61, s68
    s_lshl_b32 s68, s68, 5
    v_add_u32 v9, s68, v4
    v_mov_b32 v10, 0xf149f2ca
    v_cmp_gt_i32 vcc, 0, v9
    s_nop 1
    v_cndmask_b32 v160, v160, v10, vcc
    v_cmp_gt_i32 vcc, 1, v9
    s_nop 1
    v_cndmask_b32 v161, v161, v10, vcc
    v_cmp_gt_i32 vcc, 2, v9
    s_nop 1
    v_cndmask_b32 v162, v162, v10, vcc
    v_cmp_gt_i32 vcc, 3, v9
    s_nop 1
    v_cndmask_b32 v163, v163, v10, vcc
    v_cmp_gt_i32 vcc, 8, v9
    s_nop 1
    v_cndmask_b32 v164, v164, v10, vcc
    v_cmp_gt_i32 vcc, 9, v9
    s_nop 1
    v_cndmask_b32 v165, v165, v10, vcc
    v_cmp_gt_i32 vcc, 10, v9
    s_nop 1
    v_cndmask_b32 v166, v166, v10, vcc
    v_cmp_gt_i32 vcc, 11, v9
    s_nop 1
    v_cndmask_b32 v167, v167, v10, vcc
    v_cmp_gt_i32 vcc, 16, v9
    s_nop 1
    v_cndmask_b32 v168, v168, v10, vcc
    v_cmp_gt_i32 vcc, 17, v9
    s_nop 1
    v_cndmask_b32 v169, v169, v10, vcc
    v_cmp_gt_i32 vcc, 18, v9
    s_nop 1
    v_cndmask_b32 v170, v170, v10, vcc
    v_cmp_gt_i32 vcc, 19, v9
    s_nop 1
    v_cndmask_b32 v171, v171, v10, vcc
    v_cmp_gt_i32 vcc, 24, v9
    s_nop 1
    v_cndmask_b32 v172, v172, v10, vcc
    v_cmp_gt_i32 vcc, 25, v9
    s_nop 1
    v_cndmask_b32 v173, v173, v10, vcc
    v_cmp_gt_i32 vcc, 26, v9
    s_nop 1
    v_cndmask_b32 v174, v174, v10, vcc
    v_cmp_gt_i32 vcc, 27, v9
    s_nop 1
    v_cndmask_b32 v175, v175, v10, vcc
LF_nomaskloop1:
    s_add_u32 s68, s62, 1
    s_max_u32 s66, s68, 32
    s_cmp_le_u32 s68, s49
    s_cselect_b32 s66, s68, s66
    s_branch LF_eretloop1
LF_raredrain0:
    s_nop 15
    s_nop 7
    v_max3_f32 v9, v128, v129, v130
    v_max3_f32 v9, v9, v131, v132
    v_max3_f32 v9, v9, v133, v134
    v_max3_f32 v9, v9, v135, v136
    v_max3_f32 v9, v9, v137, v138
    v_max3_f32 v9, v9, v139, v140
    v_max3_f32 v9, v9, v141, v142
    v_max_f32 v9, v9, v143
    v_mov_b32 v10, v9
    s_nop 1
    v_permlane32_swap_b32 v9, v10
    v_max_f32 v9, v9, v10
    v_max_f32 v9, s58, v9
    v_sub_f32 v10, 0, v9
    v_min_f32 v10, 0x42fc0000, v10
    v_exp_f32 v10, v10
    v_mul_f32 v11, s60, v9
    v_sub_f32 v128, v128, v9
    v_sub_f32 v129, v129, v9
    v_sub_f32 v130, v130, v9
    v_sub_f32 v131, v131, v9
    v_sub_f32 v132, v132, v9
    v_sub_f32 v133, v133, v9
    v_sub_f32 v134, v134, v9
    v_sub_f32 v135, v135, v9
    v_sub_f32 v136, v136, v9
    v_sub_f32 v137, v137, v9
    v_sub_f32 v138, v138, v9
    v_sub_f32 v139, v139, v9
    v_sub_f32 v140, v140, v9
    v_sub_f32 v141, v141, v9
    v_sub_f32 v142, v142, v9
    v_sub_f32 v143, v143, v9
    v_exp_f32 v216, v128
    v_exp_f32 v217, v129
    v_exp_f32 v218, v130
    v_exp_f32 v219, v131
    v_exp_f32 v220, v132
    v_exp_f32 v221, v133
    v_exp_f32 v222, v134
    v_exp_f32 v223, v135
    v_exp_f32 v224, v136
    v_exp_f32 v225, v137
    v_exp_f32 v226, v138
    v_exp_f32 v227, v139
    v_exp_f32 v228, v140
    v_exp_f32 v229, v141
    v_exp_f32 v230, v142
    v_exp_f32 v231, v143
    v_add_f32 v7, v216, v217
    v_add_f32 v7, v7, v218
    v_add_f32 v7, v7, v219
    v_add_f32 v7, v7, v220
    v_add_f32 v7, v7, v221
    v_add_f32 v7, v7, v222
    v_add_f32 v7, v7, v223
    v_add_f32 v7, v7, v224
    v_add_f32 v7, v7, v225
    v_add_f32 v7, v7, v226
    v_add_f32 v7, v7, v227
    v_add_f32 v7, v7, v228
    v_add_f32 v7, v7, v229
    v_add_f32 v7, v7, v230
    v_add_f32 v7, v7, v231
    v_cvt_pk_bf16_f32 v152, v216, v217
    v_cvt_pk_bf16_f32 v153, v218, v219
    v_cvt_pk_bf16_f32 v154, v220, v221
    v_cvt_pk_bf16_f32 v155, v222, v223
    v_cvt_pk_bf16_f32 v156, v224, v225
    v_cvt_pk_bf16_f32 v157, v226, v227
    v_cvt_pk_bf16_f32 v158, v228, v229
    v_cvt_pk_bf16_f32 v159, v230, v231
    v_sub_f32 v112, v112, v11
    v_sub_f32 v113, v113, v11
    v_sub_f32 v114, v114, v11
    v_sub_f32 v115, v115, v11
    v_sub_f32 v116, v116, v11
    v_sub_f32 v117, v117, v11
    v_sub_f32 v118, v118, v11
    v_sub_f32 v119, v119, v11
    v_sub_f32 v120, v120, v11
    v_sub_f32 v121, v121, v11
    v_sub_f32 v122, v122, v11
    v_sub_f32 v123, v123, v11
    v_sub_f32 v124, v124, v11
    v_sub_f32 v125, v125, v11
    v_sub_f32 v126, v126, v11
    v_sub_f32 v127, v127, v11
    v_sub_f32 v160, v160, v11
    v_sub_f32 v161, v161, v11
    v_sub_f32 v162, v162, v11
    v_sub_f32 v163, v163, v11
    v_sub_f32 v164, v164, v11
    v_sub_f32 v165, v165, v11
    v_sub_f32 v166, v166, v11
    v_sub_f32 v167, v167, v11
    v_sub_f32 v168, v168, v11
    v_sub_f32 v169, v169, v11
    v_sub_f32 v170, v170, v11
    v_sub_f32 v171, v171, v11
    v_sub_f32 v172, v172, v11
    v_sub_f32 v173, v173, v11
    v_sub_f32 v174, v174, v11
    v_sub_f32 v175, v175, v11
    v_add_f32 v6, v6, v11
    v_mul_f32 v5, v5, v10
    s_cmp_lg_u32 s59, 0
    s_cbranch_scc1 LF_rskipdrain0
    v_mul_f32 v48, v48, v10
    v_mul_f32 v49, v49, v10
    v_mul_f32 v50, v50, v10
    v_mul_f32 v51, v51, v10
    v_mul_f32 v52, v52, v10
    v_mul_f32 v53, v53, v10
    v_mul_f32 v54, v54, v10
    v_mul_f32 v55, v55, v10
    v_mul_f32 v56, v56, v10
    v_mul_f32 v57, v57, v10
    v_mul_f32 v58, v58, v10
    v_mul_f32 v59, v59, v10
    v_mul_f32 v60, v60, v10
    v_mul_f32 v61, v61, v10
    v_mul_f32 v62, v62, v10
    v_mul_f32 v63, v63, v10
    v_mul_f32 v64, v64, v10
    v_mul_f32 v65, v65, v10
    v_mul_f32 v66, v66, v10
    v_mul_f32 v67, v67, v10
    v_mul_f32 v68, v68, v10
    v_mul_f32 v69, v69, v10
    v_mul_f32 v70, v70, v10
    v_mul_f32 v71, v71, v10
    v_mul_f32 v72, v72, v10
    v_mul_f32 v73, v73, v10
    v_mul_f32 v74, v74, v10
    v_mul_f32 v75, v75, v10
    v_mul_f32 v76, v76, v10
    v_mul_f32 v77, v77, v10
    v_mul_f32 v78, v78, v10
    v_mul_f32 v79, v79, v10
    v_mul_f32 v80, v80, v10
    v_mul_f32 v81, v81, v10
    v_mul_f32 v82, v82, v10
    v_mul_f32 v83, v83, v10
    v_mul_f32 v84, v84, v10
    v_mul_f32 v85, v85, v10
    v_mul_f32 v86, v86, v10
    v_mul_f32 v87, v87, v10
    v_mul_f32 v88, v88, v10
    v_mul_f32 v89, v89, v10
    v_mul_f32 v90, v90, v10
    v_mul_f32 v91, v91, v10
    v_mul_f32 v92, v92, v10
    v_mul_f32 v93, v93, v10
    v_mul_f32 v94, v94, v10
    v_mul_f32 v95, v95, v10
    v_mul_f32 v96, v96, v10
    v_mul_f32 v97, v97, v10
    v_mul_f32 v98, v98, v10
    v_mul_f32 v99, v99, v10
    v_mul_f32 v100, v100, v10
    v_mul_f32 v101, v101, v10
    v_mul_f32 v102, v102, v10
    v_mul_f32 v103, v103, v10
    v_mul_f32 v104, v104, v10
    v_mul_f32 v105, v105, v10
    v_mul_f32 v106, v106, v10
    v_mul_f32 v107, v107, v10
    v_mul_f32 v108, v108, v10
    v_mul_f32 v109, v109, v10
    v_mul_f32 v110, v110, v10
    v_mul_f32 v111, v111, v10
LF_rskipdrain0:
    s_mov_b32 s56, 0x49800000
    s_branch LF_retdrain0
LF_evtdrain0:
    s_lshl_b32 s68, s47, 1
    s_add_u32 s69, s68, 2
    s_cmp_lg_u32 s62, s69
    s_cbranch_scc1 LF_nofindrain0
    s_cmp_eq_u32 s25, 0
    s_cbranch_scc1 LF_nofindrain0
    s_nop 15
    s_nop 7
    v_mov_b32 v9, v8
    s_nop 1
    v_permlane32_swap_b32 v8, v9
    v_add_f32 v9, v8, v9
    v_rcp_f32 v9, v9
    s_mul_i32 s52, s27, 350208
    s_lshl_b32 s54, s21, 13
    s_add_u32 s52, s52, s54
    s_add_u32 s52, s52, 0x2200000
    s_add_u32 s53, s52, 4096
    v_mul_f32 v48, v48, v9
    v_mul_f32 v49, v49, v9
    v_mul_f32 v50, v50, v9
    v_mul_f32 v51, v51, v9
    v_mul_f32 v52, v52, v9
    v_mul_f32 v53, v53, v9
    v_mul_f32 v54, v54, v9
    v_mul_f32 v55, v55, v9
    v_mul_f32 v56, v56, v9
    v_mul_f32 v57, v57, v9
    v_mul_f32 v58, v58, v9
    v_mul_f32 v59, v59, v9
    v_mul_f32 v60, v60, v9
    v_mul_f32 v61, v61, v9
    v_mul_f32 v62, v62, v9
    v_mul_f32 v63, v63, v9
    v_mul_f32 v64, v64, v9
    v_mul_f32 v65, v65, v9
    v_mul_f32 v66, v66, v9
    v_mul_f32 v67, v67, v9
    v_mul_f32 v68, v68, v9
    v_mul_f32 v69, v69, v9
    v_mul_f32 v70, v70, v9
    v_mul_f32 v71, v71, v9
    v_mul_f32 v72, v72, v9
    v_mul_f32 v73, v73, v9
    v_mul_f32 v74, v74, v9
    v_mul_f32 v75, v75, v9
    v_mul_f32 v76, v76, v9
    v_mul_f32 v77, v77, v9
    v_mul_f32 v78, v78, v9
    v_mul_f32 v79, v79, v9
    v_cvt_pk_bf16_f32 v216, v48, v49
    v_cvt_pk_bf16_f32 v217, v50, v51
    v_cvt_pk_bf16_f32 v218, v52, v53
    v_cvt_pk_bf16_f32 v219, v54, v55
    v_cvt_pk_bf16_f32 v220, v56, v57
    v_cvt_pk_bf16_f32 v221, v58, v59
    v_cvt_pk_bf16_f32 v222, v60, v61
    v_cvt_pk_bf16_f32 v223, v62, v63
    v_cvt_pk_bf16_f32 v224, v64, v65
    v_cvt_pk_bf16_f32 v225, v66, v67
    v_cvt_pk_bf16_f32 v226, v68, v69
    v_cvt_pk_bf16_f32 v227, v70, v71
    v_cvt_pk_bf16_f32 v228, v72, v73
    v_cvt_pk_bf16_f32 v229, v74, v75
    v_cvt_pk_bf16_f32 v230, v76, v77
    v_cvt_pk_bf16_f32 v231, v78, v79
    buffer_store_dwordx4 v[216:219], v1, s[8:11], s52 offen offset:0 sc1
    buffer_store_dwordx4 v[220:223], v1, s[8:11], s52 offen offset:1024 sc1
    buffer_store_dwordx4 v[224:227], v1, s[8:11], s52 offen offset:2048 sc1
    buffer_store_dwordx4 v[228:231], v1, s[8:11], s52 offen offset:3072 sc1
    v_mul_f32 v80, v80, v9
    v_mul_f32 v81, v81, v9
    v_mul_f32 v82, v82, v9
    v_mul_f32 v83, v83, v9
    v_mul_f32 v84, v84, v9
    v_mul_f32 v85, v85, v9
    v_mul_f32 v86, v86, v9
    v_mul_f32 v87, v87, v9
    v_mul_f32 v88, v88, v9
    v_mul_f32 v89, v89, v9
    v_mul_f32 v90, v90, v9
    v_mul_f32 v91, v91, v9
    v_mul_f32 v92, v92, v9
    v_mul_f32 v93, v93, v9
    v_mul_f32 v94, v94, v9
    v_mul_f32 v95, v95, v9
    v_mul_f32 v96, v96, v9
    v_mul_f32 v97, v97, v9
    v_mul_f32 v98, v98, v9
    v_mul_f32 v99, v99, v9
    v_mul_f32 v100, v100, v9
    v_mul_f32 v101, v101, v9
    v_mul_f32 v102, v102, v9
    v_mul_f32 v103, v103, v9
    v_mul_f32 v104, v104, v9
    v_mul_f32 v105, v105, v9
    v_mul_f32 v106, v106, v9
    v_mul_f32 v107, v107, v9
    v_mul_f32 v108, v108, v9
    v_mul_f32 v109, v109, v9
    v_mul_f32 v110, v110, v9
    v_mul_f32 v111, v111, v9
    v_cvt_pk_bf16_f32 v232, v80, v81
    v_cvt_pk_bf16_f32 v233, v82, v83
    v_cvt_pk_bf16_f32 v234, v84, v85
    v_cvt_pk_bf16_f32 v235, v86, v87
    v_cvt_pk_bf16_f32 v236, v88, v89
    v_cvt_pk_bf16_f32 v237, v90, v91
    v_cvt_pk_bf16_f32 v238, v92, v93
    v_cvt_pk_bf16_f32 v239, v94, v95
    v_cvt_pk_bf16_f32 v240, v96, v97
    v_cvt_pk_bf16_f32 v241, v98, v99
    v_cvt_pk_bf16_f32 v242, v100, v101
    v_cvt_pk_bf16_f32 v243, v102, v103
    v_cvt_pk_bf16_f32 v244, v104, v105
    v_cvt_pk_bf16_f32 v245, v106, v107
    v_cvt_pk_bf16_f32 v246, v108, v109
    v_cvt_pk_bf16_f32 v247, v110, v111
    buffer_store_dwordx4 v[232:235], v1, s[8:11], s53 offen offset:0 sc1
    buffer_store_dwordx4 v[236:239], v1, s[8:11], s53 offen offset:1024 sc1
    buffer_store_dwordx4 v[240:243], v1, s[8:11], s53 offen offset:2048 sc1
    buffer_store_dwordx4 v[244:247], v1, s[8:11], s53 offen offset:3072 sc1
    v_mov_b32 v48, 0
    v_mov_b32 v49, 0
    v_mov_b32 v50, 0
    v_mov_b32 v51, 0
    v_mov_b32 v52, 0
    v_mov_b32 v53, 0
    v_mov_b32 v54, 0
    v_mov_b32 v55, 0
    v_mov_b32 v56, 0
    v_mov_b32 v57, 0
    v_mov_b32 v58, 0
    v_mov_b32 v59, 0
    v_mov_b32 v60, 0
    v_mov_b32 v61, 0
    v_mov_b32 v62, 0
    v_mov_b32 v63, 0
    v_mov_b32 v64, 0
    v_mov_b32 v65, 0
    v_mov_b32 v66, 0
    v_mov_b32 v67, 0
    v_mov_b32 v68, 0
    v_mov_b32 v69, 0
    v_mov_b32 v70, 0
    v_mov_b32 v71, 0
    v_mov_b32 v72, 0
    v_mov_b32 v73, 0
    v_mov_b32 v74, 0
    v_mov_b32 v75, 0
    v_mov_b32 v76, 0
    v_mov_b32 v77, 0
    v_mov_b32 v78, 0
    v_mov_b32 v79, 0
    v_mov_b32 v80, 0
    v_mov_b32 v81, 0
    v_mov_b32 v82, 0
    v_mov_b32 v83, 0
    v_mov_b32 v84, 0
    v_mov_b32 v85, 0
    v_mov_b32 v86, 0
    v_mov_b32 v87, 0
    v_mov_b32 v88, 0
    v_mov_b32 v89, 0
    v_mov_b32 v90, 0
    v_mov_b32 v91, 0
    v_mov_b32 v92, 0
    v_mov_b32 v93, 0
    v_mov_b32 v94, 0
    v_mov_b32 v95, 0
    v_mov_b32 v96, 0
    v_mov_b32 v97, 0
    v_mov_b32 v98, 0
    v_mov_b32 v99, 0
    v_mov_b32 v100, 0
    v_mov_b32 v101, 0
    v_mov_b32 v102, 0
    v_mov_b32 v103, 0
    v_mov_b32 v104, 0
    v_mov_b32 v105, 0
    v_mov_b32 v106, 0
    v_mov_b32 v107, 0
    v_mov_b32 v108, 0
    v_mov_b32 v109, 0
    v_mov_b32 v110, 0
    v_mov_b32 v111, 0
LF_nofindrain0:
    s_add_u32 s68, s62, 1
    s_max_u32 s66, s68, 32
    s_cmp_le_u32 s68, s49
    s_cselect_b32 s66, s68, s66
    s_branch LF_eretdrain0
LF_pc3_slow:
    s_mov_b32 s3, 32768
    v_mov_b32 v8, 0
LF_pc3_s0:
    buffer_load_dword v14, v8, s[96:99], s29 offen sc1
    s_waitcnt vmcnt(0)
    v_readfirstlane_b32 s100, v14
    s_sub_u32 s3, s3, 1
    s_cmp_eq_u32 s3, 0
    s_cbranch_scc1 LF_pc3_ok
    s_cmp_ge_u32 s100, 16
    s_cbranch_scc1 LF_pc3_s0_ok
    s_sleep 2
    s_branch LF_pc3_s0
LF_pc3_s0_ok:
LF_pc3_s1:
    buffer_load_dword v14, v8, s[96:99], s30 offen sc1
    s_waitcnt vmcnt(0)
    v_readfirstlane_b32 s100, v14
    s_sub_u32 s3, s3, 1
    s_cmp_eq_u32 s3, 0
    s_cbranch_scc1 LF_pc3_ok
    s_cmp_ge_u32 s100, 16
    s_cbranch_scc1 LF_pc3_s1_ok
    s_sleep 2
    s_branch LF_pc3_s1
LF_pc3_s1_ok:
    s_branch LF_pc3_ok
LF_pc6_slow:
    s_mov_b32 s3, 32768
    v_mov_b32 v8, 0
LF_pc6_s0:
    buffer_load_dword v14, v8, s[96:99], s29 offen sc1
    s_waitcnt vmcnt(0)
    v_readfirstlane_b32 s100, v14
    s_sub_u32 s3, s3, 1
    s_cmp_eq_u32 s3, 0
    s_cbranch_scc1 LF_pc6_ok
    s_cmp_ge_u32 s100, 16
    s_cbranch_scc1 LF_pc6_s0_ok
    s_sleep 2
    s_branch LF_pc6_s0
LF_pc6_s0_ok:
LF_pc6_s1:
    buffer_load_dword v14, v8, s[96:99], s30 offen sc1
    s_waitcnt vmcnt(0)
    v_readfirstlane_b32 s100, v14
    s_sub_u32 s3, s3, 1
    s_cmp_eq_u32 s3, 0
    s_cbranch_scc1 LF_pc6_ok
    s_cmp_ge_u32 s100, 16
    s_cbranch_scc1 LF_pc6_s1_ok
    s_sleep 2
    s_branch LF_pc6_s1
LF_pc6_s1_ok:
    s_branch LF_pc6_ok
LF_pc10_slow:
    s_mov_b32 s3, 32768
    v_mov_b32 v8, 0
LF_pc10_s0:
    buffer_load_dword v14, v8, s[96:99], s29 offen sc1
    s_waitcnt vmcnt(0)
    v_readfirstlane_b32 s100, v14
    s_sub_u32 s3, s3, 1
    s_cmp_eq_u32 s3, 0
    s_cbranch_scc1 LF_pc10_ok
    s_cmp_ge_u32 s100, 16
    s_cbranch_scc1 LF_pc10_s0_ok
    s_sleep 2
    s_branch LF_pc10_s0
LF_pc10_s0_ok:
    s_branch LF_pc10_ok
LF_end:
    s_endpgm
.section .rodata,"a"
.p2align 6
.amdhsa_kernel recurrent_scan__compressed_kv_cla__geglu_ffn__prompt_kernel
  .amdhsa_next_free_vgpr 256
  .amdhsa_next_free_sgpr 102
  .amdhsa_accum_offset 256
  .amdhsa_group_segment_fixed_size 0
  .amdhsa_kernarg_size 104
  .amdhsa_user_sgpr_count 2
  .amdhsa_user_sgpr_kernarg_segment_ptr 1
  .amdhsa_system_sgpr_workgroup_id_x 1
  .amdhsa_float_denorm_mode_32 3
  .amdhsa_float_denorm_mode_16_64 3
.end_amdhsa_kernel
```
